```python
import torch

def _softmax(x, axis=-1):
    return torch.softmax(x, dim=axis)

def _gelu(x):
    return torch.nn.functional.gelu(x, approximate='tanh')

def _silu(x):
    return torch.nn.functional.silu(x)

def _sigmoid(x):
    return torch.sigmoid(x)

def _layernorm(x, axis=-1, eps=1e-05):
    m = x.mean(dim=axis, keepdim=True)
    v = x.var(dim=axis, keepdim=True, unbiased=False)
    return (x - m) / torch.sqrt(v + eps)

def _scatter_add(tgt, idx, src, axis=0):
    return tgt.clone().index_add_(axis, idx, src)

def _segment_sum(src, seg, n):
    out = torch.zeros((n,) + src.shape[1:], dtype=src.dtype)
    return out.index_add_(0, seg, src)

def _pad(x, pw):
    flat = tuple((v for pair in reversed(pw) for v in pair))
    return torch.nn.functional.pad(x, flat)
kernel_name = 'gated_mix__grouped_kv_mqa__mixer_gmlp__prompt'

def setup_inputs():

    _w = lambda a: (lambda t: t.to(torch.bfloat16) if t.is_floating_point() else t)(torch.as_tensor(a))

    def _A_setup():
        B, S, D, H = (1, 2048, 1024, 32)
        Dh = D // H
        return {'x': _w((lambda *s: torch.randn(*s, dtype=torch.bfloat16) * 0.05)(B, S, D)), 'wq': _w((lambda *s: torch.randn(*s, dtype=torch.bfloat16) * 0.8)(D, H * Dh)), 'wk': _w((lambda *s: torch.randn(*s, dtype=torch.bfloat16) * 0.8)(D, Dh)), 'wv': _w((lambda *s: torch.randn(*s, dtype=torch.bfloat16) * 0.2)(D, Dh)), 'wo': _w((lambda *s: torch.randn(*s, dtype=torch.bfloat16) * 0.2)(H * Dh, D))}
    _A_in = _A_setup()

    def _B_setup():
        B, S, D, F = (1, 2048, 1024, 3584)
        Fh = F // 2
        return {'x': _w((lambda *s: torch.randn(*s, dtype=torch.bfloat16) * 0.05)(B, S, D)), 'w_in': _w((lambda *s: torch.randn(*s, dtype=torch.bfloat16) * 0.4)(D, 2 * Fh)), 'w_sp': _w(0.01 * (lambda *s: torch.randn(*s, dtype=torch.bfloat16) * 0.4)(S, S)), 'b_sp': _w(1.0 + 0.01 * (lambda *s: torch.randn(*s, dtype=torch.bfloat16) * 0.05)(S)), 'w_out': _w((lambda *s: torch.randn(*s, dtype=torch.bfloat16) * 0.05)(Fh, D))}
    _B_in = _B_setup()
    return {'A_x': _A_in['x'], 'A_wq': _A_in['wq'], 'A_wk': _A_in['wk'], 'A_wv': _A_in['wv'], 'A_wo': _A_in['wo'], 'B_x': _B_in['x'], 'B_w_in': _B_in['w_in'], 'B_w_sp': _B_in['w_sp'], 'B_b_sp': _B_in['b_sp'], 'B_w_out': _B_in['w_out'], 'gate_w': _w((lambda *s: torch.randn(*s, dtype=torch.bfloat16) * 0.05)(1024) * 16.0)}

def reference(A_x, A_wq, A_wk, A_wv, A_wo, B_x, B_w_in, B_w_sp, B_b_sp, B_w_out, gate_w):

    def _A_ref(x, wq, wk, wv, wo):
        B, S, D = x.shape
        H = 32
        Dh = D // H
        q = (lambda x, *d: x.permute(*d))((x @ wq).reshape(B, S, H, Dh), 0, 2, 1, 3)
        k = x @ wk
        v = x @ wv
        scores = torch.einsum('bhqd,bkd->bhqk', q, k) * Dh ** (-0.5)
        p = _softmax(scores, axis=-1)
        o = torch.einsum('bhqk,bkd->bhqd', p, v)
        return (lambda x, *d: x.permute(*d))(o, 0, 2, 1, 3).reshape(B, S, H * Dh) @ wo

    def _B_ref(x, w_in, w_sp, b_sp, w_out):
        B, S, D = x.shape
        F = w_in.shape[-1]
        Fh = F // 2
        z = _gelu(torch.einsum('bsd,df->bsf', x, w_in))
        z1 = z[..., :Fh].clone()
        z2 = _layernorm(z[..., Fh:], axis=-1)
        g = torch.einsum('ts,bsf->btf', w_sp, z2) + b_sp[None, :, None]
        return torch.einsum('bsf,fd->bsd', z1 * g, w_out)
    x = A_x
    g = _sigmoid((x * gate_w).sum(-1, keepdims=True))
    a = _A_ref(x, A_wq, A_wk, A_wv, A_wo)
    b = _B_ref(x, B_w_in, B_w_sp, B_b_sp, B_w_out)
    return g * a + (1 - g) * b
```

```asm
; @launch grid=(256,1,1) block=(512,1,1) lds=163840
.amdgcn_target "amdgcn-amd-amdhsa--gfx950"
.text
.globl gated_mix__grouped_kv_mqa__mixer_gmlp__prompt_kernel
.p2align 12
.p2align 8
.type gated_mix__grouped_kv_mqa__mixer_gmlp__prompt_kernel,@function
gated_mix__grouped_kv_mqa__mixer_gmlp__prompt_kernel:
    s_cmp_ge_u32 s2, 256
    s_cbranch_scc1 A_exit
    s_load_dwordx2 s[8:9], s[0:1], 0
    s_load_dwordx2 s[12:13], s[0:1], 48
    s_load_dwordx2 s[24:25], s[0:1], 104
    v_lshrrev_b32 v1, 6, v0
    s_bfe_u32 s4, s2, 0x20001
    v_readfirstlane_b32 s3, v1
    s_bfe_u32 s46, s2, 0x20003
    s_lshl2_add_u32 s4, s4, s46
    s_lshr_b32 s55, s2, 5
    s_and_b32 s46, s2, 1
    s_lshl3_add_u32 s5, s46, s55
    s_mov_b32 s26, 0x2000000
    s_mov_b32 s27, 0x20000
    s_cmp_ge_u32 s3, 4
    s_cbranch_scc1 A_loader
WARM_A:
    s_cmp_lg_u32 s3, 0
    s_cbranch_scc1 WARM_A_1
    s_call_b64 s[72:73], PG0
    s_branch WARM_A_done
WARM_A_1:
    s_cmp_lg_u32 s3, 1
    s_cbranch_scc1 WARM_A_2
    s_call_b64 s[72:73], PG1
    s_branch WARM_A_done
WARM_A_2:
    s_cmp_lg_u32 s3, 2
    s_cbranch_scc1 WARM_A_3
    s_call_b64 s[72:73], PGA_l2
    s_branch WARM_A_done
WARM_A_3:
WARM_A_done:
    s_branch A_compute
A_loader:
    s_setprio 2
    s_load_dwordx2 s[36:37], s[0:1], 64
    s_sub_u32 s3, s3, 4
    v_and_b32 v11, 63, v0
    v_lshrrev_b32 v12, 3, v11
    v_and_b32 v13, 7, v11
    v_lshrrev_b32 v14, 1, v12
    v_xor_b32 v14, v14, v13
    v_lshlrev_b32 v14, 4, v14
    v_xor_b32 v15, 64, v14
    s_mov_b32 s10, 0x400000
    s_mov_b32 s11, 0x20000
    s_mov_b32 s14, 0x700000
    s_mov_b32 s15, 0x20000
    s_lshl_b32 s56, s3, 12
    s_lshl2_add_u32 s6, s4, s3
    s_lshl_b32 s6, s6, 16
    s_mov_b32 s51, 0
    s_cmp_ge_u32 s5, 14
    s_cbranch_scc1 A_loader_light
    v_lshrrev_b32 v16, 2, v12
    v_and_b32 v17, 3, v12
    v_lshl_add_u32 v16, v16, 3, v17
    v_lshl_add_u32 v1, v16, 11, v14
    v_lshl_add_u32 v2, v16, 11, v15
    v_add_u32 v2, 32768, v2
    v_lshl_add_u32 v3, v16, 11, v14
    v_add_u32 v3, 8192, v3
    v_lshl_add_u32 v4, v16, 11, v15
    v_add_u32 v4, 40960, v4
    s_mul_i32 s7, s3, 114688
    s_lshl_b32 s46, s5, 8
    s_add_u32 s7, s7, s46
    s_add_u32 s7, s7, 3584
    s_add_u32 s53, s4, s55
    s_mov_b32 s40, 0x76543210
    s_mov_b32 s41, 0xfedcba98
    s_and_b32 s46, s53, 3
    s_cmp_eq_u32 s46, 1
    s_cselect_b32 s40, 0x10765432, s40
    s_cselect_b32 s41, 0xcfed8ba9, s41
    s_cmp_eq_u32 s46, 2
    s_cselect_b32 s40, 0x32107654, s40
    s_cselect_b32 s41, 0xdcfe98ba, s41
    s_cmp_eq_u32 s46, 3
    s_cselect_b32 s40, 0x54321076, s40
    s_cselect_b32 s41, 0xedcfa98b, s41
    s_lshr_b64 s[44:45], s[40:41], s51
    s_and_b32 s59, s44, 15
    s_add_u32 s51, s51, 4
    s_lshl_b32 s58, s59, 7
    s_add_u32 s58, s58, s6
    s_mul_i32 s59, s59, 458752
    s_add_u32 s59, s59, s7
    s_add_u32 m0, s56, 0
    s_nop 0
    s_waitcnt lgkmcnt(0)
    buffer_load_dwordx4 v1, s[8:11], s58 offen lds
    s_add_u32 m0, s56, 1024
    s_nop 0
    buffer_load_dwordx4 v2, s[8:11], s58 offen lds
    s_add_u32 m0, s56, 2048
    s_nop 0
    buffer_load_dwordx4 v3, s[8:11], s58 offen lds
    s_add_u32 m0, s56, 3072
    s_nop 0
    buffer_load_dwordx4 v4, s[8:11], s58 offen lds
    v_lshrrev_b32 v16, 4, v11
    v_and_b32 v17, 15, v11
    v_lshlrev_b32 v18, 2, v16
    v_xor_b32 v17, v17, v18
    v_lshlrev_b32 v17, 4, v17
    v_mul_u32_u24 v16, 7168, v16
    v_add_u32 v5, v16, v17
    v_add_u32 v6, 28672, v5
    v_xor_b32 v17, 32, v5
    v_add_u32 v7, 57344, v17
    v_add_u32 v8, 86016, v17
    s_mov_b32 s38, 0x1000
    s_mov_b32 s39, 0x20000
    v_lshlrev_b32 v16, 2, v11
    s_mov_b32 m0, 158720
    s_lshl_b32 s46, s4, 8
    buffer_load_dword v16, s[36:39], s46 offen lds
    s_add_u32 m0, s56, 65536
    s_nop 0
    buffer_load_dwordx4 v5, s[12:15], s59 offen lds
    s_add_u32 m0, s56, 66560
    s_nop 0
    buffer_load_dwordx4 v6, s[12:15], s59 offen lds
    s_add_u32 m0, s56, 67584
    s_nop 0
    buffer_load_dwordx4 v7, s[12:15], s59 offen lds
    s_add_u32 m0, s56, 68608
    s_nop 0
    buffer_load_dwordx4 v8, s[12:15], s59 offen lds
    s_add_u32 s56, s56, 16384
    s_and_b32 s56, s56, 0xffff
    s_load_dwordx2 s[16:17], s[0:1], 8
    s_load_dwordx2 s[20:21], s[0:1], 56
    s_load_dwordx2 s[28:29], s[0:1], 96
    s_mov_b32 s18, 0x200000
    s_mov_b32 s19, 0x20000
    s_mov_b32 s22, 0x800000
    s_mov_b32 s23, 0x20000
    s_mov_b32 s30, 0x100
    s_mov_b32 s31, 0x20000
    v_lshlrev_b32 v28, 4, v11
    s_lshl_b32 s57, s3, 11
    s_add_u32 s57, s57, 131072
    s_lshl_b32 s50, s3, 15
    s_lshl_b32 s46, s5, 7
    s_add_u32 s50, s50, s46
    s_mov_b32 s52, 0
    v_lshl_add_u32 v20, v12, 11, v14
    v_lshl_add_u32 v21, v12, 11, v15
    v_add_u32 v21, 16384, v21
    v_lshl_add_u32 v22, v12, 11, v14
    v_add_u32 v22, 32768, v22
    v_lshl_add_u32 v23, v12, 11, v15
    v_add_u32 v23, 49152, v23
    v_and_b32 v16, 2, v12
    v_lshlrev_b32 v16, 1, v16
    v_xor_b32 v16, v16, v13
    v_lshlrev_b32 v16, 4, v16
    v_lshl_add_u32 v9, v12, 11, v16
    v_xor_b32 v10, 32, v9
    v_add_u32 v10, 16384, v10
    v_and_b32 v16, 6, v12
    v_xor_b32 v16, v16, v13
    v_lshlrev_b32 v16, 4, v16
    v_lshl_add_u32 v16, v12, 11, v16
    v_add_u32 v29, s50, v16
    v_add_u32 v30, 16384, v29
    v_lshl_add_u32 v24, v12, 12, v14
    v_lshl_add_u32 v25, v12, 12, v15
    v_add_u32 v25, 32768, v25
    v_lshl_add_u32 v26, v12, 12, v14
    v_add_u32 v26, 65536, v26
    v_lshl_add_u32 v27, v12, 12, v15
    v_add_u32 v27, 98304, v27
    v_and_b32 v12, 31, v11
    v_lshlrev_b32 v12, 2, v12
    s_mov_b32 s48, 64
    s_mov_b32 s36, 0x76543210
    s_mov_b32 s37, 0xfedcba98
    s_and_b32 s46, s53, 3
    s_cmp_eq_u32 s46, 1
    s_cselect_b32 s36, 0x47650321, s36
    s_cselect_b32 s37, 0xcfed8ba9, s37
    s_cmp_eq_u32 s46, 2
    s_cselect_b32 s36, 0x54761032, s36
    s_cselect_b32 s37, 0xdcfe98ba, s37
    s_cmp_eq_u32 s46, 3
    s_cselect_b32 s36, 0x65472103, s36
    s_cselect_b32 s37, 0xedcfa98b, s37
    s_waitcnt lgkmcnt(0)
    s_setprio 0
    s_lshr_b64 s[44:45], s[40:41], s51
    s_and_b32 s59, s44, 15
    s_add_u32 s51, s51, 4
    s_lshl_b32 s58, s59, 7
    s_add_u32 s58, s58, s6
    s_mul_i32 s59, s59, 458752
    s_add_u32 s59, s59, s7
    s_add_u32 m0, s56, 0
    s_nop 0
    buffer_load_dwordx4 v1, s[8:11], s58 offen lds
    s_add_u32 m0, s56, 1024
    s_nop 0
    buffer_load_dwordx4 v2, s[8:11], s58 offen lds
    s_add_u32 m0, s56, 2048
    s_nop 0
    buffer_load_dwordx4 v3, s[8:11], s58 offen lds
    s_add_u32 m0, s56, 3072
    s_nop 0
    buffer_load_dwordx4 v4, s[8:11], s58 offen lds
    s_add_u32 m0, s56, 65536
    s_nop 0
    buffer_load_dwordx4 v5, s[12:15], s59 offen lds
    s_add_u32 m0, s56, 66560
    s_nop 0
    buffer_load_dwordx4 v6, s[12:15], s59 offen lds
    s_add_u32 m0, s56, 67584
    s_nop 0
    buffer_load_dwordx4 v7, s[12:15], s59 offen lds
    s_add_u32 m0, s56, 68608
    s_nop 0
    buffer_load_dwordx4 v8, s[12:15], s59 offen lds
    s_add_u32 s56, s56, 16384
    s_and_b32 s56, s56, 0xffff
    s_mov_b32 s61, 14
A_seg1:
    s_waitcnt vmcnt(8)
    s_barrier
    s_lshr_b64 s[44:45], s[40:41], s51
    s_and_b32 s59, s44, 15
    s_add_u32 s51, s51, 4
    s_lshl_b32 s58, s59, 7
    s_add_u32 s58, s58, s6
    s_mul_i32 s59, s59, 458752
    s_add_u32 s59, s59, s7
    s_add_u32 m0, s56, 0
    s_nop 0
    buffer_load_dwordx4 v1, s[8:11], s58 offen lds
    s_add_u32 m0, s56, 1024
    s_nop 0
    buffer_load_dwordx4 v2, s[8:11], s58 offen lds
    s_add_u32 m0, s56, 2048
    s_nop 0
    buffer_load_dwordx4 v3, s[8:11], s58 offen lds
    s_add_u32 m0, s56, 3072
    s_nop 0
    buffer_load_dwordx4 v4, s[8:11], s58 offen lds
    s_add_u32 m0, s56, 65536
    s_nop 0
    buffer_load_dwordx4 v5, s[12:15], s59 offen lds
    s_add_u32 m0, s56, 66560
    s_nop 0
    buffer_load_dwordx4 v6, s[12:15], s59 offen lds
    s_add_u32 m0, s56, 67584
    s_nop 0
    buffer_load_dwordx4 v7, s[12:15], s59 offen lds
    s_add_u32 m0, s56, 68608
    s_nop 0
    buffer_load_dwordx4 v8, s[12:15], s59 offen lds
    s_add_u32 s56, s56, 16384
    s_and_b32 s56, s56, 0xffff
    s_sub_u32 s61, s61, 1
    s_cmp_lg_u32 s61, 0
    s_cbranch_scc1 A_seg1
    s_branch A_l2
A_compute:
    s_and_b32 s6, s3, 1
    s_lshr_b32 s7, s3, 1
    v_and_b32 v251, 63, v0
    s_waitcnt lgkmcnt(0)
    s_getpc_b64 s[70:71]
A_pc:
    s_lshl_b32 s46, s2, 2
    s_add_u32 s46, s46, s3
    s_lshl_b32 s46, s46, 6
    s_min_u32 s46, s46, A_fallback-A_pc
    s_load_dword s69, s[70:71], s46
    s_load_dwordx2 s[8:9], s[0:1], 88
    s_mov_b32 s10, 0x400000
    s_mov_b32 s11, 0x20000
    s_lshl_b32 s46, s4, 1
    s_add_u32 s46, s46, s6
    s_lshl_b32 s47, s5, 1
    s_add_u32 s47, s47, s7
    s_lshl_b32 s22, s6, 8
    s_add_u32 s22, s22, 157696
    s_lshl_b32 s12, s4, 5
    s_add_u32 s12, s12, s47
    s_lshl_b32 s12, s12, 1
    s_add_u32 s12, s12, s6
    s_lshl_b32 s12, s12, 9
    s_add_u32 s12, s12, 4521984
    s_lshl_b32 s13, s5, 5
    s_add_u32 s13, s13, s46
    s_lshl_b32 s13, s13, 2
    s_add_u32 s13, s13, s7
    s_lshl_b32 s13, s13, 12
    s_add_u32 s13, s13, 5242880
    s_add_u32 s14, s13, 8192
    s_mul_i32 s46, s46, 360448
    s_lshl_b32 s47, s47, 10
    s_add_u32 s46, s46, s47
    s_add_u32 s20, s46, 12582912
    s_add_u32 s21, s20, 180224
    s_add_u32 s46, s46, s47
    s_add_u32 s16, s46, 12615680
    s_add_u32 s17, s46, 12705792
    s_add_u32 s18, s46, 12795904
    s_add_u32 s19, s46, 12886016
    s_lshl_b32 s46, s4, 2
    s_add_u32 s46, s46, s3
    s_lshl_b32 s23, s46, 16
    s_lshl_b32 s47, s5, 7
    s_add_u32 s23, s23, s47
    s_mul_i32 s15, s3, 4608
    s_add_u32 s15, s15, 131072
    s_mul_i32 s62, s55, 7
    s_lshr_b32 s62, s62, 1
    s_mul_i32 s63, s55, 2
    s_mul_i32 s60, s46, 180224
    s_add_u32 s60, s60, 12582912
    s_and_b32 s47, s3, 1
    s_cselect_b32 s32, -1, 1
    s_mul_i32 s32, s32, 180224
    s_add_u32 s46, s62, s47
    s_lshl_b32 s56, s46, 11
    s_add_u32 s56, s56, s60
    s_add_u32 s56, s56, 32768
    s_add_u32 s61, s56, s32
    s_and_b32 s46, s46, 1
    s_lshl_b32 s46, s46, 11
    s_add_u32 s46, s46, s60
    s_add_u32 s57, s46, 32768
    s_add_u32 s58, s46, 90112
    s_lshl_b32 s46, s47, 11
    s_add_u32 s60, s60, s46
    s_add_u32 s67, s60, 32768
    s_lshl_b32 s59, s63, 11
    s_add_u32 s59, s59, s60
    s_mov_b32 s66, 0x14
    s_mov_b32 s68, 34603008
    s_mov_b32 s49, 4194304
    s_mov_b32 s40, 0xaaaaaaaa
    s_mov_b32 s42, 0xcccccccc
    s_mov_b32 s41, 0xaaaaaaaa
    s_mov_b32 s43, 0xcccccccc
    v_lshlrev_b32 v244, 4, v251
    s_mov_b32 s51, 0
    s_mov_b32 s53, 8192
    s_mov_b32 s54, -16384
    s_setprio 1
    s_lshl_b32 s46, s6, 13
    v_bfe_u32 v110, v251, 2, 2
    v_bfe_u32 v112, v251, 4, 1
    s_cmp_ge_u32 s5, 14
    s_cbranch_scc1 A_light
    v_lshrrev_b32 v115, 4, v251
    v_and_b32 v116, 15, v251
    v_lshrrev_b32 v114, 1, v116
    v_xor_b32 v114, v114, v115
    v_lshlrev_b32 v114, 4, v114
    v_lshl_add_u32 v114, v116, 7, v114
    v_add_u32 v245, s46, v114
    v_xor_b32 v246, 64, v245
    v_and_b32 v116, 3, v251
    v_lshlrev_b32 v116, 3, v116
    v_lshl_add_u32 v115, v115, 3, v110
    v_lshl_add_u32 v114, v110, 1, v112
    s_lshl_b32 s47, s7, 2
    v_xor_b32 v114, s47, v114
    v_lshl_add_u32 v114, v114, 5, v116
    v_lshl_add_u32 v114, v115, 8, v114
    v_add_u32 v232, 65536, v114
    v_xor_b32 v233, 32, v232
    v_xor_b32 v234, 64, v232
    v_xor_b32 v235, 96, v232
    v_and_b32 v114, 2, v110
    v_or_b32 v114, v114, v112
    s_lshl_b32 s47, s7, 1
    v_xor_b32 v114, s47, v114
    v_lshl_add_u32 v114, v114, 5, v116
    v_lshl_add_u32 v114, v115, 7, v114
    v_add_u32 v250, 131072, v114
    v_xor_b32 v236, 32, v250
    v_and_b32 v243, 15, v251
    s_lshl_b32 s47, s6, 7
    s_add_u32 s47, s47, 158720
    v_lshl_add_u32 v243, v243, 1, s47
    v_mov_b32 v0, 0
    v_mov_b32 v1, 0
    v_mov_b32 v2, 0
    v_mov_b32 v3, 0
    v_mov_b32 v4, 0
    v_mov_b32 v5, 0
    v_mov_b32 v6, 0
    v_mov_b32 v7, 0
    v_mov_b32 v8, 0
    v_mov_b32 v9, 0
    v_mov_b32 v10, 0
    v_mov_b32 v11, 0
    v_mov_b32 v12, 0
    v_mov_b32 v13, 0
    v_mov_b32 v14, 0
    v_mov_b32 v15, 0
    v_mov_b32 v16, 0
    v_mov_b32 v17, 0
    v_mov_b32 v18, 0
    v_mov_b32 v19, 0
    v_mov_b32 v20, 0
    v_mov_b32 v21, 0
    v_mov_b32 v22, 0
    v_mov_b32 v23, 0
    v_mov_b32 v24, 0
    v_mov_b32 v25, 0
    v_mov_b32 v26, 0
    v_mov_b32 v27, 0
    v_mov_b32 v28, 0
    v_mov_b32 v29, 0
    v_mov_b32 v30, 0
    v_mov_b32 v31, 0
    v_mov_b32 v32, 0
    v_mov_b32 v33, 0
    v_mov_b32 v34, 0
    v_mov_b32 v35, 0
    v_mov_b32 v36, 0
    v_mov_b32 v37, 0
    v_mov_b32 v38, 0
    v_mov_b32 v39, 0
    v_mov_b32 v40, 0
    v_mov_b32 v41, 0
    v_mov_b32 v42, 0
    v_mov_b32 v43, 0
    v_mov_b32 v44, 0
    v_mov_b32 v45, 0
    v_mov_b32 v46, 0
    v_mov_b32 v47, 0
    v_mov_b32 v48, 0
    v_mov_b32 v49, 0
    v_mov_b32 v50, 0
    v_mov_b32 v51, 0
    v_mov_b32 v52, 0
    v_mov_b32 v53, 0
    v_mov_b32 v54, 0
    v_mov_b32 v55, 0
    v_mov_b32 v56, 0
    v_mov_b32 v57, 0
    v_mov_b32 v58, 0
    v_mov_b32 v59, 0
    v_mov_b32 v60, 0
    v_mov_b32 v61, 0
    v_mov_b32 v62, 0
    v_mov_b32 v63, 0
    v_mov_b32 v238, 0xc0135761
    v_mov_b32 v239, 0xbdd2d3e8
    v_lshrrev_b32 v252, 4, v251
    v_bfe_u32 v247, v251, 2, 2
    v_and_b32 v253, 3, v251
    v_lshl_add_u32 v247, v247, 4, v253
    v_lshl_add_u32 v247, v252, 2, v247
    v_lshlrev_b32 v247, 3, v247
    s_lshl_b32 s46, s6, 8
    s_add_u32 s46, s46, 155648
    v_lshl_add_u32 v248, v252, 4, s46
    s_lshl_b32 s46, s7, 12
    s_add_u32 s46, s46, 65536
    v_add_u32 v249, s46, v244
    s_waitcnt lgkmcnt(0)
    s_barrier
    ds_read_u16 v240, v243 offset:0
    ds_read_u16 v241, v243 offset:32
    ds_read_u16 v242, v243 offset:64
    ds_read_u16 v243, v243 offset:96
    ds_read_b64_tr_b16 v[128:129], v232 offset:0
    ds_read_b64_tr_b16 v[130:131], v232 offset:1024
    ds_read_b64_tr_b16 v[144:145], v232 offset:8192
    ds_read_b64_tr_b16 v[146:147], v232 offset:9216
    ds_read_b128 v[96:99], v245 offset:0
    ds_read_b128 v[112:115], v246 offset:0
    ds_read_b128 v[100:103], v245 offset:2048
    ds_read_b128 v[116:119], v246 offset:2048
    ds_read_b128 v[104:107], v245 offset:4096
    ds_read_b128 v[120:123], v246 offset:4096
    ds_read_b128 v[108:111], v245 offset:6144
    ds_read_b128 v[124:127], v246 offset:6144
    ds_read_b64_tr_b16 v[132:133], v233 offset:0
    ds_read_b64_tr_b16 v[134:135], v233 offset:1024
    ds_read_b64_tr_b16 v[148:149], v233 offset:8192
    ds_read_b64_tr_b16 v[150:151], v233 offset:9216
    s_mov_b32 s50, 4
    s_branch PG0_go
    .p2align 12
PG0:
    s_setpc_b64 s[72:73]
    s_nop 0
PG0_go:
    .p2align 3
A_p1:
    s_waitcnt lgkmcnt(6)
    v_mfma_f32_16x16x32_bf16 v[0:3], v[96:99], v[128:131], v[0:3]
    ds_read_b64_tr_b16 v[136:137], v234 offset:0
    v_mfma_f32_16x16x32_bf16 v[0:3], v[112:115], v[144:147], v[0:3]
    ds_read_b64_tr_b16 v[138:139], v234 offset:1024
    v_mfma_f32_16x16x32_bf16 v[4:7], v[100:103], v[128:131], v[4:7]
    ds_read_b64_tr_b16 v[152:153], v234 offset:8192
    v_mfma_f32_16x16x32_bf16 v[4:7], v[116:119], v[144:147], v[4:7]
    ds_read_b64_tr_b16 v[154:155], v234 offset:9216
    v_mfma_f32_16x16x32_bf16 v[8:11], v[104:107], v[128:131], v[8:11]
    ds_read_b64_tr_b16 v[140:141], v235 offset:0
    v_mfma_f32_16x16x32_bf16 v[8:11], v[120:123], v[144:147], v[8:11]
    ds_read_b64_tr_b16 v[142:143], v235 offset:1024
    s_waitcnt lgkmcnt(6)
    v_mfma_f32_16x16x32_bf16 v[12:15], v[108:111], v[128:131], v[12:15]
    ds_read_b64_tr_b16 v[156:157], v235 offset:8192
    v_mfma_f32_16x16x32_bf16 v[12:15], v[124:127], v[144:147], v[12:15]
    ds_read_b64_tr_b16 v[158:159], v235 offset:9216
    v_mfma_f32_16x16x32_bf16 v[16:19], v[96:99], v[132:135], v[16:19]
    v_mfma_f32_16x16x32_bf16 v[16:19], v[112:115], v[148:151], v[16:19]
    v_mfma_f32_16x16x32_bf16 v[20:23], v[100:103], v[132:135], v[20:23]
    v_mfma_f32_16x16x32_bf16 v[20:23], v[116:119], v[148:151], v[20:23]
    v_mfma_f32_16x16x32_bf16 v[24:27], v[104:107], v[132:135], v[24:27]
    v_mfma_f32_16x16x32_bf16 v[24:27], v[120:123], v[148:151], v[24:27]
    v_mfma_f32_16x16x32_bf16 v[28:31], v[108:111], v[132:135], v[28:31]
    s_waitcnt lgkmcnt(0)
    v_mfma_f32_16x16x32_bf16 v[28:31], v[124:127], v[148:151], v[28:31]
    s_barrier
    v_mfma_f32_16x16x32_bf16 v[32:35], v[96:99], v[136:139], v[32:35]
    ds_read_b64_tr_b16 v[192:193], v232 offset:16384
    v_mfma_f32_16x16x32_bf16 v[32:35], v[112:115], v[152:155], v[32:35]
    ds_read_b64_tr_b16 v[194:195], v232 offset:17408
    v_mfma_f32_16x16x32_bf16 v[36:39], v[100:103], v[136:139], v[36:39]
    ds_read_b64_tr_b16 v[208:209], v232 offset:24576
    v_mfma_f32_16x16x32_bf16 v[36:39], v[116:119], v[152:155], v[36:39]
    ds_read_b64_tr_b16 v[210:211], v232 offset:25600
    v_mfma_f32_16x16x32_bf16 v[40:43], v[104:107], v[136:139], v[40:43]
    ds_read_b128 v[160:163], v245 offset:16384
    v_mfma_f32_16x16x32_bf16 v[40:43], v[120:123], v[152:155], v[40:43]
    ds_read_b128 v[176:179], v246 offset:16384
    v_mfma_f32_16x16x32_bf16 v[44:47], v[108:111], v[136:139], v[44:47]
    ds_read_b128 v[164:167], v245 offset:18432
    v_mfma_f32_16x16x32_bf16 v[44:47], v[124:127], v[152:155], v[44:47]
    ds_read_b128 v[180:183], v246 offset:18432
    v_mfma_f32_16x16x32_bf16 v[48:51], v[96:99], v[140:143], v[48:51]
    ds_read_b128 v[168:171], v245 offset:20480
    v_mfma_f32_16x16x32_bf16 v[48:51], v[112:115], v[156:159], v[48:51]
    ds_read_b128 v[184:187], v246 offset:20480
    v_mfma_f32_16x16x32_bf16 v[52:55], v[100:103], v[140:143], v[52:55]
    ds_read_b128 v[172:175], v245 offset:22528
    v_mfma_f32_16x16x32_bf16 v[52:55], v[116:119], v[156:159], v[52:55]
    ds_read_b128 v[188:191], v246 offset:22528
    v_mfma_f32_16x16x32_bf16 v[56:59], v[104:107], v[140:143], v[56:59]
    ds_read_b64_tr_b16 v[196:197], v233 offset:16384
    v_mfma_f32_16x16x32_bf16 v[56:59], v[120:123], v[156:159], v[56:59]
    ds_read_b64_tr_b16 v[198:199], v233 offset:17408
    v_mfma_f32_16x16x32_bf16 v[60:63], v[108:111], v[140:143], v[60:63]
    ds_read_b64_tr_b16 v[212:213], v233 offset:24576
    v_mfma_f32_16x16x32_bf16 v[60:63], v[124:127], v[156:159], v[60:63]
    ds_read_b64_tr_b16 v[214:215], v233 offset:25600
    s_waitcnt lgkmcnt(6)
    v_mfma_f32_16x16x32_bf16 v[0:3], v[160:163], v[192:195], v[0:3]
    ds_read_b64_tr_b16 v[200:201], v234 offset:16384
    v_mfma_f32_16x16x32_bf16 v[0:3], v[176:179], v[208:211], v[0:3]
    ds_read_b64_tr_b16 v[202:203], v234 offset:17408
    v_mfma_f32_16x16x32_bf16 v[4:7], v[164:167], v[192:195], v[4:7]
    ds_read_b64_tr_b16 v[216:217], v234 offset:24576
    v_mfma_f32_16x16x32_bf16 v[4:7], v[180:183], v[208:211], v[4:7]
    ds_read_b64_tr_b16 v[218:219], v234 offset:25600
    v_mfma_f32_16x16x32_bf16 v[8:11], v[168:171], v[192:195], v[8:11]
    ds_read_b64_tr_b16 v[204:205], v235 offset:16384
    v_mfma_f32_16x16x32_bf16 v[8:11], v[184:187], v[208:211], v[8:11]
    ds_read_b64_tr_b16 v[206:207], v235 offset:17408
    s_waitcnt lgkmcnt(6)
    v_mfma_f32_16x16x32_bf16 v[12:15], v[172:175], v[192:195], v[12:15]
    ds_read_b64_tr_b16 v[220:221], v235 offset:24576
    v_mfma_f32_16x16x32_bf16 v[12:15], v[188:191], v[208:211], v[12:15]
    ds_read_b64_tr_b16 v[222:223], v235 offset:25600
    v_mfma_f32_16x16x32_bf16 v[16:19], v[160:163], v[196:199], v[16:19]
    v_mfma_f32_16x16x32_bf16 v[16:19], v[176:179], v[212:215], v[16:19]
    v_mfma_f32_16x16x32_bf16 v[20:23], v[164:167], v[196:199], v[20:23]
    v_mfma_f32_16x16x32_bf16 v[20:23], v[180:183], v[212:215], v[20:23]
    v_mfma_f32_16x16x32_bf16 v[24:27], v[168:171], v[196:199], v[24:27]
    v_mfma_f32_16x16x32_bf16 v[24:27], v[184:187], v[212:215], v[24:27]
    v_mfma_f32_16x16x32_bf16 v[28:31], v[172:175], v[196:199], v[28:31]
    s_waitcnt lgkmcnt(0)
    v_mfma_f32_16x16x32_bf16 v[28:31], v[188:191], v[212:215], v[28:31]
    s_barrier
    v_mfma_f32_16x16x32_bf16 v[32:35], v[160:163], v[200:203], v[32:35]
    ds_read_b64_tr_b16 v[128:129], v232 offset:32768
    v_mfma_f32_16x16x32_bf16 v[32:35], v[176:179], v[216:219], v[32:35]
    ds_read_b64_tr_b16 v[130:131], v232 offset:33792
    v_mfma_f32_16x16x32_bf16 v[36:39], v[164:167], v[200:203], v[36:39]
    ds_read_b64_tr_b16 v[144:145], v232 offset:40960
    v_mfma_f32_16x16x32_bf16 v[36:39], v[180:183], v[216:219], v[36:39]
    ds_read_b64_tr_b16 v[146:147], v232 offset:41984
    v_mfma_f32_16x16x32_bf16 v[40:43], v[168:171], v[200:203], v[40:43]
    ds_read_b128 v[96:99], v245 offset:32768
    v_mfma_f32_16x16x32_bf16 v[40:43], v[184:187], v[216:219], v[40:43]
    ds_read_b128 v[112:115], v246 offset:32768
    v_mfma_f32_16x16x32_bf16 v[44:47], v[172:175], v[200:203], v[44:47]
    ds_read_b128 v[100:103], v245 offset:34816
    v_mfma_f32_16x16x32_bf16 v[44:47], v[188:191], v[216:219], v[44:47]
    ds_read_b128 v[116:119], v246 offset:34816
    v_mfma_f32_16x16x32_bf16 v[48:51], v[160:163], v[204:207], v[48:51]
    ds_read_b128 v[104:107], v245 offset:36864
    v_mfma_f32_16x16x32_bf16 v[48:51], v[176:179], v[220:223], v[48:51]
    ds_read_b128 v[120:123], v246 offset:36864
    v_mfma_f32_16x16x32_bf16 v[52:55], v[164:167], v[204:207], v[52:55]
    ds_read_b128 v[108:111], v245 offset:38912
    v_mfma_f32_16x16x32_bf16 v[52:55], v[180:183], v[220:223], v[52:55]
    ds_read_b128 v[124:127], v246 offset:38912
    v_mfma_f32_16x16x32_bf16 v[56:59], v[168:171], v[204:207], v[56:59]
    ds_read_b64_tr_b16 v[132:133], v233 offset:32768
    v_mfma_f32_16x16x32_bf16 v[56:59], v[184:187], v[220:223], v[56:59]
    ds_read_b64_tr_b16 v[134:135], v233 offset:33792
    v_mfma_f32_16x16x32_bf16 v[60:63], v[172:175], v[204:207], v[60:63]
    ds_read_b64_tr_b16 v[148:149], v233 offset:40960
    v_mfma_f32_16x16x32_bf16 v[60:63], v[188:191], v[220:223], v[60:63]
    ds_read_b64_tr_b16 v[150:151], v233 offset:41984
    s_waitcnt lgkmcnt(6)
    v_mfma_f32_16x16x32_bf16 v[0:3], v[96:99], v[128:131], v[0:3]
    ds_read_b64_tr_b16 v[136:137], v234 offset:32768
    v_mfma_f32_16x16x32_bf16 v[0:3], v[112:115], v[144:147], v[0:3]
    ds_read_b64_tr_b16 v[138:139], v234 offset:33792
    v_mfma_f32_16x16x32_bf16 v[4:7], v[100:103], v[128:131], v[4:7]
    ds_read_b64_tr_b16 v[152:153], v234 offset:40960
    v_mfma_f32_16x16x32_bf16 v[4:7], v[116:119], v[144:147], v[4:7]
    ds_read_b64_tr_b16 v[154:155], v234 offset:41984
    v_mfma_f32_16x16x32_bf16 v[8:11], v[104:107], v[128:131], v[8:11]
    ds_read_b64_tr_b16 v[140:141], v235 offset:32768
    v_mfma_f32_16x16x32_bf16 v[8:11], v[120:123], v[144:147], v[8:11]
    ds_read_b64_tr_b16 v[142:143], v235 offset:33792
    s_waitcnt lgkmcnt(6)
    v_mfma_f32_16x16x32_bf16 v[12:15], v[108:111], v[128:131], v[12:15]
    ds_read_b64_tr_b16 v[156:157], v235 offset:40960
    v_mfma_f32_16x16x32_bf16 v[12:15], v[124:127], v[144:147], v[12:15]
    ds_read_b64_tr_b16 v[158:159], v235 offset:41984
    v_mfma_f32_16x16x32_bf16 v[16:19], v[96:99], v[132:135], v[16:19]
    v_mfma_f32_16x16x32_bf16 v[16:19], v[112:115], v[148:151], v[16:19]
    v_mfma_f32_16x16x32_bf16 v[20:23], v[100:103], v[132:135], v[20:23]
    s_sub_u32 s50, s50, 1
    v_mfma_f32_16x16x32_bf16 v[20:23], v[116:119], v[148:151], v[20:23]
    s_cmp_eq_u32 s50, 0
    v_mfma_f32_16x16x32_bf16 v[24:27], v[104:107], v[132:135], v[24:27]
    v_mfma_f32_16x16x32_bf16 v[24:27], v[120:123], v[148:151], v[24:27]
    v_mfma_f32_16x16x32_bf16 v[28:31], v[108:111], v[132:135], v[28:31]
    s_waitcnt lgkmcnt(0)
    v_mfma_f32_16x16x32_bf16 v[28:31], v[124:127], v[148:151], v[28:31]
    s_barrier
    v_mfma_f32_16x16x32_bf16 v[32:35], v[96:99], v[136:139], v[32:35]
    ds_read_b64_tr_b16 v[192:193], v232 offset:49152
    v_mfma_f32_16x16x32_bf16 v[32:35], v[112:115], v[152:155], v[32:35]
    ds_read_b64_tr_b16 v[194:195], v232 offset:50176
    v_mfma_f32_16x16x32_bf16 v[36:39], v[100:103], v[136:139], v[36:39]
    ds_read_b64_tr_b16 v[208:209], v232 offset:57344
    v_mfma_f32_16x16x32_bf16 v[36:39], v[116:119], v[152:155], v[36:39]
    ds_read_b64_tr_b16 v[210:211], v232 offset:58368
    v_mfma_f32_16x16x32_bf16 v[40:43], v[104:107], v[136:139], v[40:43]
    ds_read_b128 v[160:163], v245 offset:49152
    v_mfma_f32_16x16x32_bf16 v[40:43], v[120:123], v[152:155], v[40:43]
    ds_read_b128 v[176:179], v246 offset:49152
    v_mfma_f32_16x16x32_bf16 v[44:47], v[108:111], v[136:139], v[44:47]
    ds_read_b128 v[164:167], v245 offset:51200
    v_mfma_f32_16x16x32_bf16 v[44:47], v[124:127], v[152:155], v[44:47]
    ds_read_b128 v[180:183], v246 offset:51200
    v_mfma_f32_16x16x32_bf16 v[48:51], v[96:99], v[140:143], v[48:51]
    ds_read_b128 v[168:171], v245 offset:53248
    v_mfma_f32_16x16x32_bf16 v[48:51], v[112:115], v[156:159], v[48:51]
    ds_read_b128 v[184:187], v246 offset:53248
    v_mfma_f32_16x16x32_bf16 v[52:55], v[100:103], v[140:143], v[52:55]
    ds_read_b128 v[172:175], v245 offset:55296
    v_mfma_f32_16x16x32_bf16 v[52:55], v[116:119], v[156:159], v[52:55]
    ds_read_b128 v[188:191], v246 offset:55296
    v_mfma_f32_16x16x32_bf16 v[56:59], v[104:107], v[140:143], v[56:59]
    ds_read_b64_tr_b16 v[196:197], v233 offset:49152
    v_mfma_f32_16x16x32_bf16 v[56:59], v[120:123], v[156:159], v[56:59]
    ds_read_b64_tr_b16 v[198:199], v233 offset:50176
    v_mfma_f32_16x16x32_bf16 v[60:63], v[108:111], v[140:143], v[60:63]
    ds_read_b64_tr_b16 v[212:213], v233 offset:57344
    v_mfma_f32_16x16x32_bf16 v[60:63], v[124:127], v[156:159], v[60:63]
    ds_read_b64_tr_b16 v[214:215], v233 offset:58368
    s_cbranch_scc1 A_p1_end
    s_waitcnt lgkmcnt(6)
    v_mfma_f32_16x16x32_bf16 v[0:3], v[160:163], v[192:195], v[0:3]
    ds_read_b64_tr_b16 v[200:201], v234 offset:49152
    v_mfma_f32_16x16x32_bf16 v[0:3], v[176:179], v[208:211], v[0:3]
    ds_read_b64_tr_b16 v[202:203], v234 offset:50176
    v_mfma_f32_16x16x32_bf16 v[4:7], v[164:167], v[192:195], v[4:7]
    ds_read_b64_tr_b16 v[216:217], v234 offset:57344
    v_mfma_f32_16x16x32_bf16 v[4:7], v[180:183], v[208:211], v[4:7]
    ds_read_b64_tr_b16 v[218:219], v234 offset:58368
    v_mfma_f32_16x16x32_bf16 v[8:11], v[168:171], v[192:195], v[8:11]
    ds_read_b64_tr_b16 v[204:205], v235 offset:49152
    v_mfma_f32_16x16x32_bf16 v[8:11], v[184:187], v[208:211], v[8:11]
    ds_read_b64_tr_b16 v[206:207], v235 offset:50176
    s_waitcnt lgkmcnt(6)
    v_mfma_f32_16x16x32_bf16 v[12:15], v[172:175], v[192:195], v[12:15]
    ds_read_b64_tr_b16 v[220:221], v235 offset:57344
    v_mfma_f32_16x16x32_bf16 v[12:15], v[188:191], v[208:211], v[12:15]
    ds_read_b64_tr_b16 v[222:223], v235 offset:58368
    v_mfma_f32_16x16x32_bf16 v[16:19], v[160:163], v[196:199], v[16:19]
    v_mfma_f32_16x16x32_bf16 v[16:19], v[176:179], v[212:215], v[16:19]
    v_mfma_f32_16x16x32_bf16 v[20:23], v[164:167], v[196:199], v[20:23]
    v_mfma_f32_16x16x32_bf16 v[20:23], v[180:183], v[212:215], v[20:23]
    v_mfma_f32_16x16x32_bf16 v[24:27], v[168:171], v[196:199], v[24:27]
    v_mfma_f32_16x16x32_bf16 v[24:27], v[184:187], v[212:215], v[24:27]
    v_mfma_f32_16x16x32_bf16 v[28:31], v[172:175], v[196:199], v[28:31]
    s_waitcnt lgkmcnt(0)
    v_mfma_f32_16x16x32_bf16 v[28:31], v[188:191], v[212:215], v[28:31]
    s_barrier
    v_mfma_f32_16x16x32_bf16 v[32:35], v[160:163], v[200:203], v[32:35]
    ds_read_b64_tr_b16 v[128:129], v232 offset:0
    v_mfma_f32_16x16x32_bf16 v[32:35], v[176:179], v[216:219], v[32:35]
    ds_read_b64_tr_b16 v[130:131], v232 offset:1024
    v_mfma_f32_16x16x32_bf16 v[36:39], v[164:167], v[200:203], v[36:39]
    ds_read_b64_tr_b16 v[144:145], v232 offset:8192
    v_mfma_f32_16x16x32_bf16 v[36:39], v[180:183], v[216:219], v[36:39]
    ds_read_b64_tr_b16 v[146:147], v232 offset:9216
    v_mfma_f32_16x16x32_bf16 v[40:43], v[168:171], v[200:203], v[40:43]
    ds_read_b128 v[96:99], v245 offset:0
    v_mfma_f32_16x16x32_bf16 v[40:43], v[184:187], v[216:219], v[40:43]
    ds_read_b128 v[112:115], v246 offset:0
    v_mfma_f32_16x16x32_bf16 v[44:47], v[172:175], v[200:203], v[44:47]
    ds_read_b128 v[100:103], v245 offset:2048
    v_mfma_f32_16x16x32_bf16 v[44:47], v[188:191], v[216:219], v[44:47]
    ds_read_b128 v[116:119], v246 offset:2048
    v_mfma_f32_16x16x32_bf16 v[48:51], v[160:163], v[204:207], v[48:51]
    ds_read_b128 v[104:107], v245 offset:4096
    v_mfma_f32_16x16x32_bf16 v[48:51], v[176:179], v[220:223], v[48:51]
    ds_read_b128 v[120:123], v246 offset:4096
    v_mfma_f32_16x16x32_bf16 v[52:55], v[164:167], v[204:207], v[52:55]
    ds_read_b128 v[108:111], v245 offset:6144
    v_mfma_f32_16x16x32_bf16 v[52:55], v[180:183], v[220:223], v[52:55]
    ds_read_b128 v[124:127], v246 offset:6144
    v_mfma_f32_16x16x32_bf16 v[56:59], v[168:171], v[204:207], v[56:59]
    ds_read_b64_tr_b16 v[132:133], v233 offset:0
    v_mfma_f32_16x16x32_bf16 v[56:59], v[184:187], v[220:223], v[56:59]
    ds_read_b64_tr_b16 v[134:135], v233 offset:1024
    v_mfma_f32_16x16x32_bf16 v[60:63], v[172:175], v[204:207], v[60:63]
    ds_read_b64_tr_b16 v[148:149], v233 offset:8192
    v_mfma_f32_16x16x32_bf16 v[60:63], v[188:191], v[220:223], v[60:63]
    ds_read_b64_tr_b16 v[150:151], v233 offset:9216
    s_branch A_p1
A_p1_end:
    s_waitcnt lgkmcnt(6)
    v_mfma_f32_16x16x32_bf16 v[0:3], v[160:163], v[192:195], v[0:3]
    ds_read_b64_tr_b16 v[200:201], v234 offset:49152
    v_mfma_f32_16x16x32_bf16 v[0:3], v[176:179], v[208:211], v[0:3]
    ds_read_b64_tr_b16 v[202:203], v234 offset:50176
    v_mfma_f32_16x16x32_bf16 v[4:7], v[164:167], v[192:195], v[4:7]
    ds_read_b64_tr_b16 v[216:217], v234 offset:57344
    v_mfma_f32_16x16x32_bf16 v[4:7], v[180:183], v[208:211], v[4:7]
    ds_read_b64_tr_b16 v[218:219], v234 offset:58368
    v_mfma_f32_16x16x32_bf16 v[8:11], v[168:171], v[192:195], v[8:11]
    ds_read_b64_tr_b16 v[204:205], v235 offset:49152
    v_mfma_f32_16x16x32_bf16 v[8:11], v[184:187], v[208:211], v[8:11]
    ds_read_b64_tr_b16 v[206:207], v235 offset:50176
    s_waitcnt lgkmcnt(6)
    v_mfma_f32_16x16x32_bf16 v[12:15], v[172:175], v[192:195], v[12:15]
    ds_read_b64_tr_b16 v[220:221], v235 offset:57344
    v_mfma_f32_16x16x32_bf16 v[12:15], v[188:191], v[208:211], v[12:15]
    ds_read_b64_tr_b16 v[222:223], v235 offset:58368
    v_mfma_f32_16x16x32_bf16 v[16:19], v[160:163], v[196:199], v[16:19]
    v_mfma_f32_16x16x32_bf16 v[16:19], v[176:179], v[212:215], v[16:19]
    v_mfma_f32_16x16x32_bf16 v[20:23], v[164:167], v[196:199], v[20:23]
    v_mfma_f32_16x16x32_bf16 v[20:23], v[180:183], v[212:215], v[20:23]
    v_mfma_f32_16x16x32_bf16 v[24:27], v[168:171], v[196:199], v[24:27]
    v_mfma_f32_16x16x32_bf16 v[24:27], v[184:187], v[212:215], v[24:27]
    v_mfma_f32_16x16x32_bf16 v[28:31], v[172:175], v[196:199], v[28:31]
    v_mfma_f32_16x16x32_bf16 v[28:31], v[188:191], v[212:215], v[28:31]
    s_waitcnt lgkmcnt(0)
    v_mfma_f32_16x16x32_bf16 v[32:35], v[160:163], v[200:203], v[32:35]
    v_mfma_f32_16x16x32_bf16 v[32:35], v[176:179], v[216:219], v[32:35]
    v_mfma_f32_16x16x32_bf16 v[36:39], v[164:167], v[200:203], v[36:39]
    v_mfma_f32_16x16x32_bf16 v[36:39], v[180:183], v[216:219], v[36:39]
    v_mfma_f32_16x16x32_bf16 v[40:43], v[168:171], v[200:203], v[40:43]
    v_mfma_f32_16x16x32_bf16 v[40:43], v[184:187], v[216:219], v[40:43]
    v_mfma_f32_16x16x32_bf16 v[44:47], v[172:175], v[200:203], v[44:47]
    v_mfma_f32_16x16x32_bf16 v[44:47], v[188:191], v[216:219], v[44:47]
    v_mfma_f32_16x16x32_bf16 v[48:51], v[160:163], v[204:207], v[48:51]
    v_mfma_f32_16x16x32_bf16 v[48:51], v[176:179], v[220:223], v[48:51]
    v_mfma_f32_16x16x32_bf16 v[52:55], v[164:167], v[204:207], v[52:55]
    v_mfma_f32_16x16x32_bf16 v[52:55], v[180:183], v[220:223], v[52:55]
    v_mfma_f32_16x16x32_bf16 v[56:59], v[168:171], v[204:207], v[56:59]
    v_mfma_f32_16x16x32_bf16 v[56:59], v[184:187], v[220:223], v[56:59]
    v_mfma_f32_16x16x32_bf16 v[60:63], v[172:175], v[204:207], v[60:63]
    v_mfma_f32_16x16x32_bf16 v[60:63], v[188:191], v[220:223], v[60:63]
    .p2align 3
    v_pk_mul_f32 v[96:97], v[0:1], v[0:1]
    v_pk_mul_f32 v[98:99], v[2:3], v[2:3]
    v_pk_mul_f32 v[100:101], v[4:5], v[4:5]
    v_pk_mul_f32 v[102:103], v[6:7], v[6:7]
    v_pk_fma_f32 v[96:97], v[96:97], v[238:239], v[238:239] op_sel:[0,1,0] op_sel_hi:[1,1,0]
    v_pk_fma_f32 v[98:99], v[98:99], v[238:239], v[238:239] op_sel:[0,1,0] op_sel_hi:[1,1,0]
    v_pk_fma_f32 v[100:101], v[100:101], v[238:239], v[238:239] op_sel:[0,1,0] op_sel_hi:[1,1,0]
    v_pk_fma_f32 v[102:103], v[102:103], v[238:239], v[238:239] op_sel:[0,1,0] op_sel_hi:[1,1,0]
    v_pk_mul_f32 v[96:97], v[96:97], v[0:1]
    v_pk_mul_f32 v[98:99], v[98:99], v[2:3]
    v_pk_mul_f32 v[100:101], v[100:101], v[4:5]
    v_pk_mul_f32 v[102:103], v[102:103], v[6:7]
    v_exp_f32 v96, v96
    v_exp_f32 v97, v97
    v_exp_f32 v98, v98
    v_exp_f32 v99, v99
    v_exp_f32 v100, v100
    v_exp_f32 v101, v101
    v_exp_f32 v102, v102
    v_exp_f32 v103, v103
    v_pk_add_f32 v[96:97], v[96:97], 1.0 op_sel_hi:[1,0]
    v_pk_add_f32 v[98:99], v[98:99], 1.0 op_sel_hi:[1,0]
    v_pk_add_f32 v[100:101], v[100:101], 1.0 op_sel_hi:[1,0]
    v_pk_add_f32 v[102:103], v[102:103], 1.0 op_sel_hi:[1,0]
    v_rcp_f32 v96, v96
    v_rcp_f32 v97, v97
    v_rcp_f32 v98, v98
    v_rcp_f32 v99, v99
    v_rcp_f32 v100, v100
    v_rcp_f32 v101, v101
    v_rcp_f32 v102, v102
    v_rcp_f32 v103, v103
    v_pk_mul_f32 v[0:1], v[0:1], v[96:97]
    v_pk_mul_f32 v[2:3], v[2:3], v[98:99]
    v_pk_mul_f32 v[4:5], v[4:5], v[100:101]
    v_pk_mul_f32 v[6:7], v[6:7], v[102:103]
    v_pk_mul_f32 v[96:97], v[8:9], v[8:9]
    v_pk_mul_f32 v[98:99], v[10:11], v[10:11]
    v_pk_mul_f32 v[100:101], v[12:13], v[12:13]
    v_pk_mul_f32 v[102:103], v[14:15], v[14:15]
    v_pk_fma_f32 v[96:97], v[96:97], v[238:239], v[238:239] op_sel:[0,1,0] op_sel_hi:[1,1,0]
    v_pk_fma_f32 v[98:99], v[98:99], v[238:239], v[238:239] op_sel:[0,1,0] op_sel_hi:[1,1,0]
    v_pk_fma_f32 v[100:101], v[100:101], v[238:239], v[238:239] op_sel:[0,1,0] op_sel_hi:[1,1,0]
    v_pk_fma_f32 v[102:103], v[102:103], v[238:239], v[238:239] op_sel:[0,1,0] op_sel_hi:[1,1,0]
    v_pk_mul_f32 v[96:97], v[96:97], v[8:9]
    v_pk_mul_f32 v[98:99], v[98:99], v[10:11]
    v_pk_mul_f32 v[100:101], v[100:101], v[12:13]
    v_pk_mul_f32 v[102:103], v[102:103], v[14:15]
    v_exp_f32 v96, v96
    v_exp_f32 v97, v97
    v_exp_f32 v98, v98
    v_exp_f32 v99, v99
    v_exp_f32 v100, v100
    v_exp_f32 v101, v101
    v_exp_f32 v102, v102
    v_exp_f32 v103, v103
    v_pk_add_f32 v[96:97], v[96:97], 1.0 op_sel_hi:[1,0]
    v_pk_add_f32 v[98:99], v[98:99], 1.0 op_sel_hi:[1,0]
    v_pk_add_f32 v[100:101], v[100:101], 1.0 op_sel_hi:[1,0]
    v_pk_add_f32 v[102:103], v[102:103], 1.0 op_sel_hi:[1,0]
    v_rcp_f32 v96, v96
    v_rcp_f32 v97, v97
    v_rcp_f32 v98, v98
    v_rcp_f32 v99, v99
    v_rcp_f32 v100, v100
    v_rcp_f32 v101, v101
    v_rcp_f32 v102, v102
    v_rcp_f32 v103, v103
    v_pk_mul_f32 v[8:9], v[8:9], v[96:97]
    v_pk_mul_f32 v[10:11], v[10:11], v[98:99]
    v_pk_mul_f32 v[12:13], v[12:13], v[100:101]
    v_pk_mul_f32 v[14:15], v[14:15], v[102:103]
    v_pk_mul_f32 v[96:97], v[16:17], v[16:17]
    v_pk_mul_f32 v[98:99], v[18:19], v[18:19]
    v_pk_mul_f32 v[100:101], v[20:21], v[20:21]
    v_pk_mul_f32 v[102:103], v[22:23], v[22:23]
    v_pk_fma_f32 v[96:97], v[96:97], v[238:239], v[238:239] op_sel:[0,1,0] op_sel_hi:[1,1,0]
    v_pk_fma_f32 v[98:99], v[98:99], v[238:239], v[238:239] op_sel:[0,1,0] op_sel_hi:[1,1,0]
    v_pk_fma_f32 v[100:101], v[100:101], v[238:239], v[238:239] op_sel:[0,1,0] op_sel_hi:[1,1,0]
    v_pk_fma_f32 v[102:103], v[102:103], v[238:239], v[238:239] op_sel:[0,1,0] op_sel_hi:[1,1,0]
    v_pk_mul_f32 v[96:97], v[96:97], v[16:17]
    v_pk_mul_f32 v[98:99], v[98:99], v[18:19]
    v_pk_mul_f32 v[100:101], v[100:101], v[20:21]
    v_pk_mul_f32 v[102:103], v[102:103], v[22:23]
    v_exp_f32 v96, v96
    v_exp_f32 v97, v97
    v_exp_f32 v98, v98
    v_exp_f32 v99, v99
    v_exp_f32 v100, v100
    v_exp_f32 v101, v101
    v_exp_f32 v102, v102
    v_exp_f32 v103, v103
    v_pk_add_f32 v[96:97], v[96:97], 1.0 op_sel_hi:[1,0]
    v_pk_add_f32 v[98:99], v[98:99], 1.0 op_sel_hi:[1,0]
    v_pk_add_f32 v[100:101], v[100:101], 1.0 op_sel_hi:[1,0]
    v_pk_add_f32 v[102:103], v[102:103], 1.0 op_sel_hi:[1,0]
    v_rcp_f32 v96, v96
    v_rcp_f32 v97, v97
    v_rcp_f32 v98, v98
    v_rcp_f32 v99, v99
    v_rcp_f32 v100, v100
    v_rcp_f32 v101, v101
    v_rcp_f32 v102, v102
    v_rcp_f32 v103, v103
    v_pk_mul_f32 v[16:17], v[16:17], v[96:97]
    v_pk_mul_f32 v[18:19], v[18:19], v[98:99]
    v_pk_mul_f32 v[20:21], v[20:21], v[100:101]
    v_pk_mul_f32 v[22:23], v[22:23], v[102:103]
    v_pk_mul_f32 v[96:97], v[24:25], v[24:25]
    v_pk_mul_f32 v[98:99], v[26:27], v[26:27]
    v_pk_mul_f32 v[100:101], v[28:29], v[28:29]
    v_pk_mul_f32 v[102:103], v[30:31], v[30:31]
    v_pk_fma_f32 v[96:97], v[96:97], v[238:239], v[238:239] op_sel:[0,1,0] op_sel_hi:[1,1,0]
    v_pk_fma_f32 v[98:99], v[98:99], v[238:239], v[238:239] op_sel:[0,1,0] op_sel_hi:[1,1,0]
    v_pk_fma_f32 v[100:101], v[100:101], v[238:239], v[238:239] op_sel:[0,1,0] op_sel_hi:[1,1,0]
    v_pk_fma_f32 v[102:103], v[102:103], v[238:239], v[238:239] op_sel:[0,1,0] op_sel_hi:[1,1,0]
    v_pk_mul_f32 v[96:97], v[96:97], v[24:25]
    v_pk_mul_f32 v[98:99], v[98:99], v[26:27]
    v_pk_mul_f32 v[100:101], v[100:101], v[28:29]
    v_pk_mul_f32 v[102:103], v[102:103], v[30:31]
    v_exp_f32 v96, v96
    v_exp_f32 v97, v97
    v_exp_f32 v98, v98
    v_exp_f32 v99, v99
    v_exp_f32 v100, v100
    v_exp_f32 v101, v101
    v_exp_f32 v102, v102
    v_exp_f32 v103, v103
    v_pk_add_f32 v[96:97], v[96:97], 1.0 op_sel_hi:[1,0]
    v_pk_add_f32 v[98:99], v[98:99], 1.0 op_sel_hi:[1,0]
    v_pk_add_f32 v[100:101], v[100:101], 1.0 op_sel_hi:[1,0]
    v_pk_add_f32 v[102:103], v[102:103], 1.0 op_sel_hi:[1,0]
    v_rcp_f32 v96, v96
    v_rcp_f32 v97, v97
    v_rcp_f32 v98, v98
    v_rcp_f32 v99, v99
    v_rcp_f32 v100, v100
    v_rcp_f32 v101, v101
    v_rcp_f32 v102, v102
    v_rcp_f32 v103, v103
    v_pk_mul_f32 v[24:25], v[24:25], v[96:97]
    v_pk_mul_f32 v[26:27], v[26:27], v[98:99]
    v_pk_mul_f32 v[28:29], v[28:29], v[100:101]
    v_pk_mul_f32 v[30:31], v[30:31], v[102:103]
    v_pk_mul_f32 v[96:97], v[32:33], v[32:33]
    v_pk_mul_f32 v[98:99], v[34:35], v[34:35]
    v_pk_mul_f32 v[100:101], v[36:37], v[36:37]
    v_pk_mul_f32 v[102:103], v[38:39], v[38:39]
    v_pk_fma_f32 v[96:97], v[96:97], v[238:239], v[238:239] op_sel:[0,1,0] op_sel_hi:[1,1,0]
    v_pk_fma_f32 v[98:99], v[98:99], v[238:239], v[238:239] op_sel:[0,1,0] op_sel_hi:[1,1,0]
    v_pk_fma_f32 v[100:101], v[100:101], v[238:239], v[238:239] op_sel:[0,1,0] op_sel_hi:[1,1,0]
    v_pk_fma_f32 v[102:103], v[102:103], v[238:239], v[238:239] op_sel:[0,1,0] op_sel_hi:[1,1,0]
    v_pk_mul_f32 v[96:97], v[96:97], v[32:33]
    v_pk_mul_f32 v[98:99], v[98:99], v[34:35]
    v_pk_mul_f32 v[100:101], v[100:101], v[36:37]
    v_pk_mul_f32 v[102:103], v[102:103], v[38:39]
    v_exp_f32 v96, v96
    v_exp_f32 v97, v97
    v_exp_f32 v98, v98
    v_exp_f32 v99, v99
    v_exp_f32 v100, v100
    v_exp_f32 v101, v101
    v_exp_f32 v102, v102
    v_exp_f32 v103, v103
    v_pk_add_f32 v[96:97], v[96:97], 1.0 op_sel_hi:[1,0]
    v_pk_add_f32 v[98:99], v[98:99], 1.0 op_sel_hi:[1,0]
    v_pk_add_f32 v[100:101], v[100:101], 1.0 op_sel_hi:[1,0]
    v_pk_add_f32 v[102:103], v[102:103], 1.0 op_sel_hi:[1,0]
    v_rcp_f32 v96, v96
    v_rcp_f32 v97, v97
    v_rcp_f32 v98, v98
    v_rcp_f32 v99, v99
    v_rcp_f32 v100, v100
    v_rcp_f32 v101, v101
    v_rcp_f32 v102, v102
    v_rcp_f32 v103, v103
    v_pk_mul_f32 v[32:33], v[32:33], v[96:97]
    v_pk_mul_f32 v[34:35], v[34:35], v[98:99]
    v_pk_mul_f32 v[36:37], v[36:37], v[100:101]
    v_pk_mul_f32 v[38:39], v[38:39], v[102:103]
    v_pk_mul_f32 v[96:97], v[40:41], v[40:41]
    v_pk_mul_f32 v[98:99], v[42:43], v[42:43]
    v_pk_mul_f32 v[100:101], v[44:45], v[44:45]
    v_pk_mul_f32 v[102:103], v[46:47], v[46:47]
    v_pk_fma_f32 v[96:97], v[96:97], v[238:239], v[238:239] op_sel:[0,1,0] op_sel_hi:[1,1,0]
    v_pk_fma_f32 v[98:99], v[98:99], v[238:239], v[238:239] op_sel:[0,1,0] op_sel_hi:[1,1,0]
    v_pk_fma_f32 v[100:101], v[100:101], v[238:239], v[238:239] op_sel:[0,1,0] op_sel_hi:[1,1,0]
    v_pk_fma_f32 v[102:103], v[102:103], v[238:239], v[238:239] op_sel:[0,1,0] op_sel_hi:[1,1,0]
    v_pk_mul_f32 v[96:97], v[96:97], v[40:41]
    v_pk_mul_f32 v[98:99], v[98:99], v[42:43]
    v_pk_mul_f32 v[100:101], v[100:101], v[44:45]
    v_pk_mul_f32 v[102:103], v[102:103], v[46:47]
    v_exp_f32 v96, v96
    v_exp_f32 v97, v97
    v_exp_f32 v98, v98
    v_exp_f32 v99, v99
    v_exp_f32 v100, v100
    v_exp_f32 v101, v101
    v_exp_f32 v102, v102
    v_exp_f32 v103, v103
    v_pk_add_f32 v[96:97], v[96:97], 1.0 op_sel_hi:[1,0]
    v_pk_add_f32 v[98:99], v[98:99], 1.0 op_sel_hi:[1,0]
    v_pk_add_f32 v[100:101], v[100:101], 1.0 op_sel_hi:[1,0]
    v_pk_add_f32 v[102:103], v[102:103], 1.0 op_sel_hi:[1,0]
    v_rcp_f32 v96, v96
    v_rcp_f32 v97, v97
    v_rcp_f32 v98, v98
    v_rcp_f32 v99, v99
    v_rcp_f32 v100, v100
    v_rcp_f32 v101, v101
    v_rcp_f32 v102, v102
    v_rcp_f32 v103, v103
    v_pk_mul_f32 v[40:41], v[40:41], v[96:97]
    v_pk_mul_f32 v[42:43], v[42:43], v[98:99]
    v_pk_mul_f32 v[44:45], v[44:45], v[100:101]
    v_pk_mul_f32 v[46:47], v[46:47], v[102:103]
    v_pk_mul_f32 v[96:97], v[48:49], v[48:49]
    v_pk_mul_f32 v[98:99], v[50:51], v[50:51]
    v_pk_mul_f32 v[100:101], v[52:53], v[52:53]
    v_pk_mul_f32 v[102:103], v[54:55], v[54:55]
    v_pk_fma_f32 v[96:97], v[96:97], v[238:239], v[238:239] op_sel:[0,1,0] op_sel_hi:[1,1,0]
    v_pk_fma_f32 v[98:99], v[98:99], v[238:239], v[238:239] op_sel:[0,1,0] op_sel_hi:[1,1,0]
    v_pk_fma_f32 v[100:101], v[100:101], v[238:239], v[238:239] op_sel:[0,1,0] op_sel_hi:[1,1,0]
    v_pk_fma_f32 v[102:103], v[102:103], v[238:239], v[238:239] op_sel:[0,1,0] op_sel_hi:[1,1,0]
    v_pk_mul_f32 v[96:97], v[96:97], v[48:49]
    v_pk_mul_f32 v[98:99], v[98:99], v[50:51]
    v_pk_mul_f32 v[100:101], v[100:101], v[52:53]
    v_pk_mul_f32 v[102:103], v[102:103], v[54:55]
    v_exp_f32 v96, v96
    v_exp_f32 v97, v97
    v_exp_f32 v98, v98
    v_exp_f32 v99, v99
    v_exp_f32 v100, v100
    v_exp_f32 v101, v101
    v_exp_f32 v102, v102
    v_exp_f32 v103, v103
    v_pk_add_f32 v[96:97], v[96:97], 1.0 op_sel_hi:[1,0]
    v_pk_add_f32 v[98:99], v[98:99], 1.0 op_sel_hi:[1,0]
    v_pk_add_f32 v[100:101], v[100:101], 1.0 op_sel_hi:[1,0]
    v_pk_add_f32 v[102:103], v[102:103], 1.0 op_sel_hi:[1,0]
    v_rcp_f32 v96, v96
    v_rcp_f32 v97, v97
    v_rcp_f32 v98, v98
    v_rcp_f32 v99, v99
    v_rcp_f32 v100, v100
    v_rcp_f32 v101, v101
    v_rcp_f32 v102, v102
    v_rcp_f32 v103, v103
    v_pk_mul_f32 v[48:49], v[48:49], v[96:97]
    v_pk_mul_f32 v[50:51], v[50:51], v[98:99]
    v_pk_mul_f32 v[52:53], v[52:53], v[100:101]
    v_pk_mul_f32 v[54:55], v[54:55], v[102:103]
    v_pk_mul_f32 v[96:97], v[56:57], v[56:57]
    v_pk_mul_f32 v[98:99], v[58:59], v[58:59]
    v_pk_mul_f32 v[100:101], v[60:61], v[60:61]
    v_pk_mul_f32 v[102:103], v[62:63], v[62:63]
    v_pk_fma_f32 v[96:97], v[96:97], v[238:239], v[238:239] op_sel:[0,1,0] op_sel_hi:[1,1,0]
    v_pk_fma_f32 v[98:99], v[98:99], v[238:239], v[238:239] op_sel:[0,1,0] op_sel_hi:[1,1,0]
    v_pk_fma_f32 v[100:101], v[100:101], v[238:239], v[238:239] op_sel:[0,1,0] op_sel_hi:[1,1,0]
    v_pk_fma_f32 v[102:103], v[102:103], v[238:239], v[238:239] op_sel:[0,1,0] op_sel_hi:[1,1,0]
    v_pk_mul_f32 v[96:97], v[96:97], v[56:57]
    v_pk_mul_f32 v[98:99], v[98:99], v[58:59]
    v_pk_mul_f32 v[100:101], v[100:101], v[60:61]
    v_pk_mul_f32 v[102:103], v[102:103], v[62:63]
    v_exp_f32 v96, v96
    v_exp_f32 v97, v97
    v_exp_f32 v98, v98
    v_exp_f32 v99, v99
    v_exp_f32 v100, v100
    v_exp_f32 v101, v101
    v_exp_f32 v102, v102
    v_exp_f32 v103, v103
    v_pk_add_f32 v[96:97], v[96:97], 1.0 op_sel_hi:[1,0]
    v_pk_add_f32 v[98:99], v[98:99], 1.0 op_sel_hi:[1,0]
    v_pk_add_f32 v[100:101], v[100:101], 1.0 op_sel_hi:[1,0]
    v_pk_add_f32 v[102:103], v[102:103], 1.0 op_sel_hi:[1,0]
    v_rcp_f32 v96, v96
    v_rcp_f32 v97, v97
    v_rcp_f32 v98, v98
    v_rcp_f32 v99, v99
    v_rcp_f32 v100, v100
    v_rcp_f32 v101, v101
    v_rcp_f32 v102, v102
    v_rcp_f32 v103, v103
    v_pk_mul_f32 v[56:57], v[56:57], v[96:97]
    v_pk_mul_f32 v[58:59], v[58:59], v[98:99]
    v_pk_mul_f32 v[60:61], v[60:61], v[100:101]
    v_pk_mul_f32 v[62:63], v[62:63], v[102:103]
    s_barrier
    ds_read_b64_tr_b16 v[192:193], v232 offset:0
    ds_read_b64_tr_b16 v[194:195], v232 offset:1024
    ds_read_b64_tr_b16 v[196:197], v232 offset:8192
    ds_read_b64_tr_b16 v[198:199], v232 offset:9216
    ds_read_b128 v[160:163], v245 offset:0
    ds_read_b128 v[164:167], v246 offset:0
    ds_read_b128 v[168:171], v245 offset:2048
    ds_read_b128 v[172:175], v246 offset:2048
    ds_read_b128 v[176:179], v245 offset:4096
    ds_read_b128 v[180:183], v246 offset:4096
    s_branch PG1_go
    .p2align 12
PG1:
    s_setpc_b64 s[72:73]
    s_nop 0
PG1_go:
    ds_read_b128 v[184:187], v245 offset:6144
    ds_read_b128 v[188:191], v246 offset:6144
    .p2align 3
    v_pk_add_f32 v[64:65], v[0:1], v[16:17]
    v_pk_mul_f32 v[80:81], v[0:1], v[0:1]
    v_pk_add_f32 v[66:67], v[2:3], v[18:19]
    v_pk_mul_f32 v[82:83], v[2:3], v[2:3]
    v_pk_add_f32 v[68:69], v[4:5], v[20:21]
    v_pk_mul_f32 v[84:85], v[4:5], v[4:5]
    v_pk_add_f32 v[70:71], v[6:7], v[22:23]
    v_pk_mul_f32 v[86:87], v[6:7], v[6:7]
    v_pk_add_f32 v[72:73], v[8:9], v[24:25]
    v_pk_mul_f32 v[88:89], v[8:9], v[8:9]
    v_pk_add_f32 v[74:75], v[10:11], v[26:27]
    v_pk_mul_f32 v[90:91], v[10:11], v[10:11]
    v_pk_add_f32 v[76:77], v[12:13], v[28:29]
    v_pk_mul_f32 v[92:93], v[12:13], v[12:13]
    v_pk_add_f32 v[78:79], v[14:15], v[30:31]
    v_pk_mul_f32 v[94:95], v[14:15], v[14:15]
    v_pk_fma_f32 v[80:81], v[16:17], v[16:17], v[80:81]
    v_pk_fma_f32 v[82:83], v[18:19], v[18:19], v[82:83]
    v_pk_fma_f32 v[84:85], v[20:21], v[20:21], v[84:85]
    v_pk_fma_f32 v[86:87], v[22:23], v[22:23], v[86:87]
    v_pk_fma_f32 v[88:89], v[24:25], v[24:25], v[88:89]
    v_pk_fma_f32 v[90:91], v[26:27], v[26:27], v[90:91]
    v_pk_fma_f32 v[92:93], v[28:29], v[28:29], v[92:93]
    v_pk_fma_f32 v[94:95], v[30:31], v[30:31], v[94:95]
    v_pk_add_f32 v[64:65], v[64:65], v[32:33]
    v_pk_fma_f32 v[80:81], v[32:33], v[32:33], v[80:81]
    v_pk_add_f32 v[66:67], v[66:67], v[34:35]
    v_pk_fma_f32 v[82:83], v[34:35], v[34:35], v[82:83]
    v_pk_add_f32 v[68:69], v[68:69], v[36:37]
    v_pk_fma_f32 v[84:85], v[36:37], v[36:37], v[84:85]
    v_pk_add_f32 v[70:71], v[70:71], v[38:39]
    v_pk_fma_f32 v[86:87], v[38:39], v[38:39], v[86:87]
    v_pk_add_f32 v[72:73], v[72:73], v[40:41]
    v_pk_fma_f32 v[88:89], v[40:41], v[40:41], v[88:89]
    v_pk_add_f32 v[74:75], v[74:75], v[42:43]
    v_pk_fma_f32 v[90:91], v[42:43], v[42:43], v[90:91]
    v_pk_add_f32 v[76:77], v[76:77], v[44:45]
    v_pk_fma_f32 v[92:93], v[44:45], v[44:45], v[92:93]
    v_pk_add_f32 v[78:79], v[78:79], v[46:47]
    v_pk_fma_f32 v[94:95], v[46:47], v[46:47], v[94:95]
    v_pk_add_f32 v[64:65], v[64:65], v[48:49]
    v_pk_fma_f32 v[80:81], v[48:49], v[48:49], v[80:81]
    v_pk_add_f32 v[66:67], v[66:67], v[50:51]
    v_pk_fma_f32 v[82:83], v[50:51], v[50:51], v[82:83]
    v_pk_add_f32 v[68:69], v[68:69], v[52:53]
    v_pk_fma_f32 v[84:85], v[52:53], v[52:53], v[84:85]
    v_pk_add_f32 v[70:71], v[70:71], v[54:55]
    v_pk_fma_f32 v[86:87], v[54:55], v[54:55], v[86:87]
    v_pk_add_f32 v[72:73], v[72:73], v[56:57]
    v_pk_fma_f32 v[88:89], v[56:57], v[56:57], v[88:89]
    v_pk_add_f32 v[74:75], v[74:75], v[58:59]
    v_pk_fma_f32 v[90:91], v[58:59], v[58:59], v[90:91]
    v_pk_add_f32 v[76:77], v[76:77], v[60:61]
    v_pk_fma_f32 v[92:93], v[60:61], v[60:61], v[92:93]
    v_pk_add_f32 v[78:79], v[78:79], v[62:63]
    v_pk_fma_f32 v[94:95], v[62:63], v[62:63], v[94:95]
    s_mov_b32 s50, 4
    v_add_f32_dpp v216, v64, v64 row_ror:8 row_mask:0xf bank_mask:0x3
    v_add_f32_dpp v217, v65, v65 row_ror:8 row_mask:0xf bank_mask:0x3
    v_add_f32_dpp v218, v66, v66 row_ror:8 row_mask:0xf bank_mask:0x3
    v_add_f32_dpp v219, v67, v67 row_ror:8 row_mask:0xf bank_mask:0x3
    v_add_f32_dpp v220, v68, v68 row_ror:8 row_mask:0xf bank_mask:0x3
    v_add_f32_dpp v221, v69, v69 row_ror:8 row_mask:0xf bank_mask:0x3
    v_add_f32_dpp v222, v70, v70 row_ror:8 row_mask:0xf bank_mask:0x3
    v_add_f32_dpp v223, v71, v71 row_ror:8 row_mask:0xf bank_mask:0x3
    v_add_f32_dpp v224, v80, v80 row_ror:8 row_mask:0xf bank_mask:0x3
    v_add_f32_dpp v225, v81, v81 row_ror:8 row_mask:0xf bank_mask:0x3
    v_add_f32_dpp v226, v82, v82 row_ror:8 row_mask:0xf bank_mask:0x3
    v_add_f32_dpp v227, v83, v83 row_ror:8 row_mask:0xf bank_mask:0x3
    v_add_f32_dpp v228, v84, v84 row_ror:8 row_mask:0xf bank_mask:0x3
    v_add_f32_dpp v229, v85, v85 row_ror:8 row_mask:0xf bank_mask:0x3
    v_add_f32_dpp v230, v86, v86 row_ror:8 row_mask:0xf bank_mask:0x3
    v_add_f32_dpp v231, v87, v87 row_ror:8 row_mask:0xf bank_mask:0x3
    v_add_f32_dpp v216, v72, v72 row_ror:8 row_mask:0xf bank_mask:0xc
    v_add_f32_dpp v217, v73, v73 row_ror:8 row_mask:0xf bank_mask:0xc
    v_add_f32_dpp v218, v74, v74 row_ror:8 row_mask:0xf bank_mask:0xc
    v_add_f32_dpp v219, v75, v75 row_ror:8 row_mask:0xf bank_mask:0xc
    v_add_f32_dpp v220, v76, v76 row_ror:8 row_mask:0xf bank_mask:0xc
    v_add_f32_dpp v221, v77, v77 row_ror:8 row_mask:0xf bank_mask:0xc
    v_add_f32_dpp v222, v78, v78 row_ror:8 row_mask:0xf bank_mask:0xc
    v_add_f32_dpp v223, v79, v79 row_ror:8 row_mask:0xf bank_mask:0xc
    v_add_f32_dpp v224, v88, v88 row_ror:8 row_mask:0xf bank_mask:0xc
    v_add_f32_dpp v225, v89, v89 row_ror:8 row_mask:0xf bank_mask:0xc
    v_add_f32_dpp v226, v90, v90 row_ror:8 row_mask:0xf bank_mask:0xc
    v_add_f32_dpp v227, v91, v91 row_ror:8 row_mask:0xf bank_mask:0xc
    v_add_f32_dpp v228, v92, v92 row_ror:8 row_mask:0xf bank_mask:0xc
    v_add_f32_dpp v229, v93, v93 row_ror:8 row_mask:0xf bank_mask:0xc
    v_add_f32_dpp v230, v94, v94 row_ror:8 row_mask:0xf bank_mask:0xc
    v_add_f32_dpp v231, v95, v95 row_ror:8 row_mask:0xf bank_mask:0xc
    s_waitcnt lgkmcnt(6)
    v_mfma_f32_16x16x32_bf16 v[96:99], v[192:195], v[160:163], 0
    ds_read_b64_tr_b16 v[200:201], v233 offset:0
    v_add_f32_dpp v216, v216, v216 row_half_mirror row_mask:0xf bank_mask:0x5
    v_mfma_f32_16x16x32_bf16 v[96:99], v[196:199], v[164:167], v[96:99]
    ds_read_b64_tr_b16 v[202:203], v233 offset:1024
    v_add_f32_dpp v217, v217, v217 row_half_mirror row_mask:0xf bank_mask:0x5
    s_waitcnt lgkmcnt(6)
    v_mfma_f32_16x16x32_bf16 v[100:103], v[192:195], v[168:171], 0
    ds_read_b64_tr_b16 v[204:205], v233 offset:8192
    v_add_f32_dpp v218, v218, v218 row_half_mirror row_mask:0xf bank_mask:0x5
    v_mfma_f32_16x16x32_bf16 v[100:103], v[196:199], v[172:175], v[100:103]
    ds_read_b64_tr_b16 v[206:207], v233 offset:9216
    v_add_f32_dpp v219, v219, v219 row_half_mirror row_mask:0xf bank_mask:0x5
    s_waitcnt lgkmcnt(6)
    v_mfma_f32_16x16x32_bf16 v[104:107], v[192:195], v[176:179], 0
    ds_read_b64_tr_b16 v[208:209], v234 offset:0
    v_add_f32_dpp v224, v224, v224 row_half_mirror row_mask:0xf bank_mask:0x5
    v_mfma_f32_16x16x32_bf16 v[104:107], v[196:199], v[180:183], v[104:107]
    ds_read_b64_tr_b16 v[210:211], v234 offset:1024
    v_add_f32_dpp v225, v225, v225 row_half_mirror row_mask:0xf bank_mask:0x5
    s_waitcnt lgkmcnt(6)
    v_mfma_f32_16x16x32_bf16 v[108:111], v[192:195], v[184:187], 0
    ds_read_b64_tr_b16 v[212:213], v234 offset:8192
    v_add_f32_dpp v226, v226, v226 row_half_mirror row_mask:0xf bank_mask:0x5
    v_mfma_f32_16x16x32_bf16 v[108:111], v[196:199], v[188:191], v[108:111]
    ds_read_b64_tr_b16 v[214:215], v234 offset:9216
    v_add_f32_dpp v227, v227, v227 row_half_mirror row_mask:0xf bank_mask:0x5
    s_waitcnt lgkmcnt(6)
    v_mfma_f32_16x16x32_bf16 v[112:115], v[200:203], v[160:163], 0
    ds_read_b64_tr_b16 v[192:193], v235 offset:0
    v_add_f32_dpp v216, v220, v220 row_half_mirror row_mask:0xf bank_mask:0xa
    s_waitcnt lgkmcnt(5)
    v_mfma_f32_16x16x32_bf16 v[112:115], v[204:207], v[164:167], v[112:115]
    ds_read_b64_tr_b16 v[194:195], v235 offset:1024
    v_add_f32_dpp v217, v221, v221 row_half_mirror row_mask:0xf bank_mask:0xa
    v_mfma_f32_16x16x32_bf16 v[116:119], v[200:203], v[168:171], 0
    ds_read_b64_tr_b16 v[196:197], v235 offset:8192
    v_add_f32_dpp v218, v222, v222 row_half_mirror row_mask:0xf bank_mask:0xa
    v_mfma_f32_16x16x32_bf16 v[116:119], v[204:207], v[172:175], v[116:119]
    ds_read_b64_tr_b16 v[198:199], v235 offset:9216
    v_add_f32_dpp v219, v223, v223 row_half_mirror row_mask:0xf bank_mask:0xa
    v_mfma_f32_16x16x32_bf16 v[120:123], v[200:203], v[176:179], 0
    v_add_f32_dpp v224, v228, v228 row_half_mirror row_mask:0xf bank_mask:0xa
    v_add_f32_dpp v225, v229, v229 row_half_mirror row_mask:0xf bank_mask:0xa
    v_mfma_f32_16x16x32_bf16 v[120:123], v[204:207], v[180:183], v[120:123]
    v_add_f32_dpp v226, v230, v230 row_half_mirror row_mask:0xf bank_mask:0xa
    v_add_f32_dpp v227, v231, v231 row_half_mirror row_mask:0xf bank_mask:0xa
    v_mfma_f32_16x16x32_bf16 v[124:127], v[200:203], v[184:187], 0
    v_add_f32_dpp v216, v216, v216 quad_perm:[1,0,3,2] row_mask:0xf bank_mask:0xf
    v_add_f32_dpp v217, v217, v217 quad_perm:[1,0,3,2] row_mask:0xf bank_mask:0xf
    v_mfma_f32_16x16x32_bf16 v[124:127], v[204:207], v[188:191], v[124:127]
    v_add_f32_dpp v218, v218, v218 quad_perm:[1,0,3,2] row_mask:0xf bank_mask:0xf
    v_add_f32_dpp v219, v219, v219 quad_perm:[1,0,3,2] row_mask:0xf bank_mask:0xf
    s_waitcnt lgkmcnt(2)
    v_mfma_f32_16x16x32_bf16 v[128:131], v[208:211], v[160:163], 0
    ds_read_b64_tr_b16 v[200:201], v250 offset:0
    v_add_f32_dpp v224, v224, v224 quad_perm:[1,0,3,2] row_mask:0xf bank_mask:0xf
    v_mfma_f32_16x16x32_bf16 v[128:131], v[212:215], v[164:167], v[128:131]
    ds_read_b64_tr_b16 v[202:203], v250 offset:512
    v_add_f32_dpp v225, v225, v225 quad_perm:[1,0,3,2] row_mask:0xf bank_mask:0xf
    v_mfma_f32_16x16x32_bf16 v[132:135], v[208:211], v[168:171], 0
    ds_read_b64_tr_b16 v[204:205], v250 offset:4096
    v_add_f32_dpp v226, v226, v226 quad_perm:[1,0,3,2] row_mask:0xf bank_mask:0xf
    v_mfma_f32_16x16x32_bf16 v[132:135], v[212:215], v[172:175], v[132:135]
    ds_read_b64_tr_b16 v[206:207], v250 offset:4608
    v_add_f32_dpp v227, v227, v227 quad_perm:[1,0,3,2] row_mask:0xf bank_mask:0xf
    v_mfma_f32_16x16x32_bf16 v[136:139], v[208:211], v[176:179], 0
    v_add_f32_dpp v216, v216, v216 quad_perm:[2,3,0,1] row_mask:0xf bank_mask:0xf
    v_add_f32_dpp v217, v217, v217 quad_perm:[2,3,0,1] row_mask:0xf bank_mask:0xf
    v_mfma_f32_16x16x32_bf16 v[136:139], v[212:215], v[180:183], v[136:139]
    v_add_f32_dpp v218, v218, v218 quad_perm:[2,3,0,1] row_mask:0xf bank_mask:0xf
    v_add_f32_dpp v219, v219, v219 quad_perm:[2,3,0,1] row_mask:0xf bank_mask:0xf
    v_mfma_f32_16x16x32_bf16 v[140:143], v[208:211], v[184:187], 0
    v_add_f32_dpp v224, v224, v224 quad_perm:[2,3,0,1] row_mask:0xf bank_mask:0xf
    v_add_f32_dpp v225, v225, v225 quad_perm:[2,3,0,1] row_mask:0xf bank_mask:0xf
    v_mfma_f32_16x16x32_bf16 v[140:143], v[212:215], v[188:191], v[140:143]
    v_add_f32_dpp v226, v226, v226 quad_perm:[2,3,0,1] row_mask:0xf bank_mask:0xf
    v_add_f32_dpp v227, v227, v227 quad_perm:[2,3,0,1] row_mask:0xf bank_mask:0xf
    v_mfma_f32_16x16x32_bf16 v[144:147], v[192:195], v[160:163], 0
    ds_read_b64_tr_b16 v[208:209], v236 offset:0
    v_cndmask_b32 v216, v216, v217, s[40:41]
    s_waitcnt lgkmcnt(2)
    v_mfma_f32_16x16x32_bf16 v[144:147], v[196:199], v[164:167], v[144:147]
    ds_read_b64_tr_b16 v[210:211], v236 offset:512
    v_cndmask_b32 v218, v218, v219, s[40:41]
    v_mfma_f32_16x16x32_bf16 v[148:151], v[192:195], v[168:171], 0
    ds_read_b64_tr_b16 v[212:213], v236 offset:4096
    v_cndmask_b32 v224, v224, v225, s[40:41]
    v_mfma_f32_16x16x32_bf16 v[148:151], v[196:199], v[172:175], v[148:151]
    ds_read_b64_tr_b16 v[214:215], v236 offset:4608
    v_cndmask_b32 v226, v226, v227, s[40:41]
    v_mfma_f32_16x16x32_bf16 v[152:155], v[192:195], v[176:179], 0
    s_add_u32 s51, s51, 1
    v_cndmask_b32 v254, v216, v218, s[42:43]
    v_mfma_f32_16x16x32_bf16 v[152:155], v[196:199], v[180:183], v[152:155]
    s_cmp_eq_u32 s51, 3
    v_cndmask_b32 v255, v224, v226, s[42:43]
    v_mfma_f32_16x16x32_bf16 v[156:159], v[192:195], v[184:187], 0
    s_cselect_b32 s52, s54, s53
    v_min_u32 v254, -2, v254
    v_mfma_f32_16x16x32_bf16 v[156:159], v[196:199], v[188:191], v[156:159]
    s_cselect_b32 s51, 0, s51
    v_min_u32 v255, -2, v255
    v_mfma_f32_16x16x32_bf16 v[64:67], v[200:203], v[160:163], 0
    s_waitcnt lgkmcnt(0)
    buffer_store_dwordx2 v[254:255], v247, s[24:27], s12 offen sc1
    v_mfma_f32_16x16x32_bf16 v[64:67], v[204:207], v[164:167], v[64:67]
    s_barrier
    v_mfma_f32_16x16x32_bf16 v[68:71], v[200:203], v[168:171], 0
    ds_read_b64_tr_b16 v[192:193], v232 offset:16384
    v_mfma_f32_16x16x32_bf16 v[68:71], v[204:207], v[172:175], v[68:71]
    ds_read_b64_tr_b16 v[194:195], v232 offset:17408
    v_mfma_f32_16x16x32_bf16 v[72:75], v[200:203], v[176:179], 0
    ds_read_b64_tr_b16 v[196:197], v232 offset:24576
    v_mfma_f32_16x16x32_bf16 v[72:75], v[204:207], v[180:183], v[72:75]
    ds_read_b64_tr_b16 v[198:199], v232 offset:25600
    v_mfma_f32_16x16x32_bf16 v[76:79], v[200:203], v[184:187], 0
    v_add_u32 v250, s52, v250
    v_add_u32 v236, s52, v236
    v_mfma_f32_16x16x32_bf16 v[76:79], v[204:207], v[188:191], v[76:79]
    v_mfma_f32_16x16x32_bf16 v[80:83], v[208:211], v[160:163], 0
    ds_read_b128 v[160:163], v245 offset:16384
    v_mfma_f32_16x16x32_bf16 v[80:83], v[212:215], v[164:167], v[80:83]
    ds_read_b128 v[164:167], v246 offset:16384
    v_mfma_f32_16x16x32_bf16 v[84:87], v[208:211], v[168:171], 0
    ds_read_b128 v[168:171], v245 offset:18432
    v_mfma_f32_16x16x32_bf16 v[84:87], v[212:215], v[172:175], v[84:87]
    ds_read_b128 v[172:175], v246 offset:18432
    v_mfma_f32_16x16x32_bf16 v[88:91], v[208:211], v[176:179], 0
    ds_read_b128 v[176:179], v245 offset:20480
    v_mfma_f32_16x16x32_bf16 v[88:91], v[212:215], v[180:183], v[88:91]
    ds_read_b128 v[180:183], v246 offset:20480
    v_mfma_f32_16x16x32_bf16 v[92:95], v[208:211], v[184:187], 0
    ds_read_b128 v[184:187], v245 offset:22528
    v_mfma_f32_16x16x32_bf16 v[92:95], v[212:215], v[188:191], v[92:95]
    ds_read_b128 v[188:191], v246 offset:22528
    s_branch A_p2_in
    .p2align 3
A_p2:
    s_waitcnt lgkmcnt(6)
    v_mfma_f32_16x16x32_bf16 v[96:99], v[192:195], v[160:163], v[96:99]
    ds_read_b64_tr_b16 v[200:201], v233 offset:0
    v_mfma_f32_16x16x32_bf16 v[96:99], v[196:199], v[164:167], v[96:99]
    ds_read_b64_tr_b16 v[202:203], v233 offset:1024
    s_waitcnt lgkmcnt(6)
    v_mfma_f32_16x16x32_bf16 v[100:103], v[192:195], v[168:171], v[100:103]
    ds_read_b64_tr_b16 v[204:205], v233 offset:8192
    v_mfma_f32_16x16x32_bf16 v[100:103], v[196:199], v[172:175], v[100:103]
    ds_read_b64_tr_b16 v[206:207], v233 offset:9216
    s_waitcnt lgkmcnt(6)
    v_mfma_f32_16x16x32_bf16 v[104:107], v[192:195], v[176:179], v[104:107]
    ds_read_b64_tr_b16 v[208:209], v234 offset:0
    v_mfma_f32_16x16x32_bf16 v[104:107], v[196:199], v[180:183], v[104:107]
    ds_read_b64_tr_b16 v[210:211], v234 offset:1024
    s_waitcnt lgkmcnt(6)
    v_mfma_f32_16x16x32_bf16 v[108:111], v[192:195], v[184:187], v[108:111]
    ds_read_b64_tr_b16 v[212:213], v234 offset:8192
    v_mfma_f32_16x16x32_bf16 v[108:111], v[196:199], v[188:191], v[108:111]
    ds_read_b64_tr_b16 v[214:215], v234 offset:9216
    s_waitcnt lgkmcnt(6)
    v_mfma_f32_16x16x32_bf16 v[112:115], v[200:203], v[160:163], v[112:115]
    ds_read_b64_tr_b16 v[192:193], v235 offset:0
    s_waitcnt lgkmcnt(5)
    v_mfma_f32_16x16x32_bf16 v[112:115], v[204:207], v[164:167], v[112:115]
    ds_read_b64_tr_b16 v[194:195], v235 offset:1024
    v_mfma_f32_16x16x32_bf16 v[116:119], v[200:203], v[168:171], v[116:119]
    ds_read_b64_tr_b16 v[196:197], v235 offset:8192
    v_mfma_f32_16x16x32_bf16 v[116:119], v[204:207], v[172:175], v[116:119]
    ds_read_b64_tr_b16 v[198:199], v235 offset:9216
    v_mfma_f32_16x16x32_bf16 v[120:123], v[200:203], v[176:179], v[120:123]
    v_mfma_f32_16x16x32_bf16 v[120:123], v[204:207], v[180:183], v[120:123]
    v_mfma_f32_16x16x32_bf16 v[124:127], v[200:203], v[184:187], v[124:127]
    v_mfma_f32_16x16x32_bf16 v[124:127], v[204:207], v[188:191], v[124:127]
    s_waitcnt lgkmcnt(2)
    v_mfma_f32_16x16x32_bf16 v[128:131], v[208:211], v[160:163], v[128:131]
    ds_read_b64_tr_b16 v[200:201], v250 offset:0
    v_mfma_f32_16x16x32_bf16 v[128:131], v[212:215], v[164:167], v[128:131]
    ds_read_b64_tr_b16 v[202:203], v250 offset:512
    v_mfma_f32_16x16x32_bf16 v[132:135], v[208:211], v[168:171], v[132:135]
    ds_read_b64_tr_b16 v[204:205], v250 offset:4096
    v_mfma_f32_16x16x32_bf16 v[132:135], v[212:215], v[172:175], v[132:135]
    ds_read_b64_tr_b16 v[206:207], v250 offset:4608
    v_mfma_f32_16x16x32_bf16 v[136:139], v[208:211], v[176:179], v[136:139]
    v_mfma_f32_16x16x32_bf16 v[136:139], v[212:215], v[180:183], v[136:139]
    v_mfma_f32_16x16x32_bf16 v[140:143], v[208:211], v[184:187], v[140:143]
    v_mfma_f32_16x16x32_bf16 v[140:143], v[212:215], v[188:191], v[140:143]
    v_mfma_f32_16x16x32_bf16 v[144:147], v[192:195], v[160:163], v[144:147]
    ds_read_b64_tr_b16 v[208:209], v236 offset:0
    s_waitcnt lgkmcnt(2)
    v_mfma_f32_16x16x32_bf16 v[144:147], v[196:199], v[164:167], v[144:147]
    ds_read_b64_tr_b16 v[210:211], v236 offset:512
    v_mfma_f32_16x16x32_bf16 v[148:151], v[192:195], v[168:171], v[148:151]
    ds_read_b64_tr_b16 v[212:213], v236 offset:4096
    v_mfma_f32_16x16x32_bf16 v[148:151], v[196:199], v[172:175], v[148:151]
    ds_read_b64_tr_b16 v[214:215], v236 offset:4608
    v_mfma_f32_16x16x32_bf16 v[152:155], v[192:195], v[176:179], v[152:155]
    s_add_u32 s51, s51, 1
    v_mfma_f32_16x16x32_bf16 v[152:155], v[196:199], v[180:183], v[152:155]
    s_cmp_eq_u32 s51, 3
    v_mfma_f32_16x16x32_bf16 v[156:159], v[192:195], v[184:187], v[156:159]
    s_cselect_b32 s52, s54, s53
    v_mfma_f32_16x16x32_bf16 v[156:159], v[196:199], v[188:191], v[156:159]
    s_cselect_b32 s51, 0, s51
    v_mfma_f32_16x16x32_bf16 v[64:67], v[200:203], v[160:163], v[64:67]
    s_waitcnt lgkmcnt(0)
    v_mfma_f32_16x16x32_bf16 v[64:67], v[204:207], v[164:167], v[64:67]
    s_barrier
    v_mfma_f32_16x16x32_bf16 v[68:71], v[200:203], v[168:171], v[68:71]
    ds_read_b64_tr_b16 v[192:193], v232 offset:16384
    v_mfma_f32_16x16x32_bf16 v[68:71], v[204:207], v[172:175], v[68:71]
    ds_read_b64_tr_b16 v[194:195], v232 offset:17408
    v_mfma_f32_16x16x32_bf16 v[72:75], v[200:203], v[176:179], v[72:75]
    ds_read_b64_tr_b16 v[196:197], v232 offset:24576
    v_mfma_f32_16x16x32_bf16 v[72:75], v[204:207], v[180:183], v[72:75]
    ds_read_b64_tr_b16 v[198:199], v232 offset:25600
    v_mfma_f32_16x16x32_bf16 v[76:79], v[200:203], v[184:187], v[76:79]
    v_add_u32 v250, s52, v250
    v_add_u32 v236, s52, v236
    v_mfma_f32_16x16x32_bf16 v[76:79], v[204:207], v[188:191], v[76:79]
    v_mfma_f32_16x16x32_bf16 v[80:83], v[208:211], v[160:163], v[80:83]
    ds_read_b128 v[160:163], v245 offset:16384
    v_mfma_f32_16x16x32_bf16 v[80:83], v[212:215], v[164:167], v[80:83]
    ds_read_b128 v[164:167], v246 offset:16384
    v_mfma_f32_16x16x32_bf16 v[84:87], v[208:211], v[168:171], v[84:87]
    ds_read_b128 v[168:171], v245 offset:18432
    v_mfma_f32_16x16x32_bf16 v[84:87], v[212:215], v[172:175], v[84:87]
    ds_read_b128 v[172:175], v246 offset:18432
    v_mfma_f32_16x16x32_bf16 v[88:91], v[208:211], v[176:179], v[88:91]
    ds_read_b128 v[176:179], v245 offset:20480
    v_mfma_f32_16x16x32_bf16 v[88:91], v[212:215], v[180:183], v[88:91]
    ds_read_b128 v[180:183], v246 offset:20480
    v_mfma_f32_16x16x32_bf16 v[92:95], v[208:211], v[184:187], v[92:95]
    ds_read_b128 v[184:187], v245 offset:22528
    v_mfma_f32_16x16x32_bf16 v[92:95], v[212:215], v[188:191], v[92:95]
    ds_read_b128 v[188:191], v246 offset:22528
A_p2_in:
    s_waitcnt lgkmcnt(6)
    v_mfma_f32_16x16x32_bf16 v[96:99], v[192:195], v[160:163], v[96:99]
    ds_read_b64_tr_b16 v[200:201], v233 offset:16384
    v_mfma_f32_16x16x32_bf16 v[96:99], v[196:199], v[164:167], v[96:99]
    ds_read_b64_tr_b16 v[202:203], v233 offset:17408
    s_waitcnt lgkmcnt(6)
    v_mfma_f32_16x16x32_bf16 v[100:103], v[192:195], v[168:171], v[100:103]
    ds_read_b64_tr_b16 v[204:205], v233 offset:24576
    v_mfma_f32_16x16x32_bf16 v[100:103], v[196:199], v[172:175], v[100:103]
    ds_read_b64_tr_b16 v[206:207], v233 offset:25600
    s_waitcnt lgkmcnt(6)
    v_mfma_f32_16x16x32_bf16 v[104:107], v[192:195], v[176:179], v[104:107]
    ds_read_b64_tr_b16 v[208:209], v234 offset:16384
    v_mfma_f32_16x16x32_bf16 v[104:107], v[196:199], v[180:183], v[104:107]
    ds_read_b64_tr_b16 v[210:211], v234 offset:17408
    s_waitcnt lgkmcnt(6)
    v_mfma_f32_16x16x32_bf16 v[108:111], v[192:195], v[184:187], v[108:111]
    ds_read_b64_tr_b16 v[212:213], v234 offset:24576
    v_mfma_f32_16x16x32_bf16 v[108:111], v[196:199], v[188:191], v[108:111]
    ds_read_b64_tr_b16 v[214:215], v234 offset:25600
    s_waitcnt lgkmcnt(6)
    v_mfma_f32_16x16x32_bf16 v[112:115], v[200:203], v[160:163], v[112:115]
    ds_read_b64_tr_b16 v[192:193], v235 offset:16384
    s_waitcnt lgkmcnt(5)
    v_mfma_f32_16x16x32_bf16 v[112:115], v[204:207], v[164:167], v[112:115]
    ds_read_b64_tr_b16 v[194:195], v235 offset:17408
    v_mfma_f32_16x16x32_bf16 v[116:119], v[200:203], v[168:171], v[116:119]
    ds_read_b64_tr_b16 v[196:197], v235 offset:24576
    v_mfma_f32_16x16x32_bf16 v[116:119], v[204:207], v[172:175], v[116:119]
    ds_read_b64_tr_b16 v[198:199], v235 offset:25600
    v_mfma_f32_16x16x32_bf16 v[120:123], v[200:203], v[176:179], v[120:123]
    v_mfma_f32_16x16x32_bf16 v[120:123], v[204:207], v[180:183], v[120:123]
    v_mfma_f32_16x16x32_bf16 v[124:127], v[200:203], v[184:187], v[124:127]
    v_mfma_f32_16x16x32_bf16 v[124:127], v[204:207], v[188:191], v[124:127]
    s_waitcnt lgkmcnt(2)
    v_mfma_f32_16x16x32_bf16 v[128:131], v[208:211], v[160:163], v[128:131]
    ds_read_b64_tr_b16 v[200:201], v250 offset:0
    v_mfma_f32_16x16x32_bf16 v[128:131], v[212:215], v[164:167], v[128:131]
    ds_read_b64_tr_b16 v[202:203], v250 offset:512
    v_mfma_f32_16x16x32_bf16 v[132:135], v[208:211], v[168:171], v[132:135]
    ds_read_b64_tr_b16 v[204:205], v250 offset:4096
    v_mfma_f32_16x16x32_bf16 v[132:135], v[212:215], v[172:175], v[132:135]
    ds_read_b64_tr_b16 v[206:207], v250 offset:4608
    v_mfma_f32_16x16x32_bf16 v[136:139], v[208:211], v[176:179], v[136:139]
    v_mfma_f32_16x16x32_bf16 v[136:139], v[212:215], v[180:183], v[136:139]
    v_mfma_f32_16x16x32_bf16 v[140:143], v[208:211], v[184:187], v[140:143]
    v_mfma_f32_16x16x32_bf16 v[140:143], v[212:215], v[188:191], v[140:143]
    v_mfma_f32_16x16x32_bf16 v[144:147], v[192:195], v[160:163], v[144:147]
    ds_read_b64_tr_b16 v[208:209], v236 offset:0
    s_waitcnt lgkmcnt(2)
    v_mfma_f32_16x16x32_bf16 v[144:147], v[196:199], v[164:167], v[144:147]
    ds_read_b64_tr_b16 v[210:211], v236 offset:512
    v_mfma_f32_16x16x32_bf16 v[148:151], v[192:195], v[168:171], v[148:151]
    ds_read_b64_tr_b16 v[212:213], v236 offset:4096
    v_mfma_f32_16x16x32_bf16 v[148:151], v[196:199], v[172:175], v[148:151]
    ds_read_b64_tr_b16 v[214:215], v236 offset:4608
    v_mfma_f32_16x16x32_bf16 v[152:155], v[192:195], v[176:179], v[152:155]
    s_add_u32 s51, s51, 1
    v_mfma_f32_16x16x32_bf16 v[152:155], v[196:199], v[180:183], v[152:155]
    s_cmp_eq_u32 s51, 3
    v_mfma_f32_16x16x32_bf16 v[156:159], v[192:195], v[184:187], v[156:159]
    s_cselect_b32 s52, s54, s53
    v_mfma_f32_16x16x32_bf16 v[156:159], v[196:199], v[188:191], v[156:159]
    s_cselect_b32 s51, 0, s51
    v_mfma_f32_16x16x32_bf16 v[64:67], v[200:203], v[160:163], v[64:67]
    s_waitcnt vmcnt(0) lgkmcnt(0)
    v_mfma_f32_16x16x32_bf16 v[64:67], v[204:207], v[164:167], v[64:67]
    s_barrier
    v_mfma_f32_16x16x32_bf16 v[68:71], v[200:203], v[168:171], v[68:71]
    ds_read_b64_tr_b16 v[192:193], v232 offset:32768
    v_mfma_f32_16x16x32_bf16 v[68:71], v[204:207], v[172:175], v[68:71]
    ds_read_b64_tr_b16 v[194:195], v232 offset:33792
    v_mfma_f32_16x16x32_bf16 v[72:75], v[200:203], v[176:179], v[72:75]
    ds_read_b64_tr_b16 v[196:197], v232 offset:40960
    v_mfma_f32_16x16x32_bf16 v[72:75], v[204:207], v[180:183], v[72:75]
    ds_read_b64_tr_b16 v[198:199], v232 offset:41984
    v_mfma_f32_16x16x32_bf16 v[76:79], v[200:203], v[184:187], v[76:79]
    v_add_u32 v250, s52, v250
    v_add_u32 v236, s52, v236
    v_mfma_f32_16x16x32_bf16 v[76:79], v[204:207], v[188:191], v[76:79]
    s_cmp_eq_u32 s50, 3
    v_mfma_f32_16x16x32_bf16 v[80:83], v[208:211], v[160:163], v[80:83]
    ds_read_b128 v[160:163], v245 offset:32768
    v_mfma_f32_16x16x32_bf16 v[80:83], v[212:215], v[164:167], v[80:83]
    ds_read_b128 v[164:167], v246 offset:32768
    v_mfma_f32_16x16x32_bf16 v[84:87], v[208:211], v[168:171], v[84:87]
    ds_read_b128 v[168:171], v245 offset:34816
    v_mfma_f32_16x16x32_bf16 v[84:87], v[212:215], v[172:175], v[84:87]
    ds_read_b128 v[172:175], v246 offset:34816
    v_mfma_f32_16x16x32_bf16 v[88:91], v[208:211], v[176:179], v[88:91]
    ds_read_b128 v[176:179], v245 offset:36864
    v_mfma_f32_16x16x32_bf16 v[88:91], v[212:215], v[180:183], v[88:91]
    ds_read_b128 v[180:183], v246 offset:36864
    v_mfma_f32_16x16x32_bf16 v[92:95], v[208:211], v[184:187], v[92:95]
    ds_read_b128 v[184:187], v245 offset:38912
    v_mfma_f32_16x16x32_bf16 v[92:95], v[212:215], v[188:191], v[92:95]
    ds_read_b128 v[188:191], v246 offset:38912
    s_cbranch_scc1 A_norm
A_p2_in2:
    s_waitcnt lgkmcnt(6)
    v_mfma_f32_16x16x32_bf16 v[96:99], v[192:195], v[160:163], v[96:99]
    ds_read_b64_tr_b16 v[200:201], v233 offset:32768
    v_mfma_f32_16x16x32_bf16 v[96:99], v[196:199], v[164:167], v[96:99]
    ds_read_b64_tr_b16 v[202:203], v233 offset:33792
    s_waitcnt lgkmcnt(6)
    v_mfma_f32_16x16x32_bf16 v[100:103], v[192:195], v[168:171], v[100:103]
    ds_read_b64_tr_b16 v[204:205], v233 offset:40960
    v_mfma_f32_16x16x32_bf16 v[100:103], v[196:199], v[172:175], v[100:103]
    ds_read_b64_tr_b16 v[206:207], v233 offset:41984
    s_waitcnt lgkmcnt(6)
    v_mfma_f32_16x16x32_bf16 v[104:107], v[192:195], v[176:179], v[104:107]
    ds_read_b64_tr_b16 v[208:209], v234 offset:32768
    v_mfma_f32_16x16x32_bf16 v[104:107], v[196:199], v[180:183], v[104:107]
    ds_read_b64_tr_b16 v[210:211], v234 offset:33792
    s_waitcnt lgkmcnt(6)
    v_mfma_f32_16x16x32_bf16 v[108:111], v[192:195], v[184:187], v[108:111]
    ds_read_b64_tr_b16 v[212:213], v234 offset:40960
    v_mfma_f32_16x16x32_bf16 v[108:111], v[196:199], v[188:191], v[108:111]
    ds_read_b64_tr_b16 v[214:215], v234 offset:41984
    s_waitcnt lgkmcnt(6)
    v_mfma_f32_16x16x32_bf16 v[112:115], v[200:203], v[160:163], v[112:115]
    ds_read_b64_tr_b16 v[192:193], v235 offset:32768
    s_waitcnt lgkmcnt(5)
    v_mfma_f32_16x16x32_bf16 v[112:115], v[204:207], v[164:167], v[112:115]
    ds_read_b64_tr_b16 v[194:195], v235 offset:33792
    v_mfma_f32_16x16x32_bf16 v[116:119], v[200:203], v[168:171], v[116:119]
    ds_read_b64_tr_b16 v[196:197], v235 offset:40960
    v_mfma_f32_16x16x32_bf16 v[116:119], v[204:207], v[172:175], v[116:119]
    ds_read_b64_tr_b16 v[198:199], v235 offset:41984
    v_mfma_f32_16x16x32_bf16 v[120:123], v[200:203], v[176:179], v[120:123]
    v_mfma_f32_16x16x32_bf16 v[120:123], v[204:207], v[180:183], v[120:123]
    v_mfma_f32_16x16x32_bf16 v[124:127], v[200:203], v[184:187], v[124:127]
    v_mfma_f32_16x16x32_bf16 v[124:127], v[204:207], v[188:191], v[124:127]
    s_waitcnt lgkmcnt(2)
    v_mfma_f32_16x16x32_bf16 v[128:131], v[208:211], v[160:163], v[128:131]
    ds_read_b64_tr_b16 v[200:201], v250 offset:0
    v_mfma_f32_16x16x32_bf16 v[128:131], v[212:215], v[164:167], v[128:131]
    ds_read_b64_tr_b16 v[202:203], v250 offset:512
    v_mfma_f32_16x16x32_bf16 v[132:135], v[208:211], v[168:171], v[132:135]
    ds_read_b64_tr_b16 v[204:205], v250 offset:4096
    v_mfma_f32_16x16x32_bf16 v[132:135], v[212:215], v[172:175], v[132:135]
    ds_read_b64_tr_b16 v[206:207], v250 offset:4608
    v_mfma_f32_16x16x32_bf16 v[136:139], v[208:211], v[176:179], v[136:139]
    v_mfma_f32_16x16x32_bf16 v[136:139], v[212:215], v[180:183], v[136:139]
    v_mfma_f32_16x16x32_bf16 v[140:143], v[208:211], v[184:187], v[140:143]
    v_mfma_f32_16x16x32_bf16 v[140:143], v[212:215], v[188:191], v[140:143]
    v_mfma_f32_16x16x32_bf16 v[144:147], v[192:195], v[160:163], v[144:147]
    ds_read_b64_tr_b16 v[208:209], v236 offset:0
    s_waitcnt lgkmcnt(2)
    v_mfma_f32_16x16x32_bf16 v[144:147], v[196:199], v[164:167], v[144:147]
    ds_read_b64_tr_b16 v[210:211], v236 offset:512
    v_mfma_f32_16x16x32_bf16 v[148:151], v[192:195], v[168:171], v[148:151]
    ds_read_b64_tr_b16 v[212:213], v236 offset:4096
    v_mfma_f32_16x16x32_bf16 v[148:151], v[196:199], v[172:175], v[148:151]
    ds_read_b64_tr_b16 v[214:215], v236 offset:4608
    v_mfma_f32_16x16x32_bf16 v[152:155], v[192:195], v[176:179], v[152:155]
    s_add_u32 s51, s51, 1
    v_mfma_f32_16x16x32_bf16 v[152:155], v[196:199], v[180:183], v[152:155]
    s_cmp_eq_u32 s51, 3
    v_mfma_f32_16x16x32_bf16 v[156:159], v[192:195], v[184:187], v[156:159]
    s_cselect_b32 s52, s54, s53
    v_mfma_f32_16x16x32_bf16 v[156:159], v[196:199], v[188:191], v[156:159]
    s_cselect_b32 s51, 0, s51
    v_mfma_f32_16x16x32_bf16 v[64:67], v[200:203], v[160:163], v[64:67]
    s_waitcnt lgkmcnt(0)
    v_mfma_f32_16x16x32_bf16 v[64:67], v[204:207], v[164:167], v[64:67]
    s_barrier
    v_mfma_f32_16x16x32_bf16 v[68:71], v[200:203], v[168:171], v[68:71]
    ds_read_b64_tr_b16 v[192:193], v232 offset:49152
    v_mfma_f32_16x16x32_bf16 v[68:71], v[204:207], v[172:175], v[68:71]
    ds_read_b64_tr_b16 v[194:195], v232 offset:50176
    v_mfma_f32_16x16x32_bf16 v[72:75], v[200:203], v[176:179], v[72:75]
    ds_read_b64_tr_b16 v[196:197], v232 offset:57344
    v_mfma_f32_16x16x32_bf16 v[72:75], v[204:207], v[180:183], v[72:75]
    ds_read_b64_tr_b16 v[198:199], v232 offset:58368
    v_mfma_f32_16x16x32_bf16 v[76:79], v[200:203], v[184:187], v[76:79]
    v_add_u32 v250, s52, v250
    v_add_u32 v236, s52, v236
    v_mfma_f32_16x16x32_bf16 v[76:79], v[204:207], v[188:191], v[76:79]
    v_mfma_f32_16x16x32_bf16 v[80:83], v[208:211], v[160:163], v[80:83]
    ds_read_b128 v[160:163], v245 offset:49152
    v_mfma_f32_16x16x32_bf16 v[80:83], v[212:215], v[164:167], v[80:83]
    ds_read_b128 v[164:167], v246 offset:49152
    v_mfma_f32_16x16x32_bf16 v[84:87], v[208:211], v[168:171], v[84:87]
    ds_read_b128 v[168:171], v245 offset:51200
    v_mfma_f32_16x16x32_bf16 v[84:87], v[212:215], v[172:175], v[84:87]
    ds_read_b128 v[172:175], v246 offset:51200
    v_mfma_f32_16x16x32_bf16 v[88:91], v[208:211], v[176:179], v[88:91]
    ds_read_b128 v[176:179], v245 offset:53248
    v_mfma_f32_16x16x32_bf16 v[88:91], v[212:215], v[180:183], v[88:91]
    ds_read_b128 v[180:183], v246 offset:53248
    v_mfma_f32_16x16x32_bf16 v[92:95], v[208:211], v[184:187], v[92:95]
    ds_read_b128 v[184:187], v245 offset:55296
    v_mfma_f32_16x16x32_bf16 v[92:95], v[212:215], v[188:191], v[92:95]
    ds_read_b128 v[188:191], v246 offset:55296
    s_waitcnt lgkmcnt(6)
    v_mfma_f32_16x16x32_bf16 v[96:99], v[192:195], v[160:163], v[96:99]
    ds_read_b64_tr_b16 v[200:201], v233 offset:49152
    v_mfma_f32_16x16x32_bf16 v[96:99], v[196:199], v[164:167], v[96:99]
    ds_read_b64_tr_b16 v[202:203], v233 offset:50176
    s_waitcnt lgkmcnt(6)
    v_mfma_f32_16x16x32_bf16 v[100:103], v[192:195], v[168:171], v[100:103]
    ds_read_b64_tr_b16 v[204:205], v233 offset:57344
    v_mfma_f32_16x16x32_bf16 v[100:103], v[196:199], v[172:175], v[100:103]
    ds_read_b64_tr_b16 v[206:207], v233 offset:58368
    s_waitcnt lgkmcnt(6)
    v_mfma_f32_16x16x32_bf16 v[104:107], v[192:195], v[176:179], v[104:107]
    ds_read_b64_tr_b16 v[208:209], v234 offset:49152
    v_mfma_f32_16x16x32_bf16 v[104:107], v[196:199], v[180:183], v[104:107]
    ds_read_b64_tr_b16 v[210:211], v234 offset:50176
    s_waitcnt lgkmcnt(6)
    v_mfma_f32_16x16x32_bf16 v[108:111], v[192:195], v[184:187], v[108:111]
    ds_read_b64_tr_b16 v[212:213], v234 offset:57344
    v_mfma_f32_16x16x32_bf16 v[108:111], v[196:199], v[188:191], v[108:111]
    ds_read_b64_tr_b16 v[214:215], v234 offset:58368
    s_waitcnt lgkmcnt(6)
    v_mfma_f32_16x16x32_bf16 v[112:115], v[200:203], v[160:163], v[112:115]
    ds_read_b64_tr_b16 v[192:193], v235 offset:49152
    s_waitcnt lgkmcnt(5)
    v_mfma_f32_16x16x32_bf16 v[112:115], v[204:207], v[164:167], v[112:115]
    ds_read_b64_tr_b16 v[194:195], v235 offset:50176
    v_mfma_f32_16x16x32_bf16 v[116:119], v[200:203], v[168:171], v[116:119]
    ds_read_b64_tr_b16 v[196:197], v235 offset:57344
    v_mfma_f32_16x16x32_bf16 v[116:119], v[204:207], v[172:175], v[116:119]
    s_branch PG2_go
    .p2align 12
PG2:
    s_setpc_b64 s[72:73]
    s_nop 0
PG2_go:
    ds_read_b64_tr_b16 v[198:199], v235 offset:58368
    v_mfma_f32_16x16x32_bf16 v[120:123], v[200:203], v[176:179], v[120:123]
    v_mfma_f32_16x16x32_bf16 v[120:123], v[204:207], v[180:183], v[120:123]
    v_mfma_f32_16x16x32_bf16 v[124:127], v[200:203], v[184:187], v[124:127]
    v_mfma_f32_16x16x32_bf16 v[124:127], v[204:207], v[188:191], v[124:127]
    s_waitcnt lgkmcnt(2)
    v_mfma_f32_16x16x32_bf16 v[128:131], v[208:211], v[160:163], v[128:131]
    ds_read_b64_tr_b16 v[200:201], v250 offset:0
    v_mfma_f32_16x16x32_bf16 v[128:131], v[212:215], v[164:167], v[128:131]
    ds_read_b64_tr_b16 v[202:203], v250 offset:512
    v_mfma_f32_16x16x32_bf16 v[132:135], v[208:211], v[168:171], v[132:135]
    ds_read_b64_tr_b16 v[204:205], v250 offset:4096
    v_mfma_f32_16x16x32_bf16 v[132:135], v[212:215], v[172:175], v[132:135]
    ds_read_b64_tr_b16 v[206:207], v250 offset:4608
    v_mfma_f32_16x16x32_bf16 v[136:139], v[208:211], v[176:179], v[136:139]
    v_mfma_f32_16x16x32_bf16 v[136:139], v[212:215], v[180:183], v[136:139]
    v_mfma_f32_16x16x32_bf16 v[140:143], v[208:211], v[184:187], v[140:143]
    v_mfma_f32_16x16x32_bf16 v[140:143], v[212:215], v[188:191], v[140:143]
    v_mfma_f32_16x16x32_bf16 v[144:147], v[192:195], v[160:163], v[144:147]
    ds_read_b64_tr_b16 v[208:209], v236 offset:0
    s_waitcnt lgkmcnt(2)
    v_mfma_f32_16x16x32_bf16 v[144:147], v[196:199], v[164:167], v[144:147]
    ds_read_b64_tr_b16 v[210:211], v236 offset:512
    v_mfma_f32_16x16x32_bf16 v[148:151], v[192:195], v[168:171], v[148:151]
    ds_read_b64_tr_b16 v[212:213], v236 offset:4096
    v_mfma_f32_16x16x32_bf16 v[148:151], v[196:199], v[172:175], v[148:151]
    ds_read_b64_tr_b16 v[214:215], v236 offset:4608
    v_mfma_f32_16x16x32_bf16 v[152:155], v[192:195], v[176:179], v[152:155]
    s_add_u32 s51, s51, 1
    v_mfma_f32_16x16x32_bf16 v[152:155], v[196:199], v[180:183], v[152:155]
    s_cmp_eq_u32 s51, 3
    v_mfma_f32_16x16x32_bf16 v[156:159], v[192:195], v[184:187], v[156:159]
    s_cselect_b32 s52, s54, s53
    v_mfma_f32_16x16x32_bf16 v[156:159], v[196:199], v[188:191], v[156:159]
    s_cselect_b32 s51, 0, s51
    v_mfma_f32_16x16x32_bf16 v[64:67], v[200:203], v[160:163], v[64:67]
    s_waitcnt lgkmcnt(0)
    v_mfma_f32_16x16x32_bf16 v[64:67], v[204:207], v[164:167], v[64:67]
    s_barrier
    v_mfma_f32_16x16x32_bf16 v[68:71], v[200:203], v[168:171], v[68:71]
    ds_read_b64_tr_b16 v[192:193], v232 offset:0
    s_sub_u32 s50, s50, 1
    v_mfma_f32_16x16x32_bf16 v[68:71], v[204:207], v[172:175], v[68:71]
    ds_read_b64_tr_b16 v[194:195], v232 offset:1024
    s_cmp_lg_u32 s50, 0
    v_mfma_f32_16x16x32_bf16 v[72:75], v[200:203], v[176:179], v[72:75]
    ds_read_b64_tr_b16 v[196:197], v232 offset:8192
    v_mfma_f32_16x16x32_bf16 v[72:75], v[204:207], v[180:183], v[72:75]
    ds_read_b64_tr_b16 v[198:199], v232 offset:9216
    v_mfma_f32_16x16x32_bf16 v[76:79], v[200:203], v[184:187], v[76:79]
    v_add_u32 v250, s52, v250
    v_add_u32 v236, s52, v236
    v_mfma_f32_16x16x32_bf16 v[76:79], v[204:207], v[188:191], v[76:79]
    ds_read_b128 v[224:227], v249 offset:0
    ds_read_b128 v[228:231], v249 offset:8192
    v_mfma_f32_16x16x32_bf16 v[80:83], v[208:211], v[160:163], v[80:83]
    ds_read_b128 v[160:163], v245 offset:0
    v_mfma_f32_16x16x32_bf16 v[80:83], v[212:215], v[164:167], v[80:83]
    ds_read_b128 v[164:167], v246 offset:0
    v_mfma_f32_16x16x32_bf16 v[84:87], v[208:211], v[168:171], v[84:87]
    ds_read_b128 v[168:171], v245 offset:2048
    v_mfma_f32_16x16x32_bf16 v[84:87], v[212:215], v[172:175], v[84:87]
    ds_read_b128 v[172:175], v246 offset:2048
    v_mfma_f32_16x16x32_bf16 v[88:91], v[208:211], v[176:179], v[88:91]
    ds_read_b128 v[176:179], v245 offset:4096
    v_mfma_f32_16x16x32_bf16 v[88:91], v[212:215], v[180:183], v[88:91]
    ds_read_b128 v[180:183], v246 offset:4096
    v_mfma_f32_16x16x32_bf16 v[92:95], v[208:211], v[184:187], v[92:95]
    ds_read_b128 v[184:187], v245 offset:6144
    v_mfma_f32_16x16x32_bf16 v[92:95], v[212:215], v[188:191], v[92:95]
    ds_read_b128 v[188:191], v246 offset:6144
    s_cbranch_scc1 A_p2
    v_add_u32 v250, 131072, v244
    s_waitcnt lgkmcnt(5)
    v_mfma_f32_16x16x32_bf16 v[0:3], v[224:227], v[160:163], v[216:219]
    ds_read_b128 v[208:211], v249 offset:1024
    v_mfma_f32_16x16x32_bf16 v[0:3], v[228:231], v[164:167], v[0:3]
    ds_read_b128 v[212:215], v249 offset:9216
    v_mfma_f32_16x16x32_bf16 v[4:7], v[224:227], v[168:171], v[220:223]
    s_waitcnt lgkmcnt(4)
    v_mfma_f32_16x16x32_bf16 v[4:7], v[228:231], v[172:175], v[4:7]
    v_mfma_f32_16x16x32_bf16 v[8:11], v[224:227], v[176:179], v[252:255]
    v_cvt_pk_bf16_f32 v192, v64, v65
    v_cvt_pk_bf16_f32 v193, v66, v67
    v_mfma_f32_16x16x32_bf16 v[8:11], v[228:231], v[180:183], v[8:11]
    s_waitcnt lgkmcnt(1)
    v_cvt_pk_bf16_f32 v194, v68, v69
    v_cvt_pk_bf16_f32 v195, v70, v71
    v_cvt_pk_bf16_f32 v196, v80, v81
    v_mfma_f32_16x16x32_bf16 v[12:15], v[224:227], v[184:187], v[240:243]
    v_cvt_pk_bf16_f32 v197, v82, v83
    v_cvt_pk_bf16_f32 v198, v84, v85
    v_mfma_f32_16x16x32_bf16 v[12:15], v[228:231], v[188:191], v[12:15]
    v_cvt_pk_bf16_f32 v199, v86, v87
    v_cvt_pk_bf16_f32 v200, v72, v73
    v_cvt_pk_bf16_f32 v201, v74, v75
    v_mfma_f32_16x16x32_bf16 v[16:19], v[208:211], v[160:163], v[216:219]
    ds_read_b128 v[224:227], v249 offset:2048
    s_waitcnt lgkmcnt(1)
    v_mfma_f32_16x16x32_bf16 v[16:19], v[212:215], v[164:167], v[16:19]
    ds_read_b128 v[228:231], v249 offset:10240
    v_cvt_pk_bf16_f32 v202, v76, v77
    v_mfma_f32_16x16x32_bf16 v[20:23], v[208:211], v[168:171], v[220:223]
    v_cvt_pk_bf16_f32 v203, v78, v79
    v_cvt_pk_bf16_f32 v204, v88, v89
    v_mfma_f32_16x16x32_bf16 v[20:23], v[212:215], v[172:175], v[20:23]
    v_cvt_pk_bf16_f32 v205, v90, v91
    v_cvt_pk_bf16_f32 v206, v92, v93
    v_cvt_pk_bf16_f32 v207, v94, v95
    v_mfma_f32_16x16x32_bf16 v[24:27], v[208:211], v[176:179], v[252:255]
    v_permlane16_swap_b32 v192, v194
    v_permlane16_swap_b32 v193, v195
    v_mfma_f32_16x16x32_bf16 v[24:27], v[212:215], v[180:183], v[24:27]
    v_permlane16_swap_b32 v196, v198
    v_permlane16_swap_b32 v197, v199
    v_permlane16_swap_b32 v200, v202
    v_mfma_f32_16x16x32_bf16 v[28:31], v[208:211], v[184:187], v[240:243]
    v_permlane16_swap_b32 v201, v203
    v_permlane16_swap_b32 v204, v206
    v_mfma_f32_16x16x32_bf16 v[28:31], v[212:215], v[188:191], v[28:31]
    s_waitcnt lgkmcnt(0)
    v_permlane16_swap_b32 v205, v207
    v_mul_f32 v232, v96, v96
    v_mul_f32 v233, v97, v97
    v_mfma_f32_16x16x32_bf16 v[32:35], v[224:227], v[160:163], v[216:219]
    ds_read_b128 v[208:211], v249 offset:3072
    v_mul_f32 v234, v98, v98
    v_mfma_f32_16x16x32_bf16 v[32:35], v[228:231], v[164:167], v[32:35]
    ds_read_b128 v[212:215], v249 offset:11264
    v_mul_f32 v235, v99, v99
    v_mfma_f32_16x16x32_bf16 v[36:39], v[224:227], v[168:171], v[220:223]
    v_fma_f32 v232, v232, v239, v238
    v_fma_f32 v233, v233, v239, v238
    v_fma_f32 v234, v234, v239, v238
    v_mfma_f32_16x16x32_bf16 v[36:39], v[228:231], v[172:175], v[36:39]
    v_fma_f32 v235, v235, v239, v238
    v_mul_f32 v232, v232, v96
    v_mfma_f32_16x16x32_bf16 v[40:43], v[224:227], v[176:179], v[252:255]
    v_mul_f32 v233, v233, v97
    v_mul_f32 v234, v234, v98
    v_mul_f32 v235, v235, v99
    v_mfma_f32_16x16x32_bf16 v[40:43], v[228:231], v[180:183], v[40:43]
    v_exp_f32 v232, v232
    v_mfma_f32_16x16x32_bf16 v[44:47], v[224:227], v[184:187], v[240:243]
    s_waitcnt lgkmcnt(0)
    v_exp_f32 v233, v233
    v_mfma_f32_16x16x32_bf16 v[44:47], v[228:231], v[188:191], v[44:47]
    s_barrier
    v_exp_f32 v234, v234
    v_mfma_f32_16x16x32_bf16 v[48:51], v[208:211], v[160:163], v[216:219]
    ds_read_b128 v[224:227], v249 offset:16384
    ds_read_b128 v[160:163], v245 offset:16384
    v_mfma_f32_16x16x32_bf16 v[48:51], v[212:215], v[164:167], v[48:51]
    ds_read_b128 v[228:231], v249 offset:24576
    ds_read_b128 v[164:167], v246 offset:16384
    v_mfma_f32_16x16x32_bf16 v[52:55], v[208:211], v[168:171], v[220:223]
    ds_read_b128 v[168:171], v245 offset:18432
    v_exp_f32 v235, v235
    v_add_f32 v232, 1.0, v232
    v_mfma_f32_16x16x32_bf16 v[52:55], v[212:215], v[172:175], v[52:55]
    ds_read_b128 v[172:175], v246 offset:18432
    v_add_f32 v233, 1.0, v233
    v_mfma_f32_16x16x32_bf16 v[56:59], v[208:211], v[176:179], v[252:255]
    ds_read_b128 v[176:179], v245 offset:20480
    v_add_f32 v234, 1.0, v234
    v_mfma_f32_16x16x32_bf16 v[56:59], v[212:215], v[180:183], v[56:59]
    ds_read_b128 v[180:183], v246 offset:20480
    v_add_f32 v235, 1.0, v235
    v_mfma_f32_16x16x32_bf16 v[60:63], v[208:211], v[184:187], v[240:243]
    ds_read_b128 v[184:187], v245 offset:22528
    v_rcp_f32 v232, v232
    v_mfma_f32_16x16x32_bf16 v[60:63], v[212:215], v[188:191], v[60:63]
    ds_read_b128 v[188:191], v246 offset:22528
    s_waitcnt lgkmcnt(5)
    v_mfma_f32_16x16x32_bf16 v[0:3], v[224:227], v[160:163], v[0:3]
    ds_read_b128 v[208:211], v249 offset:17408
    v_rcp_f32 v233, v233
    v_mfma_f32_16x16x32_bf16 v[0:3], v[228:231], v[164:167], v[0:3]
    ds_read_b128 v[212:215], v249 offset:25600
    v_mfma_f32_16x16x32_bf16 v[4:7], v[224:227], v[168:171], v[4:7]
    s_waitcnt lgkmcnt(4)
    v_rcp_f32 v234, v234
    v_mfma_f32_16x16x32_bf16 v[4:7], v[228:231], v[172:175], v[4:7]
    v_rcp_f32 v235, v235
    v_mul_f32 v96, v96, v232
    v_mfma_f32_16x16x32_bf16 v[8:11], v[224:227], v[176:179], v[8:11]
    v_mul_f32 v97, v97, v233
    v_mul_f32 v98, v98, v234
    v_mul_f32 v99, v99, v235
    v_mfma_f32_16x16x32_bf16 v[8:11], v[228:231], v[180:183], v[8:11]
    s_waitcnt lgkmcnt(1)
    v_cvt_pk_bf16_f32 v64, v96, v97
    v_cvt_pk_bf16_f32 v65, v98, v99
    v_mfma_f32_16x16x32_bf16 v[12:15], v[224:227], v[184:187], v[12:15]
    v_mul_f32 v232, v100, v100
    v_mul_f32 v233, v101, v101
    v_mul_f32 v234, v102, v102
    v_mfma_f32_16x16x32_bf16 v[12:15], v[228:231], v[188:191], v[12:15]
    v_mul_f32 v235, v103, v103
    v_fma_f32 v232, v232, v239, v238
    v_mfma_f32_16x16x32_bf16 v[16:19], v[208:211], v[160:163], v[16:19]
    ds_read_b128 v[224:227], v249 offset:18432
    s_waitcnt lgkmcnt(1)
    v_mfma_f32_16x16x32_bf16 v[16:19], v[212:215], v[164:167], v[16:19]
    ds_read_b128 v[228:231], v249 offset:26624
    v_fma_f32 v233, v233, v239, v238
    v_fma_f32 v234, v234, v239, v238
    v_mfma_f32_16x16x32_bf16 v[20:23], v[208:211], v[168:171], v[20:23]
    v_fma_f32 v235, v235, v239, v238
    v_mul_f32 v232, v232, v100
    v_mfma_f32_16x16x32_bf16 v[20:23], v[212:215], v[172:175], v[20:23]
    v_mul_f32 v233, v233, v101
    v_mul_f32 v234, v234, v102
    v_mul_f32 v235, v235, v103
    v_mfma_f32_16x16x32_bf16 v[24:27], v[208:211], v[176:179], v[24:27]
    v_exp_f32 v232, v232
    v_mfma_f32_16x16x32_bf16 v[24:27], v[212:215], v[180:183], v[24:27]
    v_exp_f32 v233, v233
    v_mfma_f32_16x16x32_bf16 v[28:31], v[208:211], v[184:187], v[28:31]
    v_exp_f32 v234, v234
    v_mfma_f32_16x16x32_bf16 v[28:31], v[212:215], v[188:191], v[28:31]
    s_waitcnt lgkmcnt(0)
    v_exp_f32 v235, v235
    v_add_f32 v232, 1.0, v232
    v_add_f32 v233, 1.0, v233
    v_mfma_f32_16x16x32_bf16 v[32:35], v[224:227], v[160:163], v[32:35]
    ds_read_b128 v[208:211], v249 offset:19456
    v_add_f32 v234, 1.0, v234
    v_mfma_f32_16x16x32_bf16 v[32:35], v[228:231], v[164:167], v[32:35]
    ds_read_b128 v[212:215], v249 offset:27648
    v_add_f32 v235, 1.0, v235
    v_mfma_f32_16x16x32_bf16 v[36:39], v[224:227], v[168:171], v[36:39]
    v_rcp_f32 v232, v232
    v_mfma_f32_16x16x32_bf16 v[36:39], v[228:231], v[172:175], v[36:39]
    v_rcp_f32 v233, v233
    v_mfma_f32_16x16x32_bf16 v[40:43], v[224:227], v[176:179], v[40:43]
    v_rcp_f32 v234, v234
    v_rcp_f32 v235, v235
    v_mfma_f32_16x16x32_bf16 v[40:43], v[228:231], v[180:183], v[40:43]
    v_mul_f32 v100, v100, v232
    v_mul_f32 v101, v101, v233
    v_mfma_f32_16x16x32_bf16 v[44:47], v[224:227], v[184:187], v[44:47]
    s_waitcnt lgkmcnt(0)
    v_mul_f32 v102, v102, v234
    v_mul_f32 v103, v103, v235
    v_cvt_pk_bf16_f32 v68, v100, v101
    v_mfma_f32_16x16x32_bf16 v[44:47], v[228:231], v[188:191], v[44:47]
    s_barrier
    v_cvt_pk_bf16_f32 v69, v102, v103
    v_mul_f32 v232, v104, v104
    v_mfma_f32_16x16x32_bf16 v[48:51], v[208:211], v[160:163], v[48:51]
    ds_read_b128 v[224:227], v249 offset:32768
    ds_read_b128 v[160:163], v245 offset:32768
    v_mfma_f32_16x16x32_bf16 v[48:51], v[212:215], v[164:167], v[48:51]
    ds_read_b128 v[228:231], v249 offset:40960
    ds_read_b128 v[164:167], v246 offset:32768
    v_mfma_f32_16x16x32_bf16 v[52:55], v[208:211], v[168:171], v[52:55]
    ds_read_b128 v[168:171], v245 offset:34816
    v_mul_f32 v233, v105, v105
    v_mul_f32 v234, v106, v106
    v_mfma_f32_16x16x32_bf16 v[52:55], v[212:215], v[172:175], v[52:55]
    ds_read_b128 v[172:175], v246 offset:34816
    v_mul_f32 v235, v107, v107
    v_mfma_f32_16x16x32_bf16 v[56:59], v[208:211], v[176:179], v[56:59]
    ds_read_b128 v[176:179], v245 offset:36864
    v_fma_f32 v232, v232, v239, v238
    v_mfma_f32_16x16x32_bf16 v[56:59], v[212:215], v[180:183], v[56:59]
    ds_read_b128 v[180:183], v246 offset:36864
    v_fma_f32 v233, v233, v239, v238
    v_mfma_f32_16x16x32_bf16 v[60:63], v[208:211], v[184:187], v[60:63]
    ds_read_b128 v[184:187], v245 offset:38912
    v_fma_f32 v234, v234, v239, v238
    v_fma_f32 v235, v235, v239, v238
    v_mfma_f32_16x16x32_bf16 v[60:63], v[212:215], v[188:191], v[60:63]
    ds_read_b128 v[188:191], v246 offset:38912
    s_waitcnt lgkmcnt(5)
    v_mfma_f32_16x16x32_bf16 v[0:3], v[224:227], v[160:163], v[0:3]
    ds_read_b128 v[208:211], v249 offset:33792
    v_mul_f32 v232, v232, v104
    v_mfma_f32_16x16x32_bf16 v[0:3], v[228:231], v[164:167], v[0:3]
    ds_read_b128 v[212:215], v249 offset:41984
    v_mul_f32 v233, v233, v105
    v_mfma_f32_16x16x32_bf16 v[4:7], v[224:227], v[168:171], v[4:7]
    s_waitcnt lgkmcnt(4)
    v_mul_f32 v234, v234, v106
    v_mul_f32 v235, v235, v107
    v_mfma_f32_16x16x32_bf16 v[4:7], v[228:231], v[172:175], v[4:7]
    v_exp_f32 v232, v232
    v_mfma_f32_16x16x32_bf16 v[8:11], v[224:227], v[176:179], v[8:11]
    v_exp_f32 v233, v233
    v_exp_f32 v234, v234
    v_mfma_f32_16x16x32_bf16 v[8:11], v[228:231], v[180:183], v[8:11]
    s_waitcnt lgkmcnt(1)
    v_exp_f32 v235, v235
    v_mfma_f32_16x16x32_bf16 v[12:15], v[224:227], v[184:187], v[12:15]
    v_add_f32 v232, 1.0, v232
    v_add_f32 v233, 1.0, v233
    v_add_f32 v234, 1.0, v234
    v_mfma_f32_16x16x32_bf16 v[12:15], v[228:231], v[188:191], v[12:15]
    v_add_f32 v235, 1.0, v235
    v_rcp_f32 v232, v232
    v_mfma_f32_16x16x32_bf16 v[16:19], v[208:211], v[160:163], v[16:19]
    ds_read_b128 v[224:227], v249 offset:34816
    s_waitcnt lgkmcnt(1)
    v_mfma_f32_16x16x32_bf16 v[16:19], v[212:215], v[164:167], v[16:19]
    ds_read_b128 v[228:231], v249 offset:43008
    v_mfma_f32_16x16x32_bf16 v[20:23], v[208:211], v[168:171], v[20:23]
    v_rcp_f32 v233, v233
    v_mfma_f32_16x16x32_bf16 v[20:23], v[212:215], v[172:175], v[20:23]
    v_rcp_f32 v234, v234
    v_mfma_f32_16x16x32_bf16 v[24:27], v[208:211], v[176:179], v[24:27]
    v_rcp_f32 v235, v235
    v_mul_f32 v104, v104, v232
    v_mul_f32 v105, v105, v233
    v_mfma_f32_16x16x32_bf16 v[24:27], v[212:215], v[180:183], v[24:27]
    v_mul_f32 v106, v106, v234
    v_mul_f32 v107, v107, v235
    v_mfma_f32_16x16x32_bf16 v[28:31], v[208:211], v[184:187], v[28:31]
    v_cvt_pk_bf16_f32 v72, v104, v105
    v_cvt_pk_bf16_f32 v73, v106, v107
    v_mul_f32 v232, v108, v108
    v_mfma_f32_16x16x32_bf16 v[28:31], v[212:215], v[188:191], v[28:31]
    s_waitcnt lgkmcnt(0)
    v_mul_f32 v233, v109, v109
    v_mul_f32 v234, v110, v110
    v_mul_f32 v235, v111, v111
    v_mfma_f32_16x16x32_bf16 v[32:35], v[224:227], v[160:163], v[32:35]
    ds_read_b128 v[208:211], v249 offset:35840
    v_fma_f32 v232, v232, v239, v238
    v_mfma_f32_16x16x32_bf16 v[32:35], v[228:231], v[164:167], v[32:35]
    ds_read_b128 v[212:215], v249 offset:44032
    v_fma_f32 v233, v233, v239, v238
    v_mfma_f32_16x16x32_bf16 v[36:39], v[224:227], v[168:171], v[36:39]
    v_fma_f32 v234, v234, v239, v238
    v_fma_f32 v235, v235, v239, v238
    v_mul_f32 v232, v232, v108
    v_mfma_f32_16x16x32_bf16 v[36:39], v[228:231], v[172:175], v[36:39]
    v_mul_f32 v233, v233, v109
    v_mul_f32 v234, v234, v110
    v_mfma_f32_16x16x32_bf16 v[40:43], v[224:227], v[176:179], v[40:43]
    v_mul_f32 v235, v235, v111
    v_exp_f32 v232, v232
    v_mfma_f32_16x16x32_bf16 v[40:43], v[228:231], v[180:183], v[40:43]
    v_exp_f32 v233, v233
    v_mfma_f32_16x16x32_bf16 v[44:47], v[224:227], v[184:187], v[44:47]
    s_waitcnt lgkmcnt(0)
    v_exp_f32 v234, v234
    v_mfma_f32_16x16x32_bf16 v[44:47], v[228:231], v[188:191], v[44:47]
    s_barrier
    v_exp_f32 v235, v235
    v_add_f32 v232, 1.0, v232
    v_mfma_f32_16x16x32_bf16 v[48:51], v[208:211], v[160:163], v[48:51]
    ds_read_b128 v[224:227], v249 offset:49152
    ds_read_b128 v[160:163], v245 offset:49152
    v_mfma_f32_16x16x32_bf16 v[48:51], v[212:215], v[164:167], v[48:51]
    ds_read_b128 v[228:231], v249 offset:57344
    ds_read_b128 v[164:167], v246 offset:49152
    v_mfma_f32_16x16x32_bf16 v[52:55], v[208:211], v[168:171], v[52:55]
    ds_read_b128 v[168:171], v245 offset:51200
    v_add_f32 v233, 1.0, v233
    v_mfma_f32_16x16x32_bf16 v[52:55], v[212:215], v[172:175], v[52:55]
    ds_read_b128 v[172:175], v246 offset:51200
    v_add_f32 v234, 1.0, v234
    v_add_f32 v235, 1.0, v235
    v_mfma_f32_16x16x32_bf16 v[56:59], v[208:211], v[176:179], v[56:59]
    ds_read_b128 v[176:179], v245 offset:53248
    v_rcp_f32 v232, v232
    v_mfma_f32_16x16x32_bf16 v[56:59], v[212:215], v[180:183], v[56:59]
    ds_read_b128 v[180:183], v246 offset:53248
    v_mfma_f32_16x16x32_bf16 v[60:63], v[208:211], v[184:187], v[60:63]
    ds_read_b128 v[184:187], v245 offset:55296
    v_rcp_f32 v233, v233
    v_mfma_f32_16x16x32_bf16 v[60:63], v[212:215], v[188:191], v[60:63]
    ds_read_b128 v[188:191], v246 offset:55296
    s_waitcnt lgkmcnt(5)
    v_mfma_f32_16x16x32_bf16 v[0:3], v[224:227], v[160:163], v[0:3]
    ds_read_b128 v[208:211], v249 offset:50176
    v_rcp_f32 v234, v234
    v_mfma_f32_16x16x32_bf16 v[0:3], v[228:231], v[164:167], v[0:3]
    ds_read_b128 v[212:215], v249 offset:58368
    v_mfma_f32_16x16x32_bf16 v[4:7], v[224:227], v[168:171], v[4:7]
    s_waitcnt lgkmcnt(4)
    v_rcp_f32 v235, v235
    v_mfma_f32_16x16x32_bf16 v[4:7], v[228:231], v[172:175], v[4:7]
    v_mul_f32 v108, v108, v232
    v_mul_f32 v109, v109, v233
    v_mul_f32 v110, v110, v234
    v_mfma_f32_16x16x32_bf16 v[8:11], v[224:227], v[176:179], v[8:11]
    v_mul_f32 v111, v111, v235
    v_cvt_pk_bf16_f32 v76, v108, v109
    v_mfma_f32_16x16x32_bf16 v[8:11], v[228:231], v[180:183], v[8:11]
    s_waitcnt lgkmcnt(1)
    v_cvt_pk_bf16_f32 v77, v110, v111
    v_mul_f32 v232, v112, v112
    v_mul_f32 v233, v113, v113
    v_mfma_f32_16x16x32_bf16 v[12:15], v[224:227], v[184:187], v[12:15]
    v_mul_f32 v234, v114, v114
    v_mul_f32 v235, v115, v115
    v_mfma_f32_16x16x32_bf16 v[12:15], v[228:231], v[188:191], v[12:15]
    v_fma_f32 v232, v232, v239, v238
    v_fma_f32 v233, v233, v239, v238
    v_fma_f32 v234, v234, v239, v238
    v_mfma_f32_16x16x32_bf16 v[16:19], v[208:211], v[160:163], v[16:19]
    ds_read_b128 v[224:227], v249 offset:51200
    s_waitcnt lgkmcnt(1)
    v_mfma_f32_16x16x32_bf16 v[16:19], v[212:215], v[164:167], v[16:19]
    ds_read_b128 v[228:231], v249 offset:59392
    v_fma_f32 v235, v235, v239, v238
    v_mfma_f32_16x16x32_bf16 v[20:23], v[208:211], v[168:171], v[20:23]
    v_mul_f32 v232, v232, v112
    v_mul_f32 v233, v233, v113
    v_mul_f32 v234, v234, v114
    v_mfma_f32_16x16x32_bf16 v[20:23], v[212:215], v[172:175], v[20:23]
    v_mul_f32 v235, v235, v115
    v_exp_f32 v232, v232
    v_mfma_f32_16x16x32_bf16 v[24:27], v[208:211], v[176:179], v[24:27]
    v_exp_f32 v233, v233
    v_mfma_f32_16x16x32_bf16 v[24:27], v[212:215], v[180:183], v[24:27]
    v_exp_f32 v234, v234
    v_mfma_f32_16x16x32_bf16 v[28:31], v[208:211], v[184:187], v[28:31]
    v_exp_f32 v235, v235
    v_add_f32 v232, 1.0, v232
    v_mfma_f32_16x16x32_bf16 v[28:31], v[212:215], v[188:191], v[28:31]
    s_waitcnt lgkmcnt(0)
    v_add_f32 v233, 1.0, v233
    v_add_f32 v234, 1.0, v234
    v_mfma_f32_16x16x32_bf16 v[32:35], v[224:227], v[160:163], v[32:35]
    ds_read_b128 v[208:211], v249 offset:52224
    v_add_f32 v235, 1.0, v235
    v_mfma_f32_16x16x32_bf16 v[32:35], v[228:231], v[164:167], v[32:35]
    ds_read_b128 v[212:215], v249 offset:60416
    v_rcp_f32 v232, v232
    v_mfma_f32_16x16x32_bf16 v[36:39], v[224:227], v[168:171], v[36:39]
    v_rcp_f32 v233, v233
    v_mfma_f32_16x16x32_bf16 v[36:39], v[228:231], v[172:175], v[36:39]
    v_rcp_f32 v234, v234
    v_mfma_f32_16x16x32_bf16 v[40:43], v[224:227], v[176:179], v[40:43]
    v_rcp_f32 v235, v235
    v_mul_f32 v112, v112, v232
    v_mfma_f32_16x16x32_bf16 v[40:43], v[228:231], v[180:183], v[40:43]
    v_mul_f32 v113, v113, v233
    v_mul_f32 v114, v114, v234
    v_mul_f32 v115, v115, v235
    v_mfma_f32_16x16x32_bf16 v[44:47], v[224:227], v[184:187], v[44:47]
    s_waitcnt lgkmcnt(0)
    v_cvt_pk_bf16_f32 v66, v112, v113
    v_cvt_pk_bf16_f32 v67, v114, v115
    v_mfma_f32_16x16x32_bf16 v[44:47], v[228:231], v[188:191], v[44:47]
    s_barrier
    v_mul_f32 v232, v116, v116
    v_mul_f32 v233, v117, v117
    v_mul_f32 v234, v118, v118
    v_mfma_f32_16x16x32_bf16 v[48:51], v[208:211], v[160:163], v[48:51]
    ds_read_b128 v[224:227], v249 offset:0
    ds_read_b128 v[160:163], v245 offset:0
    v_mfma_f32_16x16x32_bf16 v[48:51], v[212:215], v[164:167], v[48:51]
    ds_read_b128 v[228:231], v249 offset:8192
    ds_read_b128 v[164:167], v246 offset:0
    v_mfma_f32_16x16x32_bf16 v[52:55], v[208:211], v[168:171], v[52:55]
    ds_read_b128 v[168:171], v245 offset:2048
    v_mul_f32 v235, v119, v119
    v_mfma_f32_16x16x32_bf16 v[52:55], v[212:215], v[172:175], v[52:55]
    ds_read_b128 v[172:175], v246 offset:2048
    v_fma_f32 v232, v232, v239, v238
    v_mfma_f32_16x16x32_bf16 v[56:59], v[208:211], v[176:179], v[56:59]
    ds_read_b128 v[176:179], v245 offset:4096
    v_fma_f32 v233, v233, v239, v238
    v_fma_f32 v234, v234, v239, v238
    v_mfma_f32_16x16x32_bf16 v[56:59], v[212:215], v[180:183], v[56:59]
    ds_read_b128 v[180:183], v246 offset:4096
    v_fma_f32 v235, v235, v239, v238
    v_mfma_f32_16x16x32_bf16 v[60:63], v[208:211], v[184:187], v[60:63]
    ds_read_b128 v[184:187], v245 offset:6144
    v_mul_f32 v232, v232, v116
    v_mfma_f32_16x16x32_bf16 v[60:63], v[212:215], v[188:191], v[60:63]
    ds_read_b128 v[188:191], v246 offset:6144
    s_waitcnt lgkmcnt(5)
    v_mfma_f32_16x16x32_bf16 v[0:3], v[224:227], v[160:163], v[0:3]
    ds_read_b128 v[208:211], v249 offset:1024
    v_mul_f32 v233, v233, v117
    v_mfma_f32_16x16x32_bf16 v[0:3], v[228:231], v[164:167], v[0:3]
    ds_read_b128 v[212:215], v249 offset:9216
    v_mul_f32 v234, v234, v118
    v_mul_f32 v235, v235, v119
    v_mfma_f32_16x16x32_bf16 v[4:7], v[224:227], v[168:171], v[4:7]
    s_waitcnt lgkmcnt(4)
    v_exp_f32 v232, v232
    v_mfma_f32_16x16x32_bf16 v[4:7], v[228:231], v[172:175], v[4:7]
    v_exp_f32 v233, v233
    v_mfma_f32_16x16x32_bf16 v[8:11], v[224:227], v[176:179], v[8:11]
    v_exp_f32 v234, v234
    v_mfma_f32_16x16x32_bf16 v[8:11], v[228:231], v[180:183], v[8:11]
    s_waitcnt lgkmcnt(1)
    v_exp_f32 v235, v235
    v_add_f32 v232, 1.0, v232
    v_add_f32 v233, 1.0, v233
    v_mfma_f32_16x16x32_bf16 v[12:15], v[224:227], v[184:187], v[12:15]
    v_add_f32 v234, 1.0, v234
    v_add_f32 v235, 1.0, v235
    v_mfma_f32_16x16x32_bf16 v[12:15], v[228:231], v[188:191], v[12:15]
    v_rcp_f32 v232, v232
    v_mfma_f32_16x16x32_bf16 v[16:19], v[208:211], v[160:163], v[16:19]
    ds_read_b128 v[224:227], v249 offset:2048
    s_waitcnt lgkmcnt(1)
    v_mfma_f32_16x16x32_bf16 v[16:19], v[212:215], v[164:167], v[16:19]
    ds_read_b128 v[228:231], v249 offset:10240
    v_rcp_f32 v233, v233
    v_mfma_f32_16x16x32_bf16 v[20:23], v[208:211], v[168:171], v[20:23]
    v_rcp_f32 v234, v234
    v_mfma_f32_16x16x32_bf16 v[20:23], v[212:215], v[172:175], v[20:23]
    v_rcp_f32 v235, v235
    v_mul_f32 v116, v116, v232
    v_mfma_f32_16x16x32_bf16 v[24:27], v[208:211], v[176:179], v[24:27]
    v_mul_f32 v117, v117, v233
    v_mul_f32 v118, v118, v234
    v_mul_f32 v119, v119, v235
    v_mfma_f32_16x16x32_bf16 v[24:27], v[212:215], v[180:183], v[24:27]
    v_cvt_pk_bf16_f32 v70, v116, v117
    v_cvt_pk_bf16_f32 v71, v118, v119
    v_mfma_f32_16x16x32_bf16 v[28:31], v[208:211], v[184:187], v[28:31]
    v_mul_f32 v232, v120, v120
    v_mul_f32 v233, v121, v121
    v_mul_f32 v234, v122, v122
    v_mfma_f32_16x16x32_bf16 v[28:31], v[212:215], v[188:191], v[28:31]
    s_waitcnt lgkmcnt(0)
    v_mul_f32 v235, v123, v123
    v_fma_f32 v232, v232, v239, v238
    v_mfma_f32_16x16x32_bf16 v[32:35], v[224:227], v[160:163], v[32:35]
    ds_read_b128 v[208:211], v249 offset:3072
    v_fma_f32 v233, v233, v239, v238
    v_mfma_f32_16x16x32_bf16 v[32:35], v[228:231], v[164:167], v[32:35]
    ds_read_b128 v[212:215], v249 offset:11264
    v_fma_f32 v234, v234, v239, v238
    v_fma_f32 v235, v235, v239, v238
    v_mfma_f32_16x16x32_bf16 v[36:39], v[224:227], v[168:171], v[36:39]
    v_mul_f32 v232, v232, v120
    v_mul_f32 v233, v233, v121
    v_mfma_f32_16x16x32_bf16 v[36:39], v[228:231], v[172:175], v[36:39]
    v_mul_f32 v234, v234, v122
    v_mul_f32 v235, v235, v123
    v_mfma_f32_16x16x32_bf16 v[40:43], v[224:227], v[176:179], v[40:43]
    v_exp_f32 v232, v232
    v_mfma_f32_16x16x32_bf16 v[40:43], v[228:231], v[180:183], v[40:43]
    v_exp_f32 v233, v233
    v_exp_f32 v234, v234
    v_mfma_f32_16x16x32_bf16 v[44:47], v[224:227], v[184:187], v[44:47]
    s_waitcnt lgkmcnt(0)
    v_exp_f32 v235, v235
    v_mfma_f32_16x16x32_bf16 v[44:47], v[228:231], v[188:191], v[44:47]
    s_barrier
    v_add_f32 v232, 1.0, v232
    v_add_f32 v233, 1.0, v233
    v_add_f32 v234, 1.0, v234
    v_mfma_f32_16x16x32_bf16 v[48:51], v[208:211], v[160:163], v[48:51]
    ds_read_b128 v[224:227], v249 offset:16384
    ds_read_b128 v[160:163], v245 offset:16384
    v_mfma_f32_16x16x32_bf16 v[48:51], v[212:215], v[164:167], v[48:51]
    ds_read_b128 v[228:231], v249 offset:24576
    ds_read_b128 v[164:167], v246 offset:16384
    v_mfma_f32_16x16x32_bf16 v[52:55], v[208:211], v[168:171], v[52:55]
    ds_read_b128 v[168:171], v245 offset:18432
    v_add_f32 v235, 1.0, v235
    v_mfma_f32_16x16x32_bf16 v[52:55], v[212:215], v[172:175], v[52:55]
    ds_read_b128 v[172:175], v246 offset:18432
    v_rcp_f32 v232, v232
    v_mfma_f32_16x16x32_bf16 v[56:59], v[208:211], v[176:179], v[56:59]
    ds_read_b128 v[176:179], v245 offset:20480
    v_rcp_f32 v233, v233
    v_mfma_f32_16x16x32_bf16 v[56:59], v[212:215], v[180:183], v[56:59]
    ds_read_b128 v[180:183], v246 offset:20480
    v_mfma_f32_16x16x32_bf16 v[60:63], v[208:211], v[184:187], v[60:63]
    ds_read_b128 v[184:187], v245 offset:22528
    v_rcp_f32 v234, v234
    v_mfma_f32_16x16x32_bf16 v[60:63], v[212:215], v[188:191], v[60:63]
    ds_read_b128 v[188:191], v246 offset:22528
    s_waitcnt lgkmcnt(5)
    v_mfma_f32_16x16x32_bf16 v[0:3], v[224:227], v[160:163], v[0:3]
    ds_read_b128 v[208:211], v249 offset:17408
    v_mfma_f32_16x16x32_bf16 v[0:3], v[228:231], v[164:167], v[0:3]
    ds_read_b128 v[212:215], v249 offset:25600
    v_rcp_f32 v235, v235
    v_mfma_f32_16x16x32_bf16 v[4:7], v[224:227], v[168:171], v[4:7]
    s_waitcnt lgkmcnt(4)
    v_mul_f32 v120, v120, v232
    v_mul_f32 v121, v121, v233
    v_mfma_f32_16x16x32_bf16 v[4:7], v[228:231], v[172:175], v[4:7]
    v_mul_f32 v122, v122, v234
    v_mul_f32 v123, v123, v235
    v_cvt_pk_bf16_f32 v74, v120, v121
    v_mfma_f32_16x16x32_bf16 v[8:11], v[224:227], v[176:179], v[8:11]
    v_cvt_pk_bf16_f32 v75, v122, v123
    v_mul_f32 v232, v124, v124
    v_mfma_f32_16x16x32_bf16 v[8:11], v[228:231], v[180:183], v[8:11]
    s_waitcnt lgkmcnt(1)
    v_mul_f32 v233, v125, v125
    v_mul_f32 v234, v126, v126
    v_mul_f32 v235, v127, v127
    v_mfma_f32_16x16x32_bf16 v[12:15], v[224:227], v[184:187], v[12:15]
    v_fma_f32 v232, v232, v239, v238
    v_fma_f32 v233, v233, v239, v238
    v_mfma_f32_16x16x32_bf16 v[12:15], v[228:231], v[188:191], v[12:15]
    v_fma_f32 v234, v234, v239, v238
    v_fma_f32 v235, v235, v239, v238
    v_mul_f32 v232, v232, v124
    v_mfma_f32_16x16x32_bf16 v[16:19], v[208:211], v[160:163], v[16:19]
    ds_read_b128 v[224:227], v249 offset:18432
    s_waitcnt lgkmcnt(1)
    v_mfma_f32_16x16x32_bf16 v[16:19], v[212:215], v[164:167], v[16:19]
    ds_read_b128 v[228:231], v249 offset:26624
    v_mul_f32 v233, v233, v125
    v_mfma_f32_16x16x32_bf16 v[20:23], v[208:211], v[168:171], v[20:23]
    v_mul_f32 v234, v234, v126
    v_mul_f32 v235, v235, v127
    v_mfma_f32_16x16x32_bf16 v[20:23], v[212:215], v[172:175], v[20:23]
    v_exp_f32 v232, v232
    v_mfma_f32_16x16x32_bf16 v[24:27], v[208:211], v[176:179], v[24:27]
    v_exp_f32 v233, v233
    v_mfma_f32_16x16x32_bf16 v[24:27], v[212:215], v[180:183], v[24:27]
    v_exp_f32 v234, v234
    v_exp_f32 v235, v235
    v_mfma_f32_16x16x32_bf16 v[28:31], v[208:211], v[184:187], v[28:31]
    v_add_f32 v232, 1.0, v232
    v_add_f32 v233, 1.0, v233
    v_mfma_f32_16x16x32_bf16 v[28:31], v[212:215], v[188:191], v[28:31]
    s_waitcnt lgkmcnt(0)
    v_add_f32 v234, 1.0, v234
    v_add_f32 v235, 1.0, v235
    v_mfma_f32_16x16x32_bf16 v[32:35], v[224:227], v[160:163], v[32:35]
    ds_read_b128 v[208:211], v249 offset:19456
    v_rcp_f32 v232, v232
    v_mfma_f32_16x16x32_bf16 v[32:35], v[228:231], v[164:167], v[32:35]
    ds_read_b128 v[212:215], v249 offset:27648
    v_rcp_f32 v233, v233
    v_mfma_f32_16x16x32_bf16 v[36:39], v[224:227], v[168:171], v[36:39]
    s_branch PG3_go
    .p2align 12
PG3:
    s_setpc_b64 s[72:73]
    s_nop 0
PG3_go:
    v_rcp_f32 v234, v234
    v_mfma_f32_16x16x32_bf16 v[36:39], v[228:231], v[172:175], v[36:39]
    v_rcp_f32 v235, v235
    v_mul_f32 v124, v124, v232
    v_mfma_f32_16x16x32_bf16 v[40:43], v[224:227], v[176:179], v[40:43]
    v_mul_f32 v125, v125, v233
    v_mul_f32 v126, v126, v234
    v_mfma_f32_16x16x32_bf16 v[40:43], v[228:231], v[180:183], v[40:43]
    v_mul_f32 v127, v127, v235
    v_cvt_pk_bf16_f32 v78, v124, v125
    v_cvt_pk_bf16_f32 v79, v126, v127
    v_mfma_f32_16x16x32_bf16 v[44:47], v[224:227], v[184:187], v[44:47]
    s_waitcnt lgkmcnt(0)
    v_mul_f32 v232, v128, v128
    v_mul_f32 v233, v129, v129
    v_mfma_f32_16x16x32_bf16 v[44:47], v[228:231], v[188:191], v[44:47]
    s_barrier
    v_mul_f32 v234, v130, v130
    v_mul_f32 v235, v131, v131
    v_fma_f32 v232, v232, v239, v238
    v_mfma_f32_16x16x32_bf16 v[48:51], v[208:211], v[160:163], v[48:51]
    ds_read_b128 v[224:227], v249 offset:32768
    ds_read_b128 v[160:163], v245 offset:32768
    v_mfma_f32_16x16x32_bf16 v[48:51], v[212:215], v[164:167], v[48:51]
    ds_read_b128 v[228:231], v249 offset:40960
    ds_read_b128 v[164:167], v246 offset:32768
    v_mfma_f32_16x16x32_bf16 v[52:55], v[208:211], v[168:171], v[52:55]
    ds_read_b128 v[168:171], v245 offset:34816
    v_fma_f32 v233, v233, v239, v238
    v_mfma_f32_16x16x32_bf16 v[52:55], v[212:215], v[172:175], v[52:55]
    ds_read_b128 v[172:175], v246 offset:34816
    v_fma_f32 v234, v234, v239, v238
    v_mfma_f32_16x16x32_bf16 v[56:59], v[208:211], v[176:179], v[56:59]
    ds_read_b128 v[176:179], v245 offset:36864
    v_fma_f32 v235, v235, v239, v238
    v_mfma_f32_16x16x32_bf16 v[56:59], v[212:215], v[180:183], v[56:59]
    ds_read_b128 v[180:183], v246 offset:36864
    v_mul_f32 v232, v232, v128
    v_mul_f32 v233, v233, v129
    v_mfma_f32_16x16x32_bf16 v[60:63], v[208:211], v[184:187], v[60:63]
    ds_read_b128 v[184:187], v245 offset:38912
    v_mul_f32 v234, v234, v130
    v_mfma_f32_16x16x32_bf16 v[60:63], v[212:215], v[188:191], v[60:63]
    ds_read_b128 v[188:191], v246 offset:38912
    s_waitcnt lgkmcnt(5)
    v_mfma_f32_16x16x32_bf16 v[0:3], v[224:227], v[160:163], v[0:3]
    ds_read_b128 v[208:211], v249 offset:33792
    v_mul_f32 v235, v235, v131
    v_mfma_f32_16x16x32_bf16 v[0:3], v[228:231], v[164:167], v[0:3]
    ds_read_b128 v[212:215], v249 offset:41984
    v_exp_f32 v232, v232
    v_mfma_f32_16x16x32_bf16 v[4:7], v[224:227], v[168:171], v[4:7]
    s_waitcnt lgkmcnt(4)
    v_exp_f32 v233, v233
    v_mfma_f32_16x16x32_bf16 v[4:7], v[228:231], v[172:175], v[4:7]
    v_exp_f32 v234, v234
    v_mfma_f32_16x16x32_bf16 v[8:11], v[224:227], v[176:179], v[8:11]
    v_exp_f32 v235, v235
    v_add_f32 v232, 1.0, v232
    v_mfma_f32_16x16x32_bf16 v[8:11], v[228:231], v[180:183], v[8:11]
    s_waitcnt lgkmcnt(1)
    v_add_f32 v233, 1.0, v233
    v_add_f32 v234, 1.0, v234
    v_mfma_f32_16x16x32_bf16 v[12:15], v[224:227], v[184:187], v[12:15]
    v_add_f32 v235, 1.0, v235
    v_rcp_f32 v232, v232
    v_mfma_f32_16x16x32_bf16 v[12:15], v[228:231], v[188:191], v[12:15]
    v_rcp_f32 v233, v233
    v_mfma_f32_16x16x32_bf16 v[16:19], v[208:211], v[160:163], v[16:19]
    ds_read_b128 v[224:227], v249 offset:34816
    s_waitcnt lgkmcnt(1)
    v_mfma_f32_16x16x32_bf16 v[16:19], v[212:215], v[164:167], v[16:19]
    ds_read_b128 v[228:231], v249 offset:43008
    v_rcp_f32 v234, v234
    v_mfma_f32_16x16x32_bf16 v[20:23], v[208:211], v[168:171], v[20:23]
    v_rcp_f32 v235, v235
    v_mfma_f32_16x16x32_bf16 v[20:23], v[212:215], v[172:175], v[20:23]
    v_mul_f32 v128, v128, v232
    v_mul_f32 v129, v129, v233
    v_mul_f32 v130, v130, v234
    v_mfma_f32_16x16x32_bf16 v[24:27], v[208:211], v[176:179], v[24:27]
    v_mul_f32 v131, v131, v235
    v_cvt_pk_bf16_f32 v80, v128, v129
    v_mfma_f32_16x16x32_bf16 v[24:27], v[212:215], v[180:183], v[24:27]
    v_cvt_pk_bf16_f32 v81, v130, v131
    v_mul_f32 v232, v132, v132
    v_mul_f32 v233, v133, v133
    v_mfma_f32_16x16x32_bf16 v[28:31], v[208:211], v[184:187], v[28:31]
    v_mul_f32 v234, v134, v134
    v_mul_f32 v235, v135, v135
    v_mfma_f32_16x16x32_bf16 v[28:31], v[212:215], v[188:191], v[28:31]
    s_waitcnt lgkmcnt(0)
    v_fma_f32 v232, v232, v239, v238
    v_fma_f32 v233, v233, v239, v238
    v_fma_f32 v234, v234, v239, v238
    v_mfma_f32_16x16x32_bf16 v[32:35], v[224:227], v[160:163], v[32:35]
    ds_read_b128 v[208:211], v249 offset:35840
    v_fma_f32 v235, v235, v239, v238
    v_mfma_f32_16x16x32_bf16 v[32:35], v[228:231], v[164:167], v[32:35]
    ds_read_b128 v[212:215], v249 offset:44032
    v_mul_f32 v232, v232, v132
    v_mfma_f32_16x16x32_bf16 v[36:39], v[224:227], v[168:171], v[36:39]
    v_mul_f32 v233, v233, v133
    v_mul_f32 v234, v234, v134
    v_mul_f32 v235, v235, v135
    v_mfma_f32_16x16x32_bf16 v[36:39], v[228:231], v[172:175], v[36:39]
    v_exp_f32 v232, v232
    v_mfma_f32_16x16x32_bf16 v[40:43], v[224:227], v[176:179], v[40:43]
    v_exp_f32 v233, v233
    v_mfma_f32_16x16x32_bf16 v[40:43], v[228:231], v[180:183], v[40:43]
    v_exp_f32 v234, v234
    v_mfma_f32_16x16x32_bf16 v[44:47], v[224:227], v[184:187], v[44:47]
    s_waitcnt lgkmcnt(0)
    v_exp_f32 v235, v235
    v_add_f32 v232, 1.0, v232
    v_add_f32 v233, 1.0, v233
    v_mfma_f32_16x16x32_bf16 v[44:47], v[228:231], v[188:191], v[44:47]
    s_barrier
    v_add_f32 v234, 1.0, v234
    v_add_f32 v235, 1.0, v235
    v_mfma_f32_16x16x32_bf16 v[48:51], v[208:211], v[160:163], v[48:51]
    ds_read_b128 v[224:227], v249 offset:49152
    ds_read_b128 v[160:163], v245 offset:49152
    v_mfma_f32_16x16x32_bf16 v[48:51], v[212:215], v[164:167], v[48:51]
    ds_read_b128 v[228:231], v249 offset:57344
    ds_read_b128 v[164:167], v246 offset:49152
    v_mfma_f32_16x16x32_bf16 v[52:55], v[208:211], v[168:171], v[52:55]
    ds_read_b128 v[168:171], v245 offset:51200
    v_rcp_f32 v232, v232
    v_mfma_f32_16x16x32_bf16 v[52:55], v[212:215], v[172:175], v[52:55]
    ds_read_b128 v[172:175], v246 offset:51200
    v_rcp_f32 v233, v233
    v_mfma_f32_16x16x32_bf16 v[56:59], v[208:211], v[176:179], v[56:59]
    ds_read_b128 v[176:179], v245 offset:53248
    v_mfma_f32_16x16x32_bf16 v[56:59], v[212:215], v[180:183], v[56:59]
    ds_read_b128 v[180:183], v246 offset:53248
    v_rcp_f32 v234, v234
    v_mfma_f32_16x16x32_bf16 v[60:63], v[208:211], v[184:187], v[60:63]
    ds_read_b128 v[184:187], v245 offset:55296
    v_rcp_f32 v235, v235
    v_mfma_f32_16x16x32_bf16 v[60:63], v[212:215], v[188:191], v[60:63]
    ds_read_b128 v[188:191], v246 offset:55296
    s_waitcnt lgkmcnt(5)
    v_mfma_f32_16x16x32_bf16 v[0:3], v[224:227], v[160:163], v[0:3]
    ds_read_b128 v[208:211], v249 offset:50176
    v_mul_f32 v132, v132, v232
    v_mfma_f32_16x16x32_bf16 v[0:3], v[228:231], v[164:167], v[0:3]
    ds_read_b128 v[212:215], v249 offset:58368
    v_mul_f32 v133, v133, v233
    v_mfma_f32_16x16x32_bf16 v[4:7], v[224:227], v[168:171], v[4:7]
    s_waitcnt lgkmcnt(4)
    v_mul_f32 v134, v134, v234
    v_mul_f32 v135, v135, v235
    v_mfma_f32_16x16x32_bf16 v[4:7], v[228:231], v[172:175], v[4:7]
    v_cvt_pk_bf16_f32 v84, v132, v133
    v_cvt_pk_bf16_f32 v85, v134, v135
    v_mfma_f32_16x16x32_bf16 v[8:11], v[224:227], v[176:179], v[8:11]
    v_mul_f32 v232, v136, v136
    v_mul_f32 v233, v137, v137
    v_mul_f32 v234, v138, v138
    v_mfma_f32_16x16x32_bf16 v[8:11], v[228:231], v[180:183], v[8:11]
    s_waitcnt lgkmcnt(1)
    v_mul_f32 v235, v139, v139
    v_fma_f32 v232, v232, v239, v238
    v_mfma_f32_16x16x32_bf16 v[12:15], v[224:227], v[184:187], v[12:15]
    v_fma_f32 v233, v233, v239, v238
    v_fma_f32 v234, v234, v239, v238
    v_fma_f32 v235, v235, v239, v238
    v_mfma_f32_16x16x32_bf16 v[12:15], v[228:231], v[188:191], v[12:15]
    v_mul_f32 v232, v232, v136
    v_mul_f32 v233, v233, v137
    v_mfma_f32_16x16x32_bf16 v[16:19], v[208:211], v[160:163], v[16:19]
    ds_read_b128 v[224:227], v249 offset:51200
    s_waitcnt lgkmcnt(1)
    v_mfma_f32_16x16x32_bf16 v[16:19], v[212:215], v[164:167], v[16:19]
    ds_read_b128 v[228:231], v249 offset:59392
    v_mul_f32 v234, v234, v138
    v_mul_f32 v235, v235, v139
    v_mfma_f32_16x16x32_bf16 v[20:23], v[208:211], v[168:171], v[20:23]
    v_exp_f32 v232, v232
    v_mfma_f32_16x16x32_bf16 v[20:23], v[212:215], v[172:175], v[20:23]
    v_exp_f32 v233, v233
    v_mfma_f32_16x16x32_bf16 v[24:27], v[208:211], v[176:179], v[24:27]
    v_exp_f32 v234, v234
    v_mfma_f32_16x16x32_bf16 v[24:27], v[212:215], v[180:183], v[24:27]
    v_exp_f32 v235, v235
    v_add_f32 v232, 1.0, v232
    v_add_f32 v233, 1.0, v233
    v_mfma_f32_16x16x32_bf16 v[28:31], v[208:211], v[184:187], v[28:31]
    v_add_f32 v234, 1.0, v234
    v_add_f32 v235, 1.0, v235
    v_mfma_f32_16x16x32_bf16 v[28:31], v[212:215], v[188:191], v[28:31]
    s_waitcnt lgkmcnt(0)
    v_rcp_f32 v232, v232
    v_mfma_f32_16x16x32_bf16 v[32:35], v[224:227], v[160:163], v[32:35]
    ds_read_b128 v[208:211], v249 offset:52224
    v_rcp_f32 v233, v233
    v_mfma_f32_16x16x32_bf16 v[32:35], v[228:231], v[164:167], v[32:35]
    ds_read_b128 v[212:215], v249 offset:60416
    v_rcp_f32 v234, v234
    v_mfma_f32_16x16x32_bf16 v[36:39], v[224:227], v[168:171], v[36:39]
    v_rcp_f32 v235, v235
    v_mfma_f32_16x16x32_bf16 v[36:39], v[228:231], v[172:175], v[36:39]
    v_mul_f32 v136, v136, v232
    v_mul_f32 v137, v137, v233
    v_mfma_f32_16x16x32_bf16 v[40:43], v[224:227], v[176:179], v[40:43]
    v_mul_f32 v138, v138, v234
    v_mul_f32 v139, v139, v235
    v_cvt_pk_bf16_f32 v88, v136, v137
    v_mfma_f32_16x16x32_bf16 v[40:43], v[228:231], v[180:183], v[40:43]
    v_cvt_pk_bf16_f32 v89, v138, v139
    v_mul_f32 v232, v140, v140
    v_mfma_f32_16x16x32_bf16 v[44:47], v[224:227], v[184:187], v[44:47]
    s_waitcnt lgkmcnt(0)
    v_mul_f32 v233, v141, v141
    v_mul_f32 v234, v142, v142
    v_mul_f32 v235, v143, v143
    v_mfma_f32_16x16x32_bf16 v[44:47], v[228:231], v[188:191], v[44:47]
    s_barrier
    v_fma_f32 v232, v232, v239, v238
    v_fma_f32 v233, v233, v239, v238
    v_mfma_f32_16x16x32_bf16 v[48:51], v[208:211], v[160:163], v[48:51]
    ds_read_b128 v[224:227], v249 offset:0
    ds_read_b128 v[160:163], v245 offset:0
    v_mfma_f32_16x16x32_bf16 v[48:51], v[212:215], v[164:167], v[48:51]
    ds_read_b128 v[228:231], v249 offset:8192
    ds_read_b128 v[164:167], v246 offset:0
    v_mfma_f32_16x16x32_bf16 v[52:55], v[208:211], v[168:171], v[52:55]
    ds_read_b128 v[168:171], v245 offset:2048
    v_fma_f32 v234, v234, v239, v238
    v_mfma_f32_16x16x32_bf16 v[52:55], v[212:215], v[172:175], v[52:55]
    ds_read_b128 v[172:175], v246 offset:2048
    v_fma_f32 v235, v235, v239, v238
    v_mul_f32 v232, v232, v140
    v_mfma_f32_16x16x32_bf16 v[56:59], v[208:211], v[176:179], v[56:59]
    ds_read_b128 v[176:179], v245 offset:4096
    v_mul_f32 v233, v233, v141
    v_mfma_f32_16x16x32_bf16 v[56:59], v[212:215], v[180:183], v[56:59]
    ds_read_b128 v[180:183], v246 offset:4096
    v_mul_f32 v234, v234, v142
    v_mfma_f32_16x16x32_bf16 v[60:63], v[208:211], v[184:187], v[60:63]
    ds_read_b128 v[184:187], v245 offset:6144
    v_mul_f32 v235, v235, v143
    v_mfma_f32_16x16x32_bf16 v[60:63], v[212:215], v[188:191], v[60:63]
    ds_read_b128 v[188:191], v246 offset:6144
    s_waitcnt lgkmcnt(5)
    v_mfma_f32_16x16x32_bf16 v[0:3], v[224:227], v[160:163], v[0:3]
    ds_read_b128 v[208:211], v249 offset:1024
    v_exp_f32 v232, v232
    v_mfma_f32_16x16x32_bf16 v[0:3], v[228:231], v[164:167], v[0:3]
    ds_read_b128 v[212:215], v249 offset:9216
    v_exp_f32 v233, v233
    v_mfma_f32_16x16x32_bf16 v[4:7], v[224:227], v[168:171], v[4:7]
    s_waitcnt lgkmcnt(4)
    v_exp_f32 v234, v234
    v_mfma_f32_16x16x32_bf16 v[4:7], v[228:231], v[172:175], v[4:7]
    v_exp_f32 v235, v235
    v_mfma_f32_16x16x32_bf16 v[8:11], v[224:227], v[176:179], v[8:11]
    v_add_f32 v232, 1.0, v232
    v_add_f32 v233, 1.0, v233
    v_add_f32 v234, 1.0, v234
    v_mfma_f32_16x16x32_bf16 v[8:11], v[228:231], v[180:183], v[8:11]
    s_waitcnt lgkmcnt(1)
    v_add_f32 v235, 1.0, v235
    v_rcp_f32 v232, v232
    v_mfma_f32_16x16x32_bf16 v[12:15], v[224:227], v[184:187], v[12:15]
    v_rcp_f32 v233, v233
    v_mfma_f32_16x16x32_bf16 v[12:15], v[228:231], v[188:191], v[12:15]
    v_rcp_f32 v234, v234
    v_mfma_f32_16x16x32_bf16 v[16:19], v[208:211], v[160:163], v[16:19]
    ds_read_b128 v[224:227], v249 offset:2048
    s_waitcnt lgkmcnt(1)
    v_mfma_f32_16x16x32_bf16 v[16:19], v[212:215], v[164:167], v[16:19]
    ds_read_b128 v[228:231], v249 offset:10240
    v_rcp_f32 v235, v235
    v_mfma_f32_16x16x32_bf16 v[20:23], v[208:211], v[168:171], v[20:23]
    v_mul_f32 v140, v140, v232
    v_mul_f32 v141, v141, v233
    v_mfma_f32_16x16x32_bf16 v[20:23], v[212:215], v[172:175], v[20:23]
    v_mul_f32 v142, v142, v234
    v_mul_f32 v143, v143, v235
    v_mfma_f32_16x16x32_bf16 v[24:27], v[208:211], v[176:179], v[24:27]
    v_cvt_pk_bf16_f32 v92, v140, v141
    v_cvt_pk_bf16_f32 v93, v142, v143
    v_mul_f32 v232, v144, v144
    v_mfma_f32_16x16x32_bf16 v[24:27], v[212:215], v[180:183], v[24:27]
    v_mul_f32 v233, v145, v145
    v_mul_f32 v234, v146, v146
    v_mfma_f32_16x16x32_bf16 v[28:31], v[208:211], v[184:187], v[28:31]
    v_mul_f32 v235, v147, v147
    v_fma_f32 v232, v232, v239, v238
    v_fma_f32 v233, v233, v239, v238
    v_mfma_f32_16x16x32_bf16 v[28:31], v[212:215], v[188:191], v[28:31]
    s_waitcnt lgkmcnt(0)
    v_fma_f32 v234, v234, v239, v238
    v_fma_f32 v235, v235, v239, v238
    v_mfma_f32_16x16x32_bf16 v[32:35], v[224:227], v[160:163], v[32:35]
    ds_read_b128 v[208:211], v249 offset:3072
    v_mul_f32 v232, v232, v144
    v_mul_f32 v233, v233, v145
    v_mfma_f32_16x16x32_bf16 v[32:35], v[228:231], v[164:167], v[32:35]
    ds_read_b128 v[212:215], v249 offset:11264
    v_mul_f32 v234, v234, v146
    v_mfma_f32_16x16x32_bf16 v[36:39], v[224:227], v[168:171], v[36:39]
    v_mul_f32 v235, v235, v147
    v_exp_f32 v232, v232
    v_mfma_f32_16x16x32_bf16 v[36:39], v[228:231], v[172:175], v[36:39]
    v_exp_f32 v233, v233
    v_mfma_f32_16x16x32_bf16 v[40:43], v[224:227], v[176:179], v[40:43]
    v_exp_f32 v234, v234
    v_mfma_f32_16x16x32_bf16 v[40:43], v[228:231], v[180:183], v[40:43]
    v_exp_f32 v235, v235
    v_add_f32 v232, 1.0, v232
    v_mfma_f32_16x16x32_bf16 v[44:47], v[224:227], v[184:187], v[44:47]
    s_waitcnt lgkmcnt(0)
    v_add_f32 v233, 1.0, v233
    v_add_f32 v234, 1.0, v234
    v_mfma_f32_16x16x32_bf16 v[44:47], v[228:231], v[188:191], v[44:47]
    s_barrier
    v_add_f32 v235, 1.0, v235
    v_rcp_f32 v232, v232
    v_mfma_f32_16x16x32_bf16 v[48:51], v[208:211], v[160:163], v[48:51]
    ds_read_b128 v[224:227], v249 offset:16384
    ds_read_b128 v[160:163], v245 offset:16384
    v_mfma_f32_16x16x32_bf16 v[48:51], v[212:215], v[164:167], v[48:51]
    ds_read_b128 v[228:231], v249 offset:24576
    ds_read_b128 v[164:167], v246 offset:16384
    v_mfma_f32_16x16x32_bf16 v[52:55], v[208:211], v[168:171], v[52:55]
    ds_read_b128 v[168:171], v245 offset:18432
    v_rcp_f32 v233, v233
    v_mfma_f32_16x16x32_bf16 v[52:55], v[212:215], v[172:175], v[52:55]
    ds_read_b128 v[172:175], v246 offset:18432
    v_rcp_f32 v234, v234
    v_mfma_f32_16x16x32_bf16 v[56:59], v[208:211], v[176:179], v[56:59]
    ds_read_b128 v[176:179], v245 offset:20480
    v_mfma_f32_16x16x32_bf16 v[56:59], v[212:215], v[180:183], v[56:59]
    ds_read_b128 v[180:183], v246 offset:20480
    v_rcp_f32 v235, v235
    v_mfma_f32_16x16x32_bf16 v[60:63], v[208:211], v[184:187], v[60:63]
    ds_read_b128 v[184:187], v245 offset:22528
    v_mul_f32 v144, v144, v232
    v_mfma_f32_16x16x32_bf16 v[60:63], v[212:215], v[188:191], v[60:63]
    ds_read_b128 v[188:191], v246 offset:22528
    s_waitcnt lgkmcnt(5)
    v_mfma_f32_16x16x32_bf16 v[0:3], v[224:227], v[160:163], v[0:3]
    ds_read_b128 v[208:211], v249 offset:17408
    v_mul_f32 v145, v145, v233
    v_mfma_f32_16x16x32_bf16 v[0:3], v[228:231], v[164:167], v[0:3]
    ds_read_b128 v[212:215], v249 offset:25600
    v_mul_f32 v146, v146, v234
    v_mfma_f32_16x16x32_bf16 v[4:7], v[224:227], v[168:171], v[4:7]
    s_waitcnt lgkmcnt(4)
    v_mul_f32 v147, v147, v235
    v_cvt_pk_bf16_f32 v82, v144, v145
    v_mfma_f32_16x16x32_bf16 v[4:7], v[228:231], v[172:175], v[4:7]
    v_cvt_pk_bf16_f32 v83, v146, v147
    v_mul_f32 v232, v148, v148
    v_mul_f32 v233, v149, v149
    v_mfma_f32_16x16x32_bf16 v[8:11], v[224:227], v[176:179], v[8:11]
    v_mul_f32 v234, v150, v150
    v_mul_f32 v235, v151, v151
    v_mfma_f32_16x16x32_bf16 v[8:11], v[228:231], v[180:183], v[8:11]
    s_waitcnt lgkmcnt(1)
    v_fma_f32 v232, v232, v239, v238
    v_fma_f32 v233, v233, v239, v238
    v_fma_f32 v234, v234, v239, v238
    v_mfma_f32_16x16x32_bf16 v[12:15], v[224:227], v[184:187], v[12:15]
    v_fma_f32 v235, v235, v239, v238
    v_mul_f32 v232, v232, v148
    v_mfma_f32_16x16x32_bf16 v[12:15], v[228:231], v[188:191], v[12:15]
    v_mul_f32 v233, v233, v149
    v_mul_f32 v234, v234, v150
    v_mul_f32 v235, v235, v151
    v_mfma_f32_16x16x32_bf16 v[16:19], v[208:211], v[160:163], v[16:19]
    ds_read_b128 v[224:227], v249 offset:18432
    s_waitcnt lgkmcnt(1)
    v_mfma_f32_16x16x32_bf16 v[16:19], v[212:215], v[164:167], v[16:19]
    ds_read_b128 v[228:231], v249 offset:26624
    v_exp_f32 v232, v232
    v_mfma_f32_16x16x32_bf16 v[20:23], v[208:211], v[168:171], v[20:23]
    v_exp_f32 v233, v233
    v_mfma_f32_16x16x32_bf16 v[20:23], v[212:215], v[172:175], v[20:23]
    v_exp_f32 v234, v234
    v_mfma_f32_16x16x32_bf16 v[24:27], v[208:211], v[176:179], v[24:27]
    v_exp_f32 v235, v235
    v_add_f32 v232, 1.0, v232
    v_mfma_f32_16x16x32_bf16 v[24:27], v[212:215], v[180:183], v[24:27]
    v_add_f32 v233, 1.0, v233
    v_add_f32 v234, 1.0, v234
    v_mfma_f32_16x16x32_bf16 v[28:31], v[208:211], v[184:187], v[28:31]
    v_add_f32 v235, 1.0, v235
    v_rcp_f32 v232, v232
    v_mfma_f32_16x16x32_bf16 v[28:31], v[212:215], v[188:191], v[28:31]
    s_waitcnt lgkmcnt(0)
    v_rcp_f32 v233, v233
    v_mfma_f32_16x16x32_bf16 v[32:35], v[224:227], v[160:163], v[32:35]
    ds_read_b128 v[208:211], v249 offset:19456
    v_rcp_f32 v234, v234
    v_mfma_f32_16x16x32_bf16 v[32:35], v[228:231], v[164:167], v[32:35]
    ds_read_b128 v[212:215], v249 offset:27648
    v_rcp_f32 v235, v235
    v_mfma_f32_16x16x32_bf16 v[36:39], v[224:227], v[168:171], v[36:39]
    v_mul_f32 v148, v148, v232
    v_mul_f32 v149, v149, v233
    v_mfma_f32_16x16x32_bf16 v[36:39], v[228:231], v[172:175], v[36:39]
    v_mul_f32 v150, v150, v234
    v_mul_f32 v151, v151, v235
    v_mfma_f32_16x16x32_bf16 v[40:43], v[224:227], v[176:179], v[40:43]
    v_cvt_pk_bf16_f32 v86, v148, v149
    v_cvt_pk_bf16_f32 v87, v150, v151
    v_mfma_f32_16x16x32_bf16 v[40:43], v[228:231], v[180:183], v[40:43]
    v_mul_f32 v232, v152, v152
    v_mul_f32 v233, v153, v153
    v_mul_f32 v234, v154, v154
    v_mfma_f32_16x16x32_bf16 v[44:47], v[224:227], v[184:187], v[44:47]
    s_waitcnt lgkmcnt(0)
    v_mul_f32 v235, v155, v155
    v_fma_f32 v232, v232, v239, v238
    v_mfma_f32_16x16x32_bf16 v[44:47], v[228:231], v[188:191], v[44:47]
    s_barrier
    v_fma_f32 v233, v233, v239, v238
    v_fma_f32 v234, v234, v239, v238
    v_fma_f32 v235, v235, v239, v238
    v_mfma_f32_16x16x32_bf16 v[48:51], v[208:211], v[160:163], v[48:51]
    ds_read_b128 v[224:227], v249 offset:32768
    ds_read_b128 v[160:163], v245 offset:32768
    v_mfma_f32_16x16x32_bf16 v[48:51], v[212:215], v[164:167], v[48:51]
    ds_read_b128 v[228:231], v249 offset:40960
    ds_read_b128 v[164:167], v246 offset:32768
    v_mfma_f32_16x16x32_bf16 v[52:55], v[208:211], v[168:171], v[52:55]
    ds_read_b128 v[168:171], v245 offset:34816
    v_mul_f32 v232, v232, v152
    v_mfma_f32_16x16x32_bf16 v[52:55], v[212:215], v[172:175], v[52:55]
    ds_read_b128 v[172:175], v246 offset:34816
    v_mul_f32 v233, v233, v153
    v_mfma_f32_16x16x32_bf16 v[56:59], v[208:211], v[176:179], v[56:59]
    ds_read_b128 v[176:179], v245 offset:36864
    v_mul_f32 v234, v234, v154
    v_mul_f32 v235, v235, v155
    v_mfma_f32_16x16x32_bf16 v[56:59], v[212:215], v[180:183], v[56:59]
    ds_read_b128 v[180:183], v246 offset:36864
    v_exp_f32 v232, v232
    v_mfma_f32_16x16x32_bf16 v[60:63], v[208:211], v[184:187], v[60:63]
    ds_read_b128 v[184:187], v245 offset:38912
    v_mfma_f32_16x16x32_bf16 v[60:63], v[212:215], v[188:191], v[60:63]
    ds_read_b128 v[188:191], v246 offset:38912
    s_waitcnt lgkmcnt(5)
    v_mfma_f32_16x16x32_bf16 v[0:3], v[224:227], v[160:163], v[0:3]
    ds_read_b128 v[208:211], v249 offset:33792
    v_exp_f32 v233, v233
    v_mfma_f32_16x16x32_bf16 v[0:3], v[228:231], v[164:167], v[0:3]
    ds_read_b128 v[212:215], v249 offset:41984
    v_exp_f32 v234, v234
    v_mfma_f32_16x16x32_bf16 v[4:7], v[224:227], v[168:171], v[4:7]
    s_waitcnt lgkmcnt(4)
    v_exp_f32 v235, v235
    v_mfma_f32_16x16x32_bf16 v[4:7], v[228:231], v[172:175], v[4:7]
    v_add_f32 v232, 1.0, v232
    v_add_f32 v233, 1.0, v233
    v_mfma_f32_16x16x32_bf16 v[8:11], v[224:227], v[176:179], v[8:11]
    v_add_f32 v234, 1.0, v234
    v_add_f32 v235, 1.0, v235
    v_mfma_f32_16x16x32_bf16 v[8:11], v[228:231], v[180:183], v[8:11]
    s_waitcnt lgkmcnt(1)
    v_rcp_f32 v232, v232
    v_mfma_f32_16x16x32_bf16 v[12:15], v[224:227], v[184:187], v[12:15]
    v_rcp_f32 v233, v233
    v_mfma_f32_16x16x32_bf16 v[12:15], v[228:231], v[188:191], v[12:15]
    v_rcp_f32 v234, v234
    v_rcp_f32 v235, v235
    v_mfma_f32_16x16x32_bf16 v[16:19], v[208:211], v[160:163], v[16:19]
    ds_read_b128 v[224:227], v249 offset:34816
    s_waitcnt lgkmcnt(1)
    v_mfma_f32_16x16x32_bf16 v[16:19], v[212:215], v[164:167], v[16:19]
    ds_read_b128 v[228:231], v249 offset:43008
    v_mul_f32 v152, v152, v232
    v_mfma_f32_16x16x32_bf16 v[20:23], v[208:211], v[168:171], v[20:23]
    v_mul_f32 v153, v153, v233
    v_mul_f32 v154, v154, v234
    v_mfma_f32_16x16x32_bf16 v[20:23], v[212:215], v[172:175], v[20:23]
    v_mul_f32 v155, v155, v235
    v_cvt_pk_bf16_f32 v90, v152, v153
    v_cvt_pk_bf16_f32 v91, v154, v155
    v_mfma_f32_16x16x32_bf16 v[24:27], v[208:211], v[176:179], v[24:27]
    v_mul_f32 v232, v156, v156
    v_mul_f32 v233, v157, v157
    v_mfma_f32_16x16x32_bf16 v[24:27], v[212:215], v[180:183], v[24:27]
    v_mul_f32 v234, v158, v158
    v_mul_f32 v235, v159, v159
    v_fma_f32 v232, v232, v239, v238
    v_mfma_f32_16x16x32_bf16 v[28:31], v[208:211], v[184:187], v[28:31]
    v_fma_f32 v233, v233, v239, v238
    v_fma_f32 v234, v234, v239, v238
    v_fma_f32 v235, v235, v239, v238
    v_mfma_f32_16x16x32_bf16 v[28:31], v[212:215], v[188:191], v[28:31]
    s_waitcnt lgkmcnt(0)
    v_mul_f32 v232, v232, v156
    v_mul_f32 v233, v233, v157
    v_mfma_f32_16x16x32_bf16 v[32:35], v[224:227], v[160:163], v[32:35]
    ds_read_b128 v[208:211], v249 offset:35840
    v_mul_f32 v234, v234, v158
    v_mfma_f32_16x16x32_bf16 v[32:35], v[228:231], v[164:167], v[32:35]
    ds_read_b128 v[212:215], v249 offset:44032
    v_mul_f32 v235, v235, v159
    v_mfma_f32_16x16x32_bf16 v[36:39], v[224:227], v[168:171], v[36:39]
    v_exp_f32 v232, v232
    v_mfma_f32_16x16x32_bf16 v[36:39], v[228:231], v[172:175], v[36:39]
    v_exp_f32 v233, v233
    v_exp_f32 v234, v234
    v_mfma_f32_16x16x32_bf16 v[40:43], v[224:227], v[176:179], v[40:43]
    v_exp_f32 v235, v235
    v_mfma_f32_16x16x32_bf16 v[40:43], v[228:231], v[180:183], v[40:43]
    v_add_f32 v232, 1.0, v232
    v_add_f32 v233, 1.0, v233
    v_add_f32 v234, 1.0, v234
    v_mfma_f32_16x16x32_bf16 v[44:47], v[224:227], v[184:187], v[44:47]
    s_waitcnt lgkmcnt(0)
    v_add_f32 v235, 1.0, v235
    v_rcp_f32 v232, v232
    v_mfma_f32_16x16x32_bf16 v[44:47], v[228:231], v[188:191], v[44:47]
    s_barrier
    v_rcp_f32 v233, v233
    v_mfma_f32_16x16x32_bf16 v[48:51], v[208:211], v[160:163], v[48:51]
    ds_read_b128 v[224:227], v249 offset:49152
    ds_read_b128 v[160:163], v245 offset:49152
    v_mfma_f32_16x16x32_bf16 v[48:51], v[212:215], v[164:167], v[48:51]
    ds_read_b128 v[228:231], v249 offset:57344
    ds_read_b128 v[164:167], v246 offset:49152
    v_mfma_f32_16x16x32_bf16 v[52:55], v[208:211], v[168:171], v[52:55]
    ds_read_b128 v[168:171], v245 offset:51200
    v_rcp_f32 v234, v234
    v_mfma_f32_16x16x32_bf16 v[52:55], v[212:215], v[172:175], v[52:55]
    ds_read_b128 v[172:175], v246 offset:51200
    v_mfma_f32_16x16x32_bf16 v[56:59], v[208:211], v[176:179], v[56:59]
    ds_read_b128 v[176:179], v245 offset:53248
    v_rcp_f32 v235, v235
    v_mfma_f32_16x16x32_bf16 v[56:59], v[212:215], v[180:183], v[56:59]
    ds_read_b128 v[180:183], v246 offset:53248
    v_mul_f32 v156, v156, v232
    v_mfma_f32_16x16x32_bf16 v[60:63], v[208:211], v[184:187], v[60:63]
    ds_read_b128 v[184:187], v245 offset:55296
    v_mul_f32 v157, v157, v233
    v_mfma_f32_16x16x32_bf16 v[60:63], v[212:215], v[188:191], v[60:63]
    ds_read_b128 v[188:191], v246 offset:55296
    s_waitcnt lgkmcnt(5)
    v_mfma_f32_16x16x32_bf16 v[0:3], v[224:227], v[160:163], v[0:3]
    ds_read_b128 v[208:211], v249 offset:50176
    v_mul_f32 v158, v158, v234
    v_mfma_f32_16x16x32_bf16 v[0:3], v[228:231], v[164:167], v[0:3]
    ds_read_b128 v[212:215], v249 offset:58368
    v_mul_f32 v159, v159, v235
    v_mfma_f32_16x16x32_bf16 v[4:7], v[224:227], v[168:171], v[4:7]
    s_waitcnt lgkmcnt(4)
    v_cvt_pk_bf16_f32 v94, v156, v157
    v_cvt_pk_bf16_f32 v95, v158, v159
    v_and_b32 v248, 31, v251
    v_mfma_f32_16x16x32_bf16 v[4:7], v[228:231], v[172:175], v[4:7]
    v_lshl_add_u32 v248, v248, 2, s22
    v_and_b32 v255, 15, v251
    v_mfma_f32_16x16x32_bf16 v[8:11], v[224:227], v[176:179], v[8:11]
    v_lshl_add_u32 v255, v255, 2, s22
    v_mov_b32 v96, 0
    v_mov_b32 v97, 0
    v_mfma_f32_16x16x32_bf16 v[8:11], v[228:231], v[180:183], v[8:11]
    s_waitcnt lgkmcnt(1)
    v_mov_b32 v98, 0
    v_mov_b32 v99, 0
    v_mfma_f32_16x16x32_bf16 v[12:15], v[224:227], v[184:187], v[12:15]
    v_mov_b32 v100, 0
    v_mov_b32 v101, 0
    v_mov_b32 v102, 0
    v_mfma_f32_16x16x32_bf16 v[12:15], v[228:231], v[188:191], v[12:15]
    v_mov_b32 v103, 0
    v_mov_b32 v104, 0
    v_mov_b32 v105, 0
    v_mfma_f32_16x16x32_bf16 v[16:19], v[208:211], v[160:163], v[16:19]
    ds_read_b128 v[224:227], v249 offset:51200
    s_waitcnt lgkmcnt(1)
    v_mfma_f32_16x16x32_bf16 v[16:19], v[212:215], v[164:167], v[16:19]
    ds_read_b128 v[228:231], v249 offset:59392
    v_mov_b32 v106, 0
    v_mfma_f32_16x16x32_bf16 v[20:23], v[208:211], v[168:171], v[20:23]
    v_mov_b32 v107, 0
    v_mov_b32 v108, 0
    v_mfma_f32_16x16x32_bf16 v[20:23], v[212:215], v[172:175], v[20:23]
    v_mov_b32 v109, 0
    v_mov_b32 v110, 0
    v_mov_b32 v111, 0
    v_mfma_f32_16x16x32_bf16 v[24:27], v[208:211], v[176:179], v[24:27]
    v_mov_b32 v112, 0
    v_mov_b32 v113, 0
    v_mfma_f32_16x16x32_bf16 v[24:27], v[212:215], v[180:183], v[24:27]
    v_mov_b32 v114, 0
    v_mov_b32 v115, 0
    v_mov_b32 v116, 0
    v_mfma_f32_16x16x32_bf16 v[28:31], v[208:211], v[184:187], v[28:31]
    v_mov_b32 v117, 0
    v_mov_b32 v118, 0
    v_mfma_f32_16x16x32_bf16 v[28:31], v[212:215], v[188:191], v[28:31]
    s_waitcnt lgkmcnt(0)
    v_mov_b32 v119, 0
    v_mov_b32 v120, 0
    v_mov_b32 v121, 0
    v_mfma_f32_16x16x32_bf16 v[32:35], v[224:227], v[160:163], v[32:35]
    ds_read_b128 v[208:211], v249 offset:52224
    v_mov_b32 v122, 0
    v_mfma_f32_16x16x32_bf16 v[32:35], v[228:231], v[164:167], v[32:35]
    ds_read_b128 v[212:215], v249 offset:60416
    v_mov_b32 v123, 0
    v_mfma_f32_16x16x32_bf16 v[36:39], v[224:227], v[168:171], v[36:39]
    v_mov_b32 v124, 0
    v_mov_b32 v125, 0
    v_mov_b32 v126, 0
    v_mfma_f32_16x16x32_bf16 v[36:39], v[228:231], v[172:175], v[36:39]
    v_mov_b32 v127, 0
    v_mov_b32 v232, 0
    v_mfma_f32_16x16x32_bf16 v[40:43], v[224:227], v[176:179], v[40:43]
    v_mov_b32 v233, 0
    v_mov_b32 v234, 0
    v_mov_b32 v235, 0
    v_mfma_f32_16x16x32_bf16 v[40:43], v[228:231], v[180:183], v[40:43]
    v_mov_b32 v236, 0
    v_mov_b32 v237, 0
    v_mfma_f32_16x16x32_bf16 v[44:47], v[224:227], v[184:187], v[44:47]
    s_waitcnt lgkmcnt(0)
    v_mov_b32 v238, 0
    v_mov_b32 v239, 0
    v_mov_b32 v158, 0
    v_mfma_f32_16x16x32_bf16 v[44:47], v[228:231], v[188:191], v[44:47]
    s_barrier
    v_mov_b32 v159, 0
    v_mov_b32 v129, 0x3f803f80
    v_mfma_f32_16x16x32_bf16 v[48:51], v[208:211], v[160:163], v[48:51]
    ds_read_b128 v[160:163], v249 offset:0
    v_and_b32 v128, 6, v251
    v_cmp_eq_u32 vcc, 0, v128
    v_mfma_f32_16x16x32_bf16 v[48:51], v[212:215], v[164:167], v[48:51]
    ds_read_b128 v[164:167], v249 offset:1024
    v_cmp_eq_u32 s[46:47], 4, v128
    v_mfma_f32_16x16x32_bf16 v[52:55], v[208:211], v[168:171], v[52:55]
    ds_read_b128 v[216:219], v250 offset:24576
    v_and_b32 v128, 1, v251
    v_mfma_f32_16x16x32_bf16 v[52:55], v[212:215], v[172:175], v[52:55]
    ds_read_b128 v[220:223], v250 offset:25600
    v_cndmask_b32 v240, 0, v129, vcc
    v_mfma_f32_16x16x32_bf16 v[56:59], v[208:211], v[176:179], v[56:59]
    ds_read_b128 v[176:179], v245 offset:0
    v_cndmask_b32 v241, 0, v129, vcc
    v_cndmask_b32 v242, 0, v129, s[46:47]
    v_mfma_f32_16x16x32_bf16 v[56:59], v[212:215], v[180:183], v[56:59]
    ds_read_b128 v[180:183], v245 offset:2048
    v_cndmask_b32 v243, 0, v129, s[46:47]
    v_mfma_f32_16x16x32_bf16 v[60:63], v[208:211], v[184:187], v[60:63]
    ds_read_b128 v[184:187], v245 offset:4096
    v_sub_u32 v128, 0, v128
    v_mfma_f32_16x16x32_bf16 v[60:63], v[212:215], v[188:191], v[60:63]
    s_branch PG4_go
    .p2align 12
PG4:
    s_setpc_b64 s[72:73]
    s_nop 0
PG4_go:
    ds_read_b128 v[224:227], v250 offset:2048
    v_and_b32 v128, 0xaaaaaaaa, v128
    v_or_b32 v244, 0x44444444, v128
    s_waitcnt lgkmcnt(4)
    v_mfma_f32_32x32x16_bf16 v[128:143], v[216:219], v[192:195], 0
    ds_read_b32 v247, v248 offset:0
    ds_read_b32 v248, v248 offset:128
    ds_read_b32 v252, v255 offset:0
    ds_read_b32 v253, v255 offset:64
    ds_read_b32 v254, v255 offset:128
    ds_read_b32 v255, v255 offset:192
    v_mfma_f32_32x32x16_bf16 v[128:143], v[220:223], v[196:199], v[128:143]
    v_mov_b32 v208, 0
    v_mov_b32 v209, 0
    v_mov_b32 v210, 0
    v_mov_b32 v211, 0
    v_mov_b32 v212, 0
    v_mov_b32 v213, 0
    v_mov_b32 v214, 0
    v_mov_b32 v215, 0
    v_mov_b32 v228, 0
    v_mov_b32 v229, 0
    v_mov_b32 v230, 0
    v_mov_b32 v231, 0
    s_mov_b32 s50, 5
    s_waitcnt lgkmcnt(0)
    .p2align 3
A_fused:
    v_mfma_f32_16x16x32_bf16 v[0:3], v[160:163], v[176:179], v[0:3]
    ds_read_b128 v[188:191], v245 offset:6144
    v_cvt_pk_bf16_f32 v215, v158, v159
    v_mfma_f32_16x16x32_bf16 v[4:7], v[160:163], v[180:183], v[4:7]
    v_exp_f32 v128, v128
    v_mfma_f32_16x16x32_bf16 v[16:19], v[164:167], v[176:179], v[16:19]
    v_exp_f32 v129, v129
    v_mfma_f32_16x16x32_bf16 v[20:23], v[164:167], v[180:183], v[20:23]
    s_waitcnt lgkmcnt(1)
    v_exp_f32 v130, v130
    v_smfmac_f32_16x16x64_bf16 v[236:239], v[240:243], v[208:215], v244
    ds_read_b128 v[168:171], v249 offset:2048
    v_cvt_pk_bf16_f32 v208, v128, v129
    v_mfma_f32_32x32x16_bf16 v[112:127], v[228:231], v[212:215], v[112:127]
    ds_read_b128 v[228:231], v250 offset:3072
    v_exp_f32 v131, v131
    v_exp_f32 v132, v132
    v_cvt_pk_bf16_f32 v209, v130, v131
    v_mfma_f32_32x32x16_bf16 v[144:159], v[216:219], v[200:203], 0
    ds_read_b128 v[216:219], v250 offset:0
    v_exp_f32 v133, v133
    v_exp_f32 v134, v134
    v_cvt_pk_bf16_f32 v210, v132, v133
    v_mfma_f32_32x32x16_bf16 v[144:159], v[220:223], v[204:207], v[144:159]
    ds_read_b128 v[220:223], v250 offset:1024
    v_exp_f32 v135, v135
    v_exp_f32 v136, v136
    v_cvt_pk_bf16_f32 v211, v134, v135
    v_mfma_f32_16x16x32_bf16 v[8:11], v[160:163], v[184:187], v[8:11]
    s_waitcnt lgkmcnt(4)
    v_exp_f32 v137, v137
    v_mfma_f32_32x32x16_bf16 v[96:111], v[224:227], v[208:211], v[96:111]
    ds_read_b128 v[172:175], v249 offset:3072
    v_exp_f32 v138, v138
    v_exp_f32 v139, v139
    v_cvt_pk_bf16_f32 v212, v136, v137
    v_mfma_f32_16x16x32_bf16 v[12:15], v[160:163], v[188:191], v[12:15]
    v_exp_f32 v140, v140
    v_cvt_pk_bf16_f32 v213, v138, v139
    v_mfma_f32_16x16x32_bf16 v[24:27], v[164:167], v[184:187], v[24:27]
    v_exp_f32 v141, v141
    v_exp_f32 v142, v142
    v_mfma_f32_16x16x32_bf16 v[28:31], v[164:167], v[188:191], v[28:31]
    s_waitcnt lgkmcnt(0)
    v_cvt_pk_bf16_f32 v214, v140, v141
    v_exp_f32 v143, v143
    v_mfma_f32_16x16x32_bf16 v[40:43], v[168:171], v[184:187], v[40:43]
    v_cvt_pk_bf16_f32 v215, v142, v143
    v_exp_f32 v144, v144
    v_mfma_f32_16x16x32_bf16 v[44:47], v[168:171], v[188:191], v[44:47]
    v_exp_f32 v145, v145
    v_mfma_f32_16x16x32_bf16 v[56:59], v[172:175], v[184:187], v[56:59]
    v_exp_f32 v146, v146
    v_mfma_f32_16x16x32_bf16 v[60:63], v[172:175], v[188:191], v[60:63]
    v_exp_f32 v147, v147
    v_smfmac_f32_16x16x64_bf16 v[232:235], v[240:243], v[208:215], v244
    ds_read_b128 v[160:163], v249 offset:8192
    v_cvt_pk_bf16_f32 v208, v144, v145
    v_mfma_f32_32x32x16_bf16 v[96:111], v[228:231], v[212:215], v[96:111]
    ds_read_b128 v[184:187], v246 offset:4096
    v_exp_f32 v148, v148
    v_exp_f32 v149, v149
    v_cvt_pk_bf16_f32 v209, v146, v147
    v_mfma_f32_32x32x16_bf16 v[128:143], v[216:219], v[192:195], 0
    ds_read_b128 v[188:191], v246 offset:6144
    v_exp_f32 v150, v150
    v_exp_f32 v151, v151
    v_cvt_pk_bf16_f32 v210, v148, v149
    v_mfma_f32_32x32x16_bf16 v[128:143], v[220:223], v[196:199], v[128:143]
    ds_read_b128 v[164:167], v249 offset:9216
    v_exp_f32 v152, v152
    v_cvt_pk_bf16_f32 v211, v150, v151
    v_exp_f32 v153, v153
    v_mfma_f32_16x16x32_bf16 v[32:35], v[168:171], v[176:179], v[32:35]
    v_exp_f32 v154, v154
    v_mfma_f32_32x32x16_bf16 v[112:127], v[224:227], v[208:211], v[112:127]
    ds_read_b128 v[224:227], v250 offset:6144
    v_exp_f32 v155, v155
    v_cvt_pk_bf16_f32 v212, v152, v153
    v_exp_f32 v156, v156
    v_mfma_f32_16x16x32_bf16 v[36:39], v[168:171], v[180:183], v[36:39]
    v_cvt_pk_bf16_f32 v213, v154, v155
    v_exp_f32 v157, v157
    v_mfma_f32_16x16x32_bf16 v[48:51], v[172:175], v[176:179], v[48:51]
    ds_read_b128 v[176:179], v246 offset:0
    v_exp_f32 v158, v158
    v_mfma_f32_16x16x32_bf16 v[52:55], v[172:175], v[180:183], v[52:55]
    s_waitcnt lgkmcnt(2)
    v_cvt_pk_bf16_f32 v214, v156, v157
    v_exp_f32 v159, v159
    v_mfma_f32_16x16x32_bf16 v[8:11], v[160:163], v[184:187], v[8:11]
    ds_read_b128 v[180:183], v246 offset:2048
    v_cvt_pk_bf16_f32 v215, v158, v159
    v_mfma_f32_16x16x32_bf16 v[12:15], v[160:163], v[188:191], v[12:15]
    v_exp_f32 v128, v128
    v_mfma_f32_16x16x32_bf16 v[24:27], v[164:167], v[184:187], v[24:27]
    v_exp_f32 v129, v129
    v_mfma_f32_16x16x32_bf16 v[28:31], v[164:167], v[188:191], v[28:31]
    s_waitcnt lgkmcnt(1)
    v_exp_f32 v130, v130
    v_smfmac_f32_16x16x64_bf16 v[236:239], v[240:243], v[208:215], v244
    ds_read_b128 v[168:171], v249 offset:10240
    v_cvt_pk_bf16_f32 v208, v128, v129
    v_mfma_f32_32x32x16_bf16 v[112:127], v[228:231], v[212:215], v[112:127]
    ds_read_b128 v[228:231], v250 offset:7168
    v_exp_f32 v131, v131
    v_exp_f32 v132, v132
    v_cvt_pk_bf16_f32 v209, v130, v131
    v_mfma_f32_32x32x16_bf16 v[144:159], v[216:219], v[200:203], 0
    ds_read_b128 v[216:219], v250 offset:4096
    v_exp_f32 v133, v133
    v_exp_f32 v134, v134
    v_cvt_pk_bf16_f32 v210, v132, v133
    v_mfma_f32_32x32x16_bf16 v[144:159], v[220:223], v[204:207], v[144:159]
    ds_read_b128 v[220:223], v250 offset:5120
    v_exp_f32 v135, v135
    v_exp_f32 v136, v136
    v_cvt_pk_bf16_f32 v211, v134, v135
    v_mfma_f32_16x16x32_bf16 v[0:3], v[160:163], v[176:179], v[0:3]
    s_waitcnt lgkmcnt(4)
    v_exp_f32 v137, v137
    v_mfma_f32_32x32x16_bf16 v[96:111], v[224:227], v[208:211], v[96:111]
    ds_read_b128 v[172:175], v249 offset:11264
    v_exp_f32 v138, v138
    v_exp_f32 v139, v139
    v_cvt_pk_bf16_f32 v212, v136, v137
    v_mfma_f32_16x16x32_bf16 v[4:7], v[160:163], v[180:183], v[4:7]
    v_exp_f32 v140, v140
    v_cvt_pk_bf16_f32 v213, v138, v139
    v_mfma_f32_16x16x32_bf16 v[16:19], v[164:167], v[176:179], v[16:19]
    v_exp_f32 v141, v141
    v_exp_f32 v142, v142
    v_mfma_f32_16x16x32_bf16 v[20:23], v[164:167], v[180:183], v[20:23]
    s_waitcnt lgkmcnt(0)
    v_cvt_pk_bf16_f32 v214, v140, v141
    v_exp_f32 v143, v143
    v_mfma_f32_16x16x32_bf16 v[32:35], v[168:171], v[176:179], v[32:35]
    s_barrier
    v_cvt_pk_bf16_f32 v215, v142, v143
    v_exp_f32 v144, v144
    v_mfma_f32_16x16x32_bf16 v[36:39], v[168:171], v[180:183], v[36:39]
    v_exp_f32 v145, v145
    v_mfma_f32_16x16x32_bf16 v[48:51], v[172:175], v[176:179], v[48:51]
    v_exp_f32 v146, v146
    v_mfma_f32_16x16x32_bf16 v[52:55], v[172:175], v[180:183], v[52:55]
    v_exp_f32 v147, v147
    v_smfmac_f32_16x16x64_bf16 v[232:235], v[240:243], v[208:215], v244
    ds_read_b128 v[160:163], v249 offset:16384
    v_cvt_pk_bf16_f32 v208, v144, v145
    v_mfma_f32_32x32x16_bf16 v[96:111], v[228:231], v[212:215], v[96:111]
    ds_read_b128 v[176:179], v245 offset:16384
    v_exp_f32 v148, v148
    v_exp_f32 v149, v149
    v_cvt_pk_bf16_f32 v209, v146, v147
    v_mfma_f32_32x32x16_bf16 v[128:143], v[216:219], v[192:195], 0
    ds_read_b128 v[180:183], v245 offset:18432
    v_exp_f32 v150, v150
    v_exp_f32 v151, v151
    v_cvt_pk_bf16_f32 v210, v148, v149
    v_mfma_f32_32x32x16_bf16 v[128:143], v[220:223], v[196:199], v[128:143]
    ds_read_b128 v[164:167], v249 offset:17408
    v_exp_f32 v152, v152
    v_cvt_pk_bf16_f32 v211, v150, v151
    v_exp_f32 v153, v153
    v_mfma_f32_16x16x32_bf16 v[40:43], v[168:171], v[184:187], v[40:43]
    v_exp_f32 v154, v154
    v_mfma_f32_32x32x16_bf16 v[112:127], v[224:227], v[208:211], v[112:127]
    ds_read_b128 v[224:227], v250 offset:10240
    v_exp_f32 v155, v155
    v_cvt_pk_bf16_f32 v212, v152, v153
    v_exp_f32 v156, v156
    v_mfma_f32_16x16x32_bf16 v[44:47], v[168:171], v[188:191], v[44:47]
    v_cvt_pk_bf16_f32 v213, v154, v155
    v_exp_f32 v157, v157
    v_mfma_f32_16x16x32_bf16 v[56:59], v[172:175], v[184:187], v[56:59]
    ds_read_b128 v[184:187], v245 offset:20480
    v_exp_f32 v158, v158
    v_mfma_f32_16x16x32_bf16 v[60:63], v[172:175], v[188:191], v[60:63]
    s_waitcnt lgkmcnt(2)
    v_cvt_pk_bf16_f32 v214, v156, v157
    v_exp_f32 v159, v159
    v_mfma_f32_16x16x32_bf16 v[0:3], v[160:163], v[176:179], v[0:3]
    ds_read_b128 v[188:191], v245 offset:22528
    v_cvt_pk_bf16_f32 v215, v158, v159
    v_mfma_f32_16x16x32_bf16 v[4:7], v[160:163], v[180:183], v[4:7]
    v_exp_f32 v128, v128
    v_mfma_f32_16x16x32_bf16 v[16:19], v[164:167], v[176:179], v[16:19]
    v_exp_f32 v129, v129
    v_mfma_f32_16x16x32_bf16 v[20:23], v[164:167], v[180:183], v[20:23]
    s_waitcnt lgkmcnt(1)
    v_exp_f32 v130, v130
    v_smfmac_f32_16x16x64_bf16 v[236:239], v[240:243], v[208:215], v244
    ds_read_b128 v[168:171], v249 offset:18432
    v_cvt_pk_bf16_f32 v208, v128, v129
    v_mfma_f32_32x32x16_bf16 v[112:127], v[228:231], v[212:215], v[112:127]
    ds_read_b128 v[228:231], v250 offset:11264
    v_exp_f32 v131, v131
    v_exp_f32 v132, v132
    v_cvt_pk_bf16_f32 v209, v130, v131
    v_mfma_f32_32x32x16_bf16 v[144:159], v[216:219], v[200:203], 0
    ds_read_b128 v[216:219], v250 offset:8192
    v_exp_f32 v133, v133
    v_exp_f32 v134, v134
    v_cvt_pk_bf16_f32 v210, v132, v133
    v_mfma_f32_32x32x16_bf16 v[144:159], v[220:223], v[204:207], v[144:159]
    ds_read_b128 v[220:223], v250 offset:9216
    v_exp_f32 v135, v135
    v_exp_f32 v136, v136
    v_cvt_pk_bf16_f32 v211, v134, v135
    v_mfma_f32_16x16x32_bf16 v[8:11], v[160:163], v[184:187], v[8:11]
    s_waitcnt lgkmcnt(4)
    v_exp_f32 v137, v137
    v_mfma_f32_32x32x16_bf16 v[96:111], v[224:227], v[208:211], v[96:111]
    ds_read_b128 v[172:175], v249 offset:19456
    v_exp_f32 v138, v138
    v_exp_f32 v139, v139
    v_cvt_pk_bf16_f32 v212, v136, v137
    v_mfma_f32_16x16x32_bf16 v[12:15], v[160:163], v[188:191], v[12:15]
    v_exp_f32 v140, v140
    v_cvt_pk_bf16_f32 v213, v138, v139
    v_mfma_f32_16x16x32_bf16 v[24:27], v[164:167], v[184:187], v[24:27]
    v_exp_f32 v141, v141
    v_exp_f32 v142, v142
    v_mfma_f32_16x16x32_bf16 v[28:31], v[164:167], v[188:191], v[28:31]
    s_waitcnt lgkmcnt(0)
    v_cvt_pk_bf16_f32 v214, v140, v141
    v_exp_f32 v143, v143
    v_mfma_f32_16x16x32_bf16 v[40:43], v[168:171], v[184:187], v[40:43]
    v_cvt_pk_bf16_f32 v215, v142, v143
    v_exp_f32 v144, v144
    v_mfma_f32_16x16x32_bf16 v[44:47], v[168:171], v[188:191], v[44:47]
    v_exp_f32 v145, v145
    v_mfma_f32_16x16x32_bf16 v[56:59], v[172:175], v[184:187], v[56:59]
    v_exp_f32 v146, v146
    v_mfma_f32_16x16x32_bf16 v[60:63], v[172:175], v[188:191], v[60:63]
    v_exp_f32 v147, v147
    v_smfmac_f32_16x16x64_bf16 v[232:235], v[240:243], v[208:215], v244
    ds_read_b128 v[160:163], v249 offset:24576
    v_cvt_pk_bf16_f32 v208, v144, v145
    v_mfma_f32_32x32x16_bf16 v[96:111], v[228:231], v[212:215], v[96:111]
    ds_read_b128 v[184:187], v246 offset:20480
    v_exp_f32 v148, v148
    v_exp_f32 v149, v149
    v_cvt_pk_bf16_f32 v209, v146, v147
    v_mfma_f32_32x32x16_bf16 v[128:143], v[216:219], v[192:195], 0
    ds_read_b128 v[188:191], v246 offset:22528
    v_exp_f32 v150, v150
    v_exp_f32 v151, v151
    v_cvt_pk_bf16_f32 v210, v148, v149
    v_mfma_f32_32x32x16_bf16 v[128:143], v[220:223], v[196:199], v[128:143]
    ds_read_b128 v[164:167], v249 offset:25600
    v_exp_f32 v152, v152
    v_cvt_pk_bf16_f32 v211, v150, v151
    v_exp_f32 v153, v153
    v_mfma_f32_16x16x32_bf16 v[32:35], v[168:171], v[176:179], v[32:35]
    v_exp_f32 v154, v154
    v_mfma_f32_32x32x16_bf16 v[112:127], v[224:227], v[208:211], v[112:127]
    ds_read_b128 v[224:227], v250 offset:14336
    v_exp_f32 v155, v155
    v_cvt_pk_bf16_f32 v212, v152, v153
    v_exp_f32 v156, v156
    v_mfma_f32_16x16x32_bf16 v[36:39], v[168:171], v[180:183], v[36:39]
    v_cvt_pk_bf16_f32 v213, v154, v155
    v_exp_f32 v157, v157
    v_mfma_f32_16x16x32_bf16 v[48:51], v[172:175], v[176:179], v[48:51]
    ds_read_b128 v[176:179], v246 offset:16384
    v_exp_f32 v158, v158
    v_mfma_f32_16x16x32_bf16 v[52:55], v[172:175], v[180:183], v[52:55]
    s_waitcnt lgkmcnt(2)
    v_cvt_pk_bf16_f32 v214, v156, v157
    v_exp_f32 v159, v159
    v_mfma_f32_16x16x32_bf16 v[8:11], v[160:163], v[184:187], v[8:11]
    ds_read_b128 v[180:183], v246 offset:18432
    v_cvt_pk_bf16_f32 v215, v158, v159
    v_mfma_f32_16x16x32_bf16 v[12:15], v[160:163], v[188:191], v[12:15]
    v_exp_f32 v128, v128
    v_mfma_f32_16x16x32_bf16 v[24:27], v[164:167], v[184:187], v[24:27]
    v_exp_f32 v129, v129
    v_mfma_f32_16x16x32_bf16 v[28:31], v[164:167], v[188:191], v[28:31]
    s_waitcnt lgkmcnt(1)
    v_exp_f32 v130, v130
    v_smfmac_f32_16x16x64_bf16 v[236:239], v[240:243], v[208:215], v244
    ds_read_b128 v[168:171], v249 offset:26624
    v_cvt_pk_bf16_f32 v208, v128, v129
    v_mfma_f32_32x32x16_bf16 v[112:127], v[228:231], v[212:215], v[112:127]
    ds_read_b128 v[228:231], v250 offset:15360
    v_exp_f32 v131, v131
    v_exp_f32 v132, v132
    v_cvt_pk_bf16_f32 v209, v130, v131
    v_mfma_f32_32x32x16_bf16 v[144:159], v[216:219], v[200:203], 0
    ds_read_b128 v[216:219], v250 offset:12288
    v_exp_f32 v133, v133
    v_exp_f32 v134, v134
    v_cvt_pk_bf16_f32 v210, v132, v133
    v_mfma_f32_32x32x16_bf16 v[144:159], v[220:223], v[204:207], v[144:159]
    ds_read_b128 v[220:223], v250 offset:13312
    v_exp_f32 v135, v135
    v_exp_f32 v136, v136
    v_cvt_pk_bf16_f32 v211, v134, v135
    v_mfma_f32_16x16x32_bf16 v[0:3], v[160:163], v[176:179], v[0:3]
    s_waitcnt lgkmcnt(4)
    v_exp_f32 v137, v137
    v_mfma_f32_32x32x16_bf16 v[96:111], v[224:227], v[208:211], v[96:111]
    ds_read_b128 v[172:175], v249 offset:27648
    v_exp_f32 v138, v138
    v_exp_f32 v139, v139
    v_cvt_pk_bf16_f32 v212, v136, v137
    v_mfma_f32_16x16x32_bf16 v[4:7], v[160:163], v[180:183], v[4:7]
    v_exp_f32 v140, v140
    v_cvt_pk_bf16_f32 v213, v138, v139
    v_mfma_f32_16x16x32_bf16 v[16:19], v[164:167], v[176:179], v[16:19]
    v_exp_f32 v141, v141
    v_exp_f32 v142, v142
    v_mfma_f32_16x16x32_bf16 v[20:23], v[164:167], v[180:183], v[20:23]
    s_waitcnt lgkmcnt(0)
    v_cvt_pk_bf16_f32 v214, v140, v141
    v_exp_f32 v143, v143
    v_mfma_f32_16x16x32_bf16 v[32:35], v[168:171], v[176:179], v[32:35]
    v_cvt_pk_bf16_f32 v215, v142, v143
    v_exp_f32 v144, v144
    v_mfma_f32_16x16x32_bf16 v[36:39], v[168:171], v[180:183], v[36:39]
    v_exp_f32 v145, v145
    v_mfma_f32_16x16x32_bf16 v[48:51], v[172:175], v[176:179], v[48:51]
    v_exp_f32 v146, v146
    v_mfma_f32_16x16x32_bf16 v[52:55], v[172:175], v[180:183], v[52:55]
    v_exp_f32 v147, v147
    v_smfmac_f32_16x16x64_bf16 v[232:235], v[240:243], v[208:215], v244
    ds_read_b128 v[160:163], v249 offset:32768
    v_cvt_pk_bf16_f32 v208, v144, v145
    v_mfma_f32_32x32x16_bf16 v[96:111], v[228:231], v[212:215], v[96:111]
    ds_read_b128 v[176:179], v245 offset:32768
    v_exp_f32 v148, v148
    v_exp_f32 v149, v149
    v_cvt_pk_bf16_f32 v209, v146, v147
    v_mfma_f32_32x32x16_bf16 v[128:143], v[216:219], v[192:195], 0
    ds_read_b128 v[180:183], v245 offset:34816
    v_exp_f32 v150, v150
    v_exp_f32 v151, v151
    v_cvt_pk_bf16_f32 v210, v148, v149
    v_mfma_f32_32x32x16_bf16 v[128:143], v[220:223], v[196:199], v[128:143]
    ds_read_b128 v[164:167], v249 offset:33792
    v_exp_f32 v152, v152
    v_cvt_pk_bf16_f32 v211, v150, v151
    v_exp_f32 v153, v153
    v_mfma_f32_16x16x32_bf16 v[40:43], v[168:171], v[184:187], v[40:43]
    v_exp_f32 v154, v154
    v_mfma_f32_32x32x16_bf16 v[112:127], v[224:227], v[208:211], v[112:127]
    ds_read_b128 v[224:227], v250 offset:18432
    v_exp_f32 v155, v155
    v_cvt_pk_bf16_f32 v212, v152, v153
    v_exp_f32 v156, v156
    v_mfma_f32_16x16x32_bf16 v[44:47], v[168:171], v[188:191], v[44:47]
    v_cvt_pk_bf16_f32 v213, v154, v155
    v_exp_f32 v157, v157
    v_mfma_f32_16x16x32_bf16 v[56:59], v[172:175], v[184:187], v[56:59]
    ds_read_b128 v[184:187], v245 offset:36864
    v_exp_f32 v158, v158
    v_mfma_f32_16x16x32_bf16 v[60:63], v[172:175], v[188:191], v[60:63]
    s_waitcnt lgkmcnt(2)
    v_cvt_pk_bf16_f32 v214, v156, v157
    v_exp_f32 v159, v159
    v_mfma_f32_16x16x32_bf16 v[0:3], v[160:163], v[176:179], v[0:3]
    ds_read_b128 v[188:191], v245 offset:38912
    v_cvt_pk_bf16_f32 v215, v158, v159
    v_mfma_f32_16x16x32_bf16 v[4:7], v[160:163], v[180:183], v[4:7]
    v_exp_f32 v128, v128
    v_mfma_f32_16x16x32_bf16 v[16:19], v[164:167], v[176:179], v[16:19]
    v_exp_f32 v129, v129
    v_mfma_f32_16x16x32_bf16 v[20:23], v[164:167], v[180:183], v[20:23]
    s_waitcnt lgkmcnt(1)
    v_exp_f32 v130, v130
    v_smfmac_f32_16x16x64_bf16 v[236:239], v[240:243], v[208:215], v244
    ds_read_b128 v[168:171], v249 offset:34816
    v_cvt_pk_bf16_f32 v208, v128, v129
    v_mfma_f32_32x32x16_bf16 v[112:127], v[228:231], v[212:215], v[112:127]
    ds_read_b128 v[228:231], v250 offset:19456
    v_exp_f32 v131, v131
    v_exp_f32 v132, v132
    v_cvt_pk_bf16_f32 v209, v130, v131
    v_mfma_f32_32x32x16_bf16 v[144:159], v[216:219], v[200:203], 0
    ds_read_b128 v[216:219], v250 offset:16384
    v_exp_f32 v133, v133
    v_exp_f32 v134, v134
    v_cvt_pk_bf16_f32 v210, v132, v133
    v_mfma_f32_32x32x16_bf16 v[144:159], v[220:223], v[204:207], v[144:159]
    ds_read_b128 v[220:223], v250 offset:17408
    v_exp_f32 v135, v135
    v_exp_f32 v136, v136
    v_cvt_pk_bf16_f32 v211, v134, v135
    v_mfma_f32_16x16x32_bf16 v[8:11], v[160:163], v[184:187], v[8:11]
    s_waitcnt lgkmcnt(4)
    v_exp_f32 v137, v137
    v_mfma_f32_32x32x16_bf16 v[96:111], v[224:227], v[208:211], v[96:111]
    ds_read_b128 v[172:175], v249 offset:35840
    v_exp_f32 v138, v138
    v_exp_f32 v139, v139
    v_cvt_pk_bf16_f32 v212, v136, v137
    v_mfma_f32_16x16x32_bf16 v[12:15], v[160:163], v[188:191], v[12:15]
    v_exp_f32 v140, v140
    v_cvt_pk_bf16_f32 v213, v138, v139
    v_mfma_f32_16x16x32_bf16 v[24:27], v[164:167], v[184:187], v[24:27]
    v_exp_f32 v141, v141
    v_exp_f32 v142, v142
    v_mfma_f32_16x16x32_bf16 v[28:31], v[164:167], v[188:191], v[28:31]
    s_waitcnt lgkmcnt(0)
    v_cvt_pk_bf16_f32 v214, v140, v141
    v_exp_f32 v143, v143
    v_mfma_f32_16x16x32_bf16 v[40:43], v[168:171], v[184:187], v[40:43]
    v_cvt_pk_bf16_f32 v215, v142, v143
    v_exp_f32 v144, v144
    v_mfma_f32_16x16x32_bf16 v[44:47], v[168:171], v[188:191], v[44:47]
    v_exp_f32 v145, v145
    v_mfma_f32_16x16x32_bf16 v[56:59], v[172:175], v[184:187], v[56:59]
    v_exp_f32 v146, v146
    v_mfma_f32_16x16x32_bf16 v[60:63], v[172:175], v[188:191], v[60:63]
    v_exp_f32 v147, v147
    v_smfmac_f32_16x16x64_bf16 v[232:235], v[240:243], v[208:215], v244
    ds_read_b128 v[160:163], v249 offset:40960
    v_cvt_pk_bf16_f32 v208, v144, v145
    v_mfma_f32_32x32x16_bf16 v[96:111], v[228:231], v[212:215], v[96:111]
    ds_read_b128 v[184:187], v246 offset:36864
    v_exp_f32 v148, v148
    v_exp_f32 v149, v149
    v_cvt_pk_bf16_f32 v209, v146, v147
    v_mfma_f32_32x32x16_bf16 v[128:143], v[216:219], v[192:195], 0
    ds_read_b128 v[188:191], v246 offset:38912
    v_exp_f32 v150, v150
    v_exp_f32 v151, v151
    v_cvt_pk_bf16_f32 v210, v148, v149
    v_mfma_f32_32x32x16_bf16 v[128:143], v[220:223], v[196:199], v[128:143]
    ds_read_b128 v[164:167], v249 offset:41984
    v_exp_f32 v152, v152
    v_cvt_pk_bf16_f32 v211, v150, v151
    v_exp_f32 v153, v153
    v_mfma_f32_16x16x32_bf16 v[32:35], v[168:171], v[176:179], v[32:35]
    v_exp_f32 v154, v154
    v_mfma_f32_32x32x16_bf16 v[112:127], v[224:227], v[208:211], v[112:127]
    ds_read_b128 v[224:227], v250 offset:22528
    v_exp_f32 v155, v155
    v_cvt_pk_bf16_f32 v212, v152, v153
    v_exp_f32 v156, v156
    v_mfma_f32_16x16x32_bf16 v[36:39], v[168:171], v[180:183], v[36:39]
    v_cvt_pk_bf16_f32 v213, v154, v155
    v_exp_f32 v157, v157
    v_mfma_f32_16x16x32_bf16 v[48:51], v[172:175], v[176:179], v[48:51]
    ds_read_b128 v[176:179], v246 offset:32768
    v_exp_f32 v158, v158
    v_mfma_f32_16x16x32_bf16 v[52:55], v[172:175], v[180:183], v[52:55]
    s_waitcnt lgkmcnt(2)
    v_cvt_pk_bf16_f32 v214, v156, v157
    v_exp_f32 v159, v159
    v_mfma_f32_16x16x32_bf16 v[8:11], v[160:163], v[184:187], v[8:11]
    ds_read_b128 v[180:183], v246 offset:34816
    v_cvt_pk_bf16_f32 v215, v158, v159
    v_mfma_f32_16x16x32_bf16 v[12:15], v[160:163], v[188:191], v[12:15]
    v_exp_f32 v128, v128
    v_mfma_f32_16x16x32_bf16 v[24:27], v[164:167], v[184:187], v[24:27]
    v_exp_f32 v129, v129
    v_mfma_f32_16x16x32_bf16 v[28:31], v[164:167], v[188:191], v[28:31]
    s_waitcnt lgkmcnt(1)
    v_exp_f32 v130, v130
    v_smfmac_f32_16x16x64_bf16 v[236:239], v[240:243], v[208:215], v244
    ds_read_b128 v[168:171], v249 offset:43008
    v_cvt_pk_bf16_f32 v208, v128, v129
    v_mfma_f32_32x32x16_bf16 v[112:127], v[228:231], v[212:215], v[112:127]
    ds_read_b128 v[228:231], v250 offset:23552
    v_exp_f32 v131, v131
    v_exp_f32 v132, v132
    v_cvt_pk_bf16_f32 v209, v130, v131
    v_mfma_f32_32x32x16_bf16 v[144:159], v[216:219], v[200:203], 0
    ds_read_b128 v[216:219], v250 offset:20480
    v_exp_f32 v133, v133
    v_exp_f32 v134, v134
    v_cvt_pk_bf16_f32 v210, v132, v133
    v_mfma_f32_32x32x16_bf16 v[144:159], v[220:223], v[204:207], v[144:159]
    ds_read_b128 v[220:223], v250 offset:21504
    v_exp_f32 v135, v135
    v_exp_f32 v136, v136
    v_cvt_pk_bf16_f32 v211, v134, v135
    v_mfma_f32_16x16x32_bf16 v[0:3], v[160:163], v[176:179], v[0:3]
    s_waitcnt lgkmcnt(4)
    v_exp_f32 v137, v137
    v_mfma_f32_32x32x16_bf16 v[96:111], v[224:227], v[208:211], v[96:111]
    ds_read_b128 v[172:175], v249 offset:44032
    v_exp_f32 v138, v138
    v_exp_f32 v139, v139
    v_cvt_pk_bf16_f32 v212, v136, v137
    v_mfma_f32_16x16x32_bf16 v[4:7], v[160:163], v[180:183], v[4:7]
    v_exp_f32 v140, v140
    v_cvt_pk_bf16_f32 v213, v138, v139
    v_mfma_f32_16x16x32_bf16 v[16:19], v[164:167], v[176:179], v[16:19]
    v_exp_f32 v141, v141
    v_exp_f32 v142, v142
    v_mfma_f32_16x16x32_bf16 v[20:23], v[164:167], v[180:183], v[20:23]
    s_waitcnt lgkmcnt(0)
    v_cvt_pk_bf16_f32 v214, v140, v141
    v_exp_f32 v143, v143
    v_mfma_f32_16x16x32_bf16 v[32:35], v[168:171], v[176:179], v[32:35]
    s_barrier
    v_cvt_pk_bf16_f32 v215, v142, v143
    v_exp_f32 v144, v144
    v_mfma_f32_16x16x32_bf16 v[36:39], v[168:171], v[180:183], v[36:39]
    v_exp_f32 v145, v145
    v_mfma_f32_16x16x32_bf16 v[48:51], v[172:175], v[176:179], v[48:51]
    v_exp_f32 v146, v146
    v_mfma_f32_16x16x32_bf16 v[52:55], v[172:175], v[180:183], v[52:55]
    v_exp_f32 v147, v147
    v_smfmac_f32_16x16x64_bf16 v[232:235], v[240:243], v[208:215], v244
    ds_read_b128 v[160:163], v249 offset:49152
    v_cvt_pk_bf16_f32 v208, v144, v145
    v_mfma_f32_32x32x16_bf16 v[96:111], v[228:231], v[212:215], v[96:111]
    ds_read_b128 v[176:179], v245 offset:49152
    v_exp_f32 v148, v148
    v_exp_f32 v149, v149
    v_cvt_pk_bf16_f32 v209, v146, v147
    v_mfma_f32_32x32x16_bf16 v[128:143], v[216:219], v[192:195], 0
    ds_read_b128 v[180:183], v245 offset:51200
    v_exp_f32 v150, v150
    v_exp_f32 v151, v151
    v_cvt_pk_bf16_f32 v210, v148, v149
    v_mfma_f32_32x32x16_bf16 v[128:143], v[220:223], v[196:199], v[128:143]
    ds_read_b128 v[164:167], v249 offset:50176
    v_exp_f32 v152, v152
    v_cvt_pk_bf16_f32 v211, v150, v151
    v_exp_f32 v153, v153
    v_mfma_f32_16x16x32_bf16 v[40:43], v[168:171], v[184:187], v[40:43]
    v_exp_f32 v154, v154
    v_mfma_f32_32x32x16_bf16 v[112:127], v[224:227], v[208:211], v[112:127]
    ds_read_b128 v[224:227], v250 offset:26624
    v_exp_f32 v155, v155
    v_cvt_pk_bf16_f32 v212, v152, v153
    v_exp_f32 v156, v156
    v_mfma_f32_16x16x32_bf16 v[44:47], v[168:171], v[188:191], v[44:47]
    v_cvt_pk_bf16_f32 v213, v154, v155
    v_exp_f32 v157, v157
    v_mfma_f32_16x16x32_bf16 v[56:59], v[172:175], v[184:187], v[56:59]
    ds_read_b128 v[184:187], v245 offset:53248
    v_exp_f32 v158, v158
    v_mfma_f32_16x16x32_bf16 v[60:63], v[172:175], v[188:191], v[60:63]
    s_waitcnt lgkmcnt(2)
    v_cvt_pk_bf16_f32 v214, v156, v157
    v_exp_f32 v159, v159
    v_mfma_f32_16x16x32_bf16 v[0:3], v[160:163], v[176:179], v[0:3]
    ds_read_b128 v[188:191], v245 offset:55296
    v_cvt_pk_bf16_f32 v215, v158, v159
    v_mfma_f32_16x16x32_bf16 v[4:7], v[160:163], v[180:183], v[4:7]
    v_exp_f32 v128, v128
    v_mfma_f32_16x16x32_bf16 v[16:19], v[164:167], v[176:179], v[16:19]
    v_exp_f32 v129, v129
    v_mfma_f32_16x16x32_bf16 v[20:23], v[164:167], v[180:183], v[20:23]
    s_waitcnt lgkmcnt(1)
    v_exp_f32 v130, v130
    v_smfmac_f32_16x16x64_bf16 v[236:239], v[240:243], v[208:215], v244
    ds_read_b128 v[168:171], v249 offset:51200
    v_cvt_pk_bf16_f32 v208, v128, v129
    v_mfma_f32_32x32x16_bf16 v[112:127], v[228:231], v[212:215], v[112:127]
    ds_read_b128 v[228:231], v250 offset:27648
    v_exp_f32 v131, v131
    v_exp_f32 v132, v132
    v_cvt_pk_bf16_f32 v209, v130, v131
    v_mfma_f32_32x32x16_bf16 v[144:159], v[216:219], v[200:203], 0
    ds_read_b128 v[216:219], v250 offset:24576
    v_exp_f32 v133, v133
    v_exp_f32 v134, v134
    v_cvt_pk_bf16_f32 v210, v132, v133
    v_mfma_f32_32x32x16_bf16 v[144:159], v[220:223], v[204:207], v[144:159]
    ds_read_b128 v[220:223], v250 offset:25600
    v_exp_f32 v135, v135
    v_exp_f32 v136, v136
    v_cvt_pk_bf16_f32 v211, v134, v135
    v_mfma_f32_16x16x32_bf16 v[8:11], v[160:163], v[184:187], v[8:11]
    s_waitcnt lgkmcnt(4)
    v_exp_f32 v137, v137
    v_mfma_f32_32x32x16_bf16 v[96:111], v[224:227], v[208:211], v[96:111]
    ds_read_b128 v[172:175], v249 offset:52224
    v_exp_f32 v138, v138
    v_exp_f32 v139, v139
    v_cvt_pk_bf16_f32 v212, v136, v137
    v_mfma_f32_16x16x32_bf16 v[12:15], v[160:163], v[188:191], v[12:15]
    v_exp_f32 v140, v140
    v_cvt_pk_bf16_f32 v213, v138, v139
    v_mfma_f32_16x16x32_bf16 v[24:27], v[164:167], v[184:187], v[24:27]
    v_exp_f32 v141, v141
    v_exp_f32 v142, v142
    v_mfma_f32_16x16x32_bf16 v[28:31], v[164:167], v[188:191], v[28:31]
    s_waitcnt lgkmcnt(0)
    v_cvt_pk_bf16_f32 v214, v140, v141
    v_exp_f32 v143, v143
    v_mfma_f32_16x16x32_bf16 v[40:43], v[168:171], v[184:187], v[40:43]
    v_cvt_pk_bf16_f32 v215, v142, v143
    v_exp_f32 v144, v144
    v_mfma_f32_16x16x32_bf16 v[44:47], v[168:171], v[188:191], v[44:47]
    v_exp_f32 v145, v145
    v_mfma_f32_16x16x32_bf16 v[56:59], v[172:175], v[184:187], v[56:59]
    v_exp_f32 v146, v146
    v_mfma_f32_16x16x32_bf16 v[60:63], v[172:175], v[188:191], v[60:63]
    v_exp_f32 v147, v147
    v_smfmac_f32_16x16x64_bf16 v[232:235], v[240:243], v[208:215], v244
    ds_read_b128 v[160:163], v249 offset:57344
    v_cvt_pk_bf16_f32 v208, v144, v145
    v_mfma_f32_32x32x16_bf16 v[96:111], v[228:231], v[212:215], v[96:111]
    ds_read_b128 v[184:187], v246 offset:53248
    v_exp_f32 v148, v148
    v_exp_f32 v149, v149
    v_cvt_pk_bf16_f32 v209, v146, v147
    v_mfma_f32_32x32x16_bf16 v[128:143], v[216:219], v[192:195], 0
    ds_read_b128 v[188:191], v246 offset:55296
    v_exp_f32 v150, v150
    v_exp_f32 v151, v151
    v_cvt_pk_bf16_f32 v210, v148, v149
    v_mfma_f32_32x32x16_bf16 v[128:143], v[220:223], v[196:199], v[128:143]
    s_branch PG5_go
    .p2align 12
PG5:
    s_setpc_b64 s[72:73]
    s_nop 0
PG5_go:
    ds_read_b128 v[164:167], v249 offset:58368
    v_exp_f32 v152, v152
    v_cvt_pk_bf16_f32 v211, v150, v151
    v_exp_f32 v153, v153
    v_mfma_f32_16x16x32_bf16 v[32:35], v[168:171], v[176:179], v[32:35]
    v_exp_f32 v154, v154
    v_mfma_f32_32x32x16_bf16 v[112:127], v[224:227], v[208:211], v[112:127]
    ds_read_b128 v[224:227], v250 offset:30720
    v_exp_f32 v155, v155
    v_cvt_pk_bf16_f32 v212, v152, v153
    v_exp_f32 v156, v156
    v_mfma_f32_16x16x32_bf16 v[36:39], v[168:171], v[180:183], v[36:39]
    v_cvt_pk_bf16_f32 v213, v154, v155
    v_exp_f32 v157, v157
    v_mfma_f32_16x16x32_bf16 v[48:51], v[172:175], v[176:179], v[48:51]
    ds_read_b128 v[176:179], v246 offset:49152
    v_exp_f32 v158, v158
    v_mfma_f32_16x16x32_bf16 v[52:55], v[172:175], v[180:183], v[52:55]
    s_waitcnt lgkmcnt(2)
    v_cvt_pk_bf16_f32 v214, v156, v157
    v_exp_f32 v159, v159
    v_mfma_f32_16x16x32_bf16 v[8:11], v[160:163], v[184:187], v[8:11]
    ds_read_b128 v[180:183], v246 offset:51200
    v_cvt_pk_bf16_f32 v215, v158, v159
    v_mfma_f32_16x16x32_bf16 v[12:15], v[160:163], v[188:191], v[12:15]
    v_exp_f32 v128, v128
    v_mfma_f32_16x16x32_bf16 v[24:27], v[164:167], v[184:187], v[24:27]
    v_exp_f32 v129, v129
    v_mfma_f32_16x16x32_bf16 v[28:31], v[164:167], v[188:191], v[28:31]
    s_waitcnt lgkmcnt(1)
    v_exp_f32 v130, v130
    v_smfmac_f32_16x16x64_bf16 v[236:239], v[240:243], v[208:215], v244
    ds_read_b128 v[168:171], v249 offset:59392
    v_cvt_pk_bf16_f32 v208, v128, v129
    v_mfma_f32_32x32x16_bf16 v[112:127], v[228:231], v[212:215], v[112:127]
    ds_read_b128 v[228:231], v250 offset:31744
    v_exp_f32 v131, v131
    v_exp_f32 v132, v132
    v_cvt_pk_bf16_f32 v209, v130, v131
    v_mfma_f32_32x32x16_bf16 v[144:159], v[216:219], v[200:203], 0
    ds_read_b128 v[216:219], v250 offset:28672
    v_exp_f32 v133, v133
    v_exp_f32 v134, v134
    v_cvt_pk_bf16_f32 v210, v132, v133
    v_mfma_f32_32x32x16_bf16 v[144:159], v[220:223], v[204:207], v[144:159]
    ds_read_b128 v[220:223], v250 offset:29696
    v_exp_f32 v135, v135
    v_exp_f32 v136, v136
    v_cvt_pk_bf16_f32 v211, v134, v135
    v_mfma_f32_16x16x32_bf16 v[0:3], v[160:163], v[176:179], v[0:3]
    s_waitcnt lgkmcnt(4)
    v_exp_f32 v137, v137
    v_mfma_f32_32x32x16_bf16 v[96:111], v[224:227], v[208:211], v[96:111]
    ds_read_b128 v[172:175], v249 offset:60416
    v_exp_f32 v138, v138
    v_exp_f32 v139, v139
    v_cvt_pk_bf16_f32 v212, v136, v137
    v_mfma_f32_16x16x32_bf16 v[4:7], v[160:163], v[180:183], v[4:7]
    v_exp_f32 v140, v140
    v_cvt_pk_bf16_f32 v213, v138, v139
    v_mfma_f32_16x16x32_bf16 v[16:19], v[164:167], v[176:179], v[16:19]
    v_exp_f32 v141, v141
    v_exp_f32 v142, v142
    v_mfma_f32_16x16x32_bf16 v[20:23], v[164:167], v[180:183], v[20:23]
    s_waitcnt lgkmcnt(0)
    v_cvt_pk_bf16_f32 v214, v140, v141
    v_exp_f32 v143, v143
    v_mfma_f32_16x16x32_bf16 v[32:35], v[168:171], v[176:179], v[32:35]
    v_cvt_pk_bf16_f32 v215, v142, v143
    v_exp_f32 v144, v144
    v_mfma_f32_16x16x32_bf16 v[36:39], v[168:171], v[180:183], v[36:39]
    v_exp_f32 v145, v145
    v_mfma_f32_16x16x32_bf16 v[48:51], v[172:175], v[176:179], v[48:51]
    v_exp_f32 v146, v146
    v_mfma_f32_16x16x32_bf16 v[52:55], v[172:175], v[180:183], v[52:55]
    v_exp_f32 v147, v147
    v_smfmac_f32_16x16x64_bf16 v[232:235], v[240:243], v[208:215], v244
    ds_read_b128 v[160:163], v249 offset:0
    v_cvt_pk_bf16_f32 v208, v144, v145
    v_mfma_f32_32x32x16_bf16 v[96:111], v[228:231], v[212:215], v[96:111]
    ds_read_b128 v[176:179], v245 offset:0
    v_exp_f32 v148, v148
    v_exp_f32 v149, v149
    v_cvt_pk_bf16_f32 v209, v146, v147
    v_mfma_f32_32x32x16_bf16 v[128:143], v[216:219], v[192:195], 0
    ds_read_b128 v[180:183], v245 offset:2048
    v_exp_f32 v150, v150
    v_exp_f32 v151, v151
    v_cvt_pk_bf16_f32 v210, v148, v149
    v_mfma_f32_32x32x16_bf16 v[128:143], v[220:223], v[196:199], v[128:143]
    ds_read_b128 v[164:167], v249 offset:1024
    v_exp_f32 v152, v152
    v_cvt_pk_bf16_f32 v211, v150, v151
    v_exp_f32 v153, v153
    v_mfma_f32_16x16x32_bf16 v[40:43], v[168:171], v[184:187], v[40:43]
    s_sub_u32 s50, s50, 1
    v_exp_f32 v154, v154
    v_mfma_f32_32x32x16_bf16 v[112:127], v[224:227], v[208:211], v[112:127]
    ds_read_b128 v[224:227], v250 offset:2048
    v_exp_f32 v155, v155
    v_cvt_pk_bf16_f32 v212, v152, v153
    v_exp_f32 v156, v156
    v_mfma_f32_16x16x32_bf16 v[44:47], v[168:171], v[188:191], v[44:47]
    s_cmp_lg_u32 s50, 0
    v_cvt_pk_bf16_f32 v213, v154, v155
    v_exp_f32 v157, v157
    v_mfma_f32_16x16x32_bf16 v[56:59], v[172:175], v[184:187], v[56:59]
    ds_read_b128 v[184:187], v245 offset:4096
    v_exp_f32 v158, v158
    v_mfma_f32_16x16x32_bf16 v[60:63], v[172:175], v[188:191], v[60:63]
    s_waitcnt lgkmcnt(2)
    v_cvt_pk_bf16_f32 v214, v156, v157
    v_exp_f32 v159, v159
    s_cbranch_scc1 A_fused
A_fused_end:
    v_lshlrev_b32 v245, 4, v251
    v_add_u32 v246, 90112, v245
    v_sub_f32 v252, 1.0, v252
    v_sub_f32 v253, 1.0, v253
    v_sub_f32 v254, 1.0, v254
    v_sub_f32 v255, 1.0, v255
    s_waitcnt lgkmcnt(0)
    v_lshlrev_b32 v160, 16, v64
    v_and_b32 v161, 0xffff0000, v64
    v_pk_mul_f32 v[0:1], v[0:1], v[252:253] op_sel:[0,0] op_sel_hi:[1,0]
    v_lshlrev_b32 v162, 16, v65
    v_and_b32 v163, 0xffff0000, v65
    v_pk_mul_f32 v[2:3], v[2:3], v[252:253] op_sel:[0,0] op_sel_hi:[1,0]
    v_lshlrev_b32 v164, 16, v66
    v_and_b32 v165, 0xffff0000, v66
    v_pk_mul_f32 v[16:17], v[16:17], v[252:253] op_sel:[0,0] op_sel_hi:[1,0]
    v_lshlrev_b32 v166, 16, v67
    v_and_b32 v167, 0xffff0000, v67
    v_pk_mul_f32 v[18:19], v[18:19], v[252:253] op_sel:[0,0] op_sel_hi:[1,0]
    v_pk_mul_f32 v[0:1], v[0:1], v[160:161]
    v_pk_mul_f32 v[2:3], v[2:3], v[162:163]
    v_pk_mul_f32 v[16:17], v[16:17], v[164:165]
    v_pk_mul_f32 v[18:19], v[18:19], v[166:167]
    v_cvt_pk_bf16_f32 v64, v0, v1
    v_cvt_pk_bf16_f32 v65, v2, v3
    v_cvt_pk_bf16_f32 v66, v16, v17
    v_cvt_pk_bf16_f32 v67, v18, v19
    buffer_store_dwordx4 v[64:67], v245, s[24:27], s16 offen offset:0 sc1
    v_lshlrev_b32 v168, 16, v68
    v_and_b32 v169, 0xffff0000, v68
    v_pk_mul_f32 v[4:5], v[4:5], v[252:253] op_sel:[0,1] op_sel_hi:[1,1]
    v_lshlrev_b32 v170, 16, v69
    v_and_b32 v171, 0xffff0000, v69
    v_pk_mul_f32 v[6:7], v[6:7], v[252:253] op_sel:[0,1] op_sel_hi:[1,1]
    v_lshlrev_b32 v172, 16, v70
    v_and_b32 v173, 0xffff0000, v70
    v_pk_mul_f32 v[20:21], v[20:21], v[252:253] op_sel:[0,1] op_sel_hi:[1,1]
    v_lshlrev_b32 v174, 16, v71
    v_and_b32 v175, 0xffff0000, v71
    v_pk_mul_f32 v[22:23], v[22:23], v[252:253] op_sel:[0,1] op_sel_hi:[1,1]
    v_pk_mul_f32 v[4:5], v[4:5], v[168:169]
    v_pk_mul_f32 v[6:7], v[6:7], v[170:171]
    v_pk_mul_f32 v[20:21], v[20:21], v[172:173]
    v_pk_mul_f32 v[22:23], v[22:23], v[174:175]
    v_cvt_pk_bf16_f32 v68, v4, v5
    v_cvt_pk_bf16_f32 v69, v6, v7
    v_cvt_pk_bf16_f32 v70, v20, v21
    v_cvt_pk_bf16_f32 v71, v22, v23
    buffer_store_dwordx4 v[68:71], v245, s[24:27], s17 offen offset:0 sc1
    v_lshlrev_b32 v160, 16, v72
    v_and_b32 v161, 0xffff0000, v72
    v_pk_mul_f32 v[8:9], v[8:9], v[254:255] op_sel:[0,0] op_sel_hi:[1,0]
    v_lshlrev_b32 v162, 16, v73
    v_and_b32 v163, 0xffff0000, v73
    v_pk_mul_f32 v[10:11], v[10:11], v[254:255] op_sel:[0,0] op_sel_hi:[1,0]
    v_lshlrev_b32 v164, 16, v74
    v_and_b32 v165, 0xffff0000, v74
    v_pk_mul_f32 v[24:25], v[24:25], v[254:255] op_sel:[0,0] op_sel_hi:[1,0]
    v_lshlrev_b32 v166, 16, v75
    v_and_b32 v167, 0xffff0000, v75
    v_pk_mul_f32 v[26:27], v[26:27], v[254:255] op_sel:[0,0] op_sel_hi:[1,0]
    v_pk_mul_f32 v[8:9], v[8:9], v[160:161]
    v_pk_mul_f32 v[10:11], v[10:11], v[162:163]
    v_pk_mul_f32 v[24:25], v[24:25], v[164:165]
    v_pk_mul_f32 v[26:27], v[26:27], v[166:167]
    v_cvt_pk_bf16_f32 v72, v8, v9
    v_cvt_pk_bf16_f32 v73, v10, v11
    v_cvt_pk_bf16_f32 v74, v24, v25
    v_cvt_pk_bf16_f32 v75, v26, v27
    buffer_store_dwordx4 v[72:75], v245, s[24:27], s18 offen offset:0 sc1
    v_lshlrev_b32 v168, 16, v76
    v_and_b32 v169, 0xffff0000, v76
    v_pk_mul_f32 v[12:13], v[12:13], v[254:255] op_sel:[0,1] op_sel_hi:[1,1]
    v_lshlrev_b32 v170, 16, v77
    v_and_b32 v171, 0xffff0000, v77
    v_pk_mul_f32 v[14:15], v[14:15], v[254:255] op_sel:[0,1] op_sel_hi:[1,1]
    v_lshlrev_b32 v172, 16, v78
    v_and_b32 v173, 0xffff0000, v78
    v_pk_mul_f32 v[28:29], v[28:29], v[254:255] op_sel:[0,1] op_sel_hi:[1,1]
    v_lshlrev_b32 v174, 16, v79
    v_and_b32 v175, 0xffff0000, v79
    v_pk_mul_f32 v[30:31], v[30:31], v[254:255] op_sel:[0,1] op_sel_hi:[1,1]
    v_pk_mul_f32 v[12:13], v[12:13], v[168:169]
    v_pk_mul_f32 v[14:15], v[14:15], v[170:171]
    v_pk_mul_f32 v[28:29], v[28:29], v[172:173]
    v_pk_mul_f32 v[30:31], v[30:31], v[174:175]
    v_cvt_pk_bf16_f32 v76, v12, v13
    v_cvt_pk_bf16_f32 v77, v14, v15
    v_cvt_pk_bf16_f32 v78, v28, v29
    v_cvt_pk_bf16_f32 v79, v30, v31
    buffer_store_dwordx4 v[76:79], v245, s[24:27], s19 offen offset:0 sc1
    v_lshlrev_b32 v160, 16, v80
    v_and_b32 v161, 0xffff0000, v80
    v_pk_mul_f32 v[32:33], v[32:33], v[252:253] op_sel:[0,0] op_sel_hi:[1,0]
    v_lshlrev_b32 v162, 16, v81
    v_and_b32 v163, 0xffff0000, v81
    v_pk_mul_f32 v[34:35], v[34:35], v[252:253] op_sel:[0,0] op_sel_hi:[1,0]
    v_lshlrev_b32 v164, 16, v82
    v_and_b32 v165, 0xffff0000, v82
    v_pk_mul_f32 v[48:49], v[48:49], v[252:253] op_sel:[0,0] op_sel_hi:[1,0]
    v_lshlrev_b32 v166, 16, v83
    v_and_b32 v167, 0xffff0000, v83
    v_pk_mul_f32 v[50:51], v[50:51], v[252:253] op_sel:[0,0] op_sel_hi:[1,0]
    v_pk_mul_f32 v[32:33], v[32:33], v[160:161]
    v_pk_mul_f32 v[34:35], v[34:35], v[162:163]
    v_pk_mul_f32 v[48:49], v[48:49], v[164:165]
    v_pk_mul_f32 v[50:51], v[50:51], v[166:167]
    v_cvt_pk_bf16_f32 v80, v32, v33
    v_cvt_pk_bf16_f32 v81, v34, v35
    v_cvt_pk_bf16_f32 v82, v48, v49
    v_cvt_pk_bf16_f32 v83, v50, v51
    buffer_store_dwordx4 v[80:83], v245, s[24:27], s16 offen offset:1024 sc1
    v_lshlrev_b32 v168, 16, v84
    v_and_b32 v169, 0xffff0000, v84
    v_pk_mul_f32 v[36:37], v[36:37], v[252:253] op_sel:[0,1] op_sel_hi:[1,1]
    v_lshlrev_b32 v170, 16, v85
    v_and_b32 v171, 0xffff0000, v85
    v_pk_mul_f32 v[38:39], v[38:39], v[252:253] op_sel:[0,1] op_sel_hi:[1,1]
    v_lshlrev_b32 v172, 16, v86
    v_and_b32 v173, 0xffff0000, v86
    v_pk_mul_f32 v[52:53], v[52:53], v[252:253] op_sel:[0,1] op_sel_hi:[1,1]
    v_lshlrev_b32 v174, 16, v87
    v_and_b32 v175, 0xffff0000, v87
    v_pk_mul_f32 v[54:55], v[54:55], v[252:253] op_sel:[0,1] op_sel_hi:[1,1]
    v_pk_mul_f32 v[36:37], v[36:37], v[168:169]
    v_pk_mul_f32 v[38:39], v[38:39], v[170:171]
    v_pk_mul_f32 v[52:53], v[52:53], v[172:173]
    v_pk_mul_f32 v[54:55], v[54:55], v[174:175]
    v_cvt_pk_bf16_f32 v84, v36, v37
    v_cvt_pk_bf16_f32 v85, v38, v39
    v_cvt_pk_bf16_f32 v86, v52, v53
    v_cvt_pk_bf16_f32 v87, v54, v55
    buffer_store_dwordx4 v[84:87], v245, s[24:27], s17 offen offset:1024 sc1
    v_lshlrev_b32 v160, 16, v88
    v_and_b32 v161, 0xffff0000, v88
    v_pk_mul_f32 v[40:41], v[40:41], v[254:255] op_sel:[0,0] op_sel_hi:[1,0]
    v_lshlrev_b32 v162, 16, v89
    v_and_b32 v163, 0xffff0000, v89
    v_pk_mul_f32 v[42:43], v[42:43], v[254:255] op_sel:[0,0] op_sel_hi:[1,0]
    v_lshlrev_b32 v164, 16, v90
    v_and_b32 v165, 0xffff0000, v90
    v_pk_mul_f32 v[56:57], v[56:57], v[254:255] op_sel:[0,0] op_sel_hi:[1,0]
    v_lshlrev_b32 v166, 16, v91
    v_and_b32 v167, 0xffff0000, v91
    v_pk_mul_f32 v[58:59], v[58:59], v[254:255] op_sel:[0,0] op_sel_hi:[1,0]
    v_pk_mul_f32 v[40:41], v[40:41], v[160:161]
    v_pk_mul_f32 v[42:43], v[42:43], v[162:163]
    v_pk_mul_f32 v[56:57], v[56:57], v[164:165]
    v_pk_mul_f32 v[58:59], v[58:59], v[166:167]
    v_cvt_pk_bf16_f32 v88, v40, v41
    v_cvt_pk_bf16_f32 v89, v42, v43
    v_cvt_pk_bf16_f32 v90, v56, v57
    v_cvt_pk_bf16_f32 v91, v58, v59
    buffer_store_dwordx4 v[88:91], v245, s[24:27], s18 offen offset:1024 sc1
    v_lshlrev_b32 v168, 16, v92
    v_and_b32 v169, 0xffff0000, v92
    v_pk_mul_f32 v[44:45], v[44:45], v[254:255] op_sel:[0,1] op_sel_hi:[1,1]
    v_lshlrev_b32 v170, 16, v93
    v_and_b32 v171, 0xffff0000, v93
    v_pk_mul_f32 v[46:47], v[46:47], v[254:255] op_sel:[0,1] op_sel_hi:[1,1]
    v_lshlrev_b32 v172, 16, v94
    v_and_b32 v173, 0xffff0000, v94
    v_pk_mul_f32 v[60:61], v[60:61], v[254:255] op_sel:[0,1] op_sel_hi:[1,1]
    v_lshlrev_b32 v174, 16, v95
    v_and_b32 v175, 0xffff0000, v95
    v_pk_mul_f32 v[62:63], v[62:63], v[254:255] op_sel:[0,1] op_sel_hi:[1,1]
    v_pk_mul_f32 v[44:45], v[44:45], v[168:169]
    v_pk_mul_f32 v[46:47], v[46:47], v[170:171]
    v_pk_mul_f32 v[60:61], v[60:61], v[172:173]
    v_pk_mul_f32 v[62:63], v[62:63], v[174:175]
    v_cvt_pk_bf16_f32 v92, v44, v45
    v_cvt_pk_bf16_f32 v93, v46, v47
    v_cvt_pk_bf16_f32 v94, v60, v61
    v_cvt_pk_bf16_f32 v95, v62, v63
    buffer_store_dwordx4 v[92:95], v245, s[24:27], s19 offen offset:1024 sc1
    s_mov_b32 s50, 2
    .p2align 3
A_attonly:
    v_exp_f32 v128, v128
    v_cvt_pk_bf16_f32 v215, v158, v159
    v_exp_f32 v129, v129
    v_exp_f32 v130, v130
    v_mfma_f32_32x32x16_bf16 v[112:127], v[228:231], v[212:215], v[112:127]
    s_waitcnt lgkmcnt(0)
    v_exp_f32 v131, v131
    v_exp_f32 v132, v132
    v_exp_f32 v133, v133
    v_smfmac_f32_16x16x64_bf16 v[236:239], v[240:243], v[208:215], v244
    ds_read_b128 v[228:231], v250 offset:3072
    v_cvt_pk_bf16_f32 v208, v128, v129
    v_mfma_f32_32x32x16_bf16 v[144:159], v[216:219], v[200:203], 0
    ds_read_b128 v[216:219], v250 offset:0
    v_cvt_pk_bf16_f32 v209, v130, v131
    v_exp_f32 v134, v134
    v_exp_f32 v135, v135
    v_mfma_f32_32x32x16_bf16 v[144:159], v[220:223], v[204:207], v[144:159]
    ds_read_b128 v[220:223], v250 offset:1024
    v_cvt_pk_bf16_f32 v210, v132, v133
    v_cvt_pk_bf16_f32 v211, v134, v135
    v_exp_f32 v136, v136
    v_exp_f32 v137, v137
    v_mfma_f32_32x32x16_bf16 v[96:111], v[224:227], v[208:211], v[96:111]
    s_waitcnt lgkmcnt(2)
    v_exp_f32 v138, v138
    v_cvt_pk_bf16_f32 v212, v136, v137
    v_exp_f32 v139, v139
    v_exp_f32 v140, v140
    v_cvt_pk_bf16_f32 v213, v138, v139
    v_exp_f32 v141, v141
    v_exp_f32 v142, v142
    v_cvt_pk_bf16_f32 v214, v140, v141
    v_exp_f32 v143, v143
    v_exp_f32 v144, v144
    v_cvt_pk_bf16_f32 v215, v142, v143
    v_exp_f32 v145, v145
    v_exp_f32 v146, v146
    v_mfma_f32_32x32x16_bf16 v[96:111], v[228:231], v[212:215], v[96:111]
    s_waitcnt lgkmcnt(0)
    v_exp_f32 v147, v147
    v_exp_f32 v148, v148
    v_exp_f32 v149, v149
    v_smfmac_f32_16x16x64_bf16 v[232:235], v[240:243], v[208:215], v244
    v_cvt_pk_bf16_f32 v208, v144, v145
    v_mfma_f32_32x32x16_bf16 v[128:143], v[216:219], v[192:195], 0
    v_cvt_pk_bf16_f32 v209, v146, v147
    v_exp_f32 v150, v150
    v_cvt_pk_bf16_f32 v210, v148, v149
    v_exp_f32 v151, v151
    v_mfma_f32_32x32x16_bf16 v[128:143], v[220:223], v[196:199], v[128:143]
    v_exp_f32 v152, v152
    v_cvt_pk_bf16_f32 v211, v150, v151
    v_exp_f32 v153, v153
    v_exp_f32 v154, v154
    v_mfma_f32_32x32x16_bf16 v[112:127], v[224:227], v[208:211], v[112:127]
    ds_read_b128 v[224:227], v250 offset:6144
    v_cvt_pk_bf16_f32 v212, v152, v153
    v_exp_f32 v155, v155
    v_exp_f32 v156, v156
    v_cvt_pk_bf16_f32 v213, v154, v155
    v_exp_f32 v157, v157
    v_exp_f32 v158, v158
    v_cvt_pk_bf16_f32 v214, v156, v157
    v_exp_f32 v159, v159
    v_exp_f32 v128, v128
    v_cvt_pk_bf16_f32 v215, v158, v159
    v_exp_f32 v129, v129
    v_exp_f32 v130, v130
    v_mfma_f32_32x32x16_bf16 v[112:127], v[228:231], v[212:215], v[112:127]
    s_waitcnt lgkmcnt(0)
    v_exp_f32 v131, v131
    v_exp_f32 v132, v132
    v_exp_f32 v133, v133
    v_smfmac_f32_16x16x64_bf16 v[236:239], v[240:243], v[208:215], v244
    ds_read_b128 v[228:231], v250 offset:7168
    v_cvt_pk_bf16_f32 v208, v128, v129
    v_mfma_f32_32x32x16_bf16 v[144:159], v[216:219], v[200:203], 0
    ds_read_b128 v[216:219], v250 offset:4096
    v_cvt_pk_bf16_f32 v209, v130, v131
    v_exp_f32 v134, v134
    v_exp_f32 v135, v135
    v_mfma_f32_32x32x16_bf16 v[144:159], v[220:223], v[204:207], v[144:159]
    ds_read_b128 v[220:223], v250 offset:5120
    v_cvt_pk_bf16_f32 v210, v132, v133
    v_cvt_pk_bf16_f32 v211, v134, v135
    v_exp_f32 v136, v136
    v_exp_f32 v137, v137
    v_mfma_f32_32x32x16_bf16 v[96:111], v[224:227], v[208:211], v[96:111]
    s_waitcnt lgkmcnt(2)
    v_exp_f32 v138, v138
    v_cvt_pk_bf16_f32 v212, v136, v137
    v_exp_f32 v139, v139
    v_exp_f32 v140, v140
    v_cvt_pk_bf16_f32 v213, v138, v139
    v_exp_f32 v141, v141
    v_exp_f32 v142, v142
    v_cvt_pk_bf16_f32 v214, v140, v141
    v_exp_f32 v143, v143
    v_exp_f32 v144, v144
    v_cvt_pk_bf16_f32 v215, v142, v143
    v_exp_f32 v145, v145
    v_exp_f32 v146, v146
    v_mfma_f32_32x32x16_bf16 v[96:111], v[228:231], v[212:215], v[96:111]
    s_waitcnt lgkmcnt(0)
    v_exp_f32 v147, v147
    v_exp_f32 v148, v148
    v_exp_f32 v149, v149
    v_smfmac_f32_16x16x64_bf16 v[232:235], v[240:243], v[208:215], v244
    s_barrier
    v_cvt_pk_bf16_f32 v208, v144, v145
    v_mfma_f32_32x32x16_bf16 v[128:143], v[216:219], v[192:195], 0
    v_cvt_pk_bf16_f32 v209, v146, v147
    v_exp_f32 v150, v150
    v_cvt_pk_bf16_f32 v210, v148, v149
    v_exp_f32 v151, v151
    v_mfma_f32_32x32x16_bf16 v[128:143], v[220:223], v[196:199], v[128:143]
    v_exp_f32 v152, v152
    v_cvt_pk_bf16_f32 v211, v150, v151
    v_exp_f32 v153, v153
    v_exp_f32 v154, v154
    v_mfma_f32_32x32x16_bf16 v[112:127], v[224:227], v[208:211], v[112:127]
    ds_read_b128 v[224:227], v250 offset:10240
    v_cvt_pk_bf16_f32 v212, v152, v153
    v_exp_f32 v155, v155
    v_exp_f32 v156, v156
    v_cvt_pk_bf16_f32 v213, v154, v155
    v_exp_f32 v157, v157
    v_exp_f32 v158, v158
    v_cvt_pk_bf16_f32 v214, v156, v157
    v_exp_f32 v159, v159
    v_exp_f32 v128, v128
    v_cvt_pk_bf16_f32 v215, v158, v159
    v_exp_f32 v129, v129
    v_exp_f32 v130, v130
    v_mfma_f32_32x32x16_bf16 v[112:127], v[228:231], v[212:215], v[112:127]
    s_waitcnt lgkmcnt(0)
    v_exp_f32 v131, v131
    v_exp_f32 v132, v132
    v_exp_f32 v133, v133
    v_smfmac_f32_16x16x64_bf16 v[236:239], v[240:243], v[208:215], v244
    ds_read_b128 v[228:231], v250 offset:11264
    v_cvt_pk_bf16_f32 v208, v128, v129
    v_mfma_f32_32x32x16_bf16 v[144:159], v[216:219], v[200:203], 0
    ds_read_b128 v[216:219], v250 offset:8192
    v_cvt_pk_bf16_f32 v209, v130, v131
    v_exp_f32 v134, v134
    v_exp_f32 v135, v135
    v_mfma_f32_32x32x16_bf16 v[144:159], v[220:223], v[204:207], v[144:159]
    ds_read_b128 v[220:223], v250 offset:9216
    v_cvt_pk_bf16_f32 v210, v132, v133
    v_cvt_pk_bf16_f32 v211, v134, v135
    v_exp_f32 v136, v136
    v_exp_f32 v137, v137
    v_mfma_f32_32x32x16_bf16 v[96:111], v[224:227], v[208:211], v[96:111]
    s_waitcnt lgkmcnt(2)
    v_exp_f32 v138, v138
    v_cvt_pk_bf16_f32 v212, v136, v137
    v_exp_f32 v139, v139
    v_exp_f32 v140, v140
    v_cvt_pk_bf16_f32 v213, v138, v139
    v_exp_f32 v141, v141
    v_exp_f32 v142, v142
    v_cvt_pk_bf16_f32 v214, v140, v141
    v_exp_f32 v143, v143
    v_exp_f32 v144, v144
    v_cvt_pk_bf16_f32 v215, v142, v143
    v_exp_f32 v145, v145
    v_exp_f32 v146, v146
    v_mfma_f32_32x32x16_bf16 v[96:111], v[228:231], v[212:215], v[96:111]
    s_waitcnt lgkmcnt(0)
    v_exp_f32 v147, v147
    v_exp_f32 v148, v148
    v_exp_f32 v149, v149
    v_smfmac_f32_16x16x64_bf16 v[232:235], v[240:243], v[208:215], v244
    v_cvt_pk_bf16_f32 v208, v144, v145
    v_mfma_f32_32x32x16_bf16 v[128:143], v[216:219], v[192:195], 0
    v_cvt_pk_bf16_f32 v209, v146, v147
    v_exp_f32 v150, v150
    v_cvt_pk_bf16_f32 v210, v148, v149
    v_exp_f32 v151, v151
    v_mfma_f32_32x32x16_bf16 v[128:143], v[220:223], v[196:199], v[128:143]
    v_exp_f32 v152, v152
    v_cvt_pk_bf16_f32 v211, v150, v151
    v_exp_f32 v153, v153
    v_exp_f32 v154, v154
    v_mfma_f32_32x32x16_bf16 v[112:127], v[224:227], v[208:211], v[112:127]
    ds_read_b128 v[224:227], v250 offset:14336
    v_cvt_pk_bf16_f32 v212, v152, v153
    v_exp_f32 v155, v155
    v_exp_f32 v156, v156
    v_cvt_pk_bf16_f32 v213, v154, v155
    v_exp_f32 v157, v157
    v_exp_f32 v158, v158
    v_cvt_pk_bf16_f32 v214, v156, v157
    v_exp_f32 v159, v159
    v_exp_f32 v128, v128
    v_cvt_pk_bf16_f32 v215, v158, v159
    v_exp_f32 v129, v129
    v_exp_f32 v130, v130
    v_mfma_f32_32x32x16_bf16 v[112:127], v[228:231], v[212:215], v[112:127]
    s_waitcnt lgkmcnt(0)
    v_exp_f32 v131, v131
    v_exp_f32 v132, v132
    v_exp_f32 v133, v133
    v_smfmac_f32_16x16x64_bf16 v[236:239], v[240:243], v[208:215], v244
    ds_read_b128 v[228:231], v250 offset:15360
    v_cvt_pk_bf16_f32 v208, v128, v129
    v_mfma_f32_32x32x16_bf16 v[144:159], v[216:219], v[200:203], 0
    ds_read_b128 v[216:219], v250 offset:12288
    v_cvt_pk_bf16_f32 v209, v130, v131
    v_exp_f32 v134, v134
    v_exp_f32 v135, v135
    v_mfma_f32_32x32x16_bf16 v[144:159], v[220:223], v[204:207], v[144:159]
    ds_read_b128 v[220:223], v250 offset:13312
    v_cvt_pk_bf16_f32 v210, v132, v133
    v_cvt_pk_bf16_f32 v211, v134, v135
    v_exp_f32 v136, v136
    v_exp_f32 v137, v137
    v_mfma_f32_32x32x16_bf16 v[96:111], v[224:227], v[208:211], v[96:111]
    s_waitcnt lgkmcnt(2)
    v_exp_f32 v138, v138
    v_cvt_pk_bf16_f32 v212, v136, v137
    v_exp_f32 v139, v139
    v_exp_f32 v140, v140
    v_cvt_pk_bf16_f32 v213, v138, v139
    v_exp_f32 v141, v141
    v_exp_f32 v142, v142
    v_cvt_pk_bf16_f32 v214, v140, v141
    v_exp_f32 v143, v143
    v_exp_f32 v144, v144
    v_cvt_pk_bf16_f32 v215, v142, v143
    v_exp_f32 v145, v145
    v_exp_f32 v146, v146
    v_mfma_f32_32x32x16_bf16 v[96:111], v[228:231], v[212:215], v[96:111]
    s_waitcnt lgkmcnt(0)
    v_exp_f32 v147, v147
    v_exp_f32 v148, v148
    v_exp_f32 v149, v149
    v_smfmac_f32_16x16x64_bf16 v[232:235], v[240:243], v[208:215], v244
    v_cvt_pk_bf16_f32 v208, v144, v145
    v_mfma_f32_32x32x16_bf16 v[128:143], v[216:219], v[192:195], 0
    v_cvt_pk_bf16_f32 v209, v146, v147
    v_exp_f32 v150, v150
    v_cvt_pk_bf16_f32 v210, v148, v149
    v_exp_f32 v151, v151
    v_mfma_f32_32x32x16_bf16 v[128:143], v[220:223], v[196:199], v[128:143]
    v_exp_f32 v152, v152
    v_cvt_pk_bf16_f32 v211, v150, v151
    v_exp_f32 v153, v153
    v_exp_f32 v154, v154
    v_mfma_f32_32x32x16_bf16 v[112:127], v[224:227], v[208:211], v[112:127]
    ds_read_b128 v[224:227], v250 offset:18432
    v_cvt_pk_bf16_f32 v212, v152, v153
    v_exp_f32 v155, v155
    v_exp_f32 v156, v156
    v_cvt_pk_bf16_f32 v213, v154, v155
    v_exp_f32 v157, v157
    v_exp_f32 v158, v158
    v_cvt_pk_bf16_f32 v214, v156, v157
    v_exp_f32 v159, v159
    v_exp_f32 v128, v128
    v_cvt_pk_bf16_f32 v215, v158, v159
    v_exp_f32 v129, v129
    v_exp_f32 v130, v130
    v_mfma_f32_32x32x16_bf16 v[112:127], v[228:231], v[212:215], v[112:127]
    s_waitcnt lgkmcnt(0)
    v_exp_f32 v131, v131
    v_exp_f32 v132, v132
    v_exp_f32 v133, v133
    v_smfmac_f32_16x16x64_bf16 v[236:239], v[240:243], v[208:215], v244
    ds_read_b128 v[228:231], v250 offset:19456
    v_cvt_pk_bf16_f32 v208, v128, v129
    v_mfma_f32_32x32x16_bf16 v[144:159], v[216:219], v[200:203], 0
    ds_read_b128 v[216:219], v250 offset:16384
    v_cvt_pk_bf16_f32 v209, v130, v131
    v_exp_f32 v134, v134
    v_exp_f32 v135, v135
    v_mfma_f32_32x32x16_bf16 v[144:159], v[220:223], v[204:207], v[144:159]
    ds_read_b128 v[220:223], v250 offset:17408
    v_cvt_pk_bf16_f32 v210, v132, v133
    v_cvt_pk_bf16_f32 v211, v134, v135
    v_exp_f32 v136, v136
    v_exp_f32 v137, v137
    v_mfma_f32_32x32x16_bf16 v[96:111], v[224:227], v[208:211], v[96:111]
    s_waitcnt lgkmcnt(2)
    v_exp_f32 v138, v138
    v_cvt_pk_bf16_f32 v212, v136, v137
    v_exp_f32 v139, v139
    v_exp_f32 v140, v140
    v_cvt_pk_bf16_f32 v213, v138, v139
    v_exp_f32 v141, v141
    v_exp_f32 v142, v142
    v_cvt_pk_bf16_f32 v214, v140, v141
    v_exp_f32 v143, v143
    v_exp_f32 v144, v144
    v_cvt_pk_bf16_f32 v215, v142, v143
    v_exp_f32 v145, v145
    v_exp_f32 v146, v146
    v_mfma_f32_32x32x16_bf16 v[96:111], v[228:231], v[212:215], v[96:111]
    s_waitcnt lgkmcnt(0)
    v_exp_f32 v147, v147
    v_exp_f32 v148, v148
    v_exp_f32 v149, v149
    v_smfmac_f32_16x16x64_bf16 v[232:235], v[240:243], v[208:215], v244
    v_cvt_pk_bf16_f32 v208, v144, v145
    v_mfma_f32_32x32x16_bf16 v[128:143], v[216:219], v[192:195], 0
    v_cvt_pk_bf16_f32 v209, v146, v147
    v_exp_f32 v150, v150
    v_cvt_pk_bf16_f32 v210, v148, v149
    v_exp_f32 v151, v151
    v_mfma_f32_32x32x16_bf16 v[128:143], v[220:223], v[196:199], v[128:143]
    v_exp_f32 v152, v152
    v_cvt_pk_bf16_f32 v211, v150, v151
    v_exp_f32 v153, v153
    v_exp_f32 v154, v154
    v_mfma_f32_32x32x16_bf16 v[112:127], v[224:227], v[208:211], v[112:127]
    ds_read_b128 v[224:227], v250 offset:22528
    v_cvt_pk_bf16_f32 v212, v152, v153
    v_exp_f32 v155, v155
    v_exp_f32 v156, v156
    v_cvt_pk_bf16_f32 v213, v154, v155
    v_exp_f32 v157, v157
    v_exp_f32 v158, v158
    v_cvt_pk_bf16_f32 v214, v156, v157
    v_exp_f32 v159, v159
    v_exp_f32 v128, v128
    v_cvt_pk_bf16_f32 v215, v158, v159
    v_exp_f32 v129, v129
    v_exp_f32 v130, v130
    v_mfma_f32_32x32x16_bf16 v[112:127], v[228:231], v[212:215], v[112:127]
    s_waitcnt lgkmcnt(0)
    v_exp_f32 v131, v131
    v_exp_f32 v132, v132
    v_exp_f32 v133, v133
    v_smfmac_f32_16x16x64_bf16 v[236:239], v[240:243], v[208:215], v244
    ds_read_b128 v[228:231], v250 offset:23552
    v_cvt_pk_bf16_f32 v208, v128, v129
    v_mfma_f32_32x32x16_bf16 v[144:159], v[216:219], v[200:203], 0
    ds_read_b128 v[216:219], v250 offset:20480
    v_cvt_pk_bf16_f32 v209, v130, v131
    v_exp_f32 v134, v134
    v_exp_f32 v135, v135
    v_mfma_f32_32x32x16_bf16 v[144:159], v[220:223], v[204:207], v[144:159]
    ds_read_b128 v[220:223], v250 offset:21504
    v_cvt_pk_bf16_f32 v210, v132, v133
    v_cvt_pk_bf16_f32 v211, v134, v135
    v_exp_f32 v136, v136
    v_exp_f32 v137, v137
    v_mfma_f32_32x32x16_bf16 v[96:111], v[224:227], v[208:211], v[96:111]
    s_branch PG6_go
    .p2align 12
PG6:
    s_setpc_b64 s[72:73]
    s_nop 0
PG6_go:
    s_waitcnt lgkmcnt(2)
    v_exp_f32 v138, v138
    v_cvt_pk_bf16_f32 v212, v136, v137
    v_exp_f32 v139, v139
    v_exp_f32 v140, v140
    v_cvt_pk_bf16_f32 v213, v138, v139
    v_exp_f32 v141, v141
    v_exp_f32 v142, v142
    v_cvt_pk_bf16_f32 v214, v140, v141
    v_exp_f32 v143, v143
    v_exp_f32 v144, v144
    v_cvt_pk_bf16_f32 v215, v142, v143
    v_exp_f32 v145, v145
    v_exp_f32 v146, v146
    v_mfma_f32_32x32x16_bf16 v[96:111], v[228:231], v[212:215], v[96:111]
    s_waitcnt vmcnt(0) lgkmcnt(0)
    v_exp_f32 v147, v147
    v_exp_f32 v148, v148
    v_exp_f32 v149, v149
    v_smfmac_f32_16x16x64_bf16 v[232:235], v[240:243], v[208:215], v244
    s_barrier
    v_cvt_pk_bf16_f32 v208, v144, v145
    v_mfma_f32_32x32x16_bf16 v[128:143], v[216:219], v[192:195], 0
    v_cvt_pk_bf16_f32 v209, v146, v147
    v_exp_f32 v150, v150
    v_cvt_pk_bf16_f32 v210, v148, v149
    v_exp_f32 v151, v151
    v_mfma_f32_32x32x16_bf16 v[128:143], v[220:223], v[196:199], v[128:143]
    v_exp_f32 v152, v152
    v_cvt_pk_bf16_f32 v211, v150, v151
    v_exp_f32 v153, v153
    v_exp_f32 v154, v154
    v_mfma_f32_32x32x16_bf16 v[112:127], v[224:227], v[208:211], v[112:127]
    ds_read_b128 v[224:227], v250 offset:26624
    v_cvt_pk_bf16_f32 v212, v152, v153
    v_exp_f32 v155, v155
    v_exp_f32 v156, v156
    v_cvt_pk_bf16_f32 v213, v154, v155
    v_exp_f32 v157, v157
    v_exp_f32 v158, v158
    v_cvt_pk_bf16_f32 v214, v156, v157
    v_exp_f32 v159, v159
    v_exp_f32 v128, v128
    v_cvt_pk_bf16_f32 v215, v158, v159
    v_exp_f32 v129, v129
    v_exp_f32 v130, v130
    v_mfma_f32_32x32x16_bf16 v[112:127], v[228:231], v[212:215], v[112:127]
    s_waitcnt lgkmcnt(0)
    v_exp_f32 v131, v131
    v_exp_f32 v132, v132
    v_exp_f32 v133, v133
    v_smfmac_f32_16x16x64_bf16 v[236:239], v[240:243], v[208:215], v244
    ds_read_b128 v[228:231], v250 offset:27648
    v_cvt_pk_bf16_f32 v208, v128, v129
    v_mfma_f32_32x32x16_bf16 v[144:159], v[216:219], v[200:203], 0
    ds_read_b128 v[216:219], v250 offset:24576
    v_cvt_pk_bf16_f32 v209, v130, v131
    v_exp_f32 v134, v134
    v_exp_f32 v135, v135
    v_mfma_f32_32x32x16_bf16 v[144:159], v[220:223], v[204:207], v[144:159]
    ds_read_b128 v[220:223], v250 offset:25600
    v_cvt_pk_bf16_f32 v210, v132, v133
    v_cvt_pk_bf16_f32 v211, v134, v135
    v_exp_f32 v136, v136
    v_exp_f32 v137, v137
    v_mfma_f32_32x32x16_bf16 v[96:111], v[224:227], v[208:211], v[96:111]
    s_waitcnt lgkmcnt(2)
    v_exp_f32 v138, v138
    v_cvt_pk_bf16_f32 v212, v136, v137
    v_exp_f32 v139, v139
    v_exp_f32 v140, v140
    v_cvt_pk_bf16_f32 v213, v138, v139
    v_exp_f32 v141, v141
    v_exp_f32 v142, v142
    v_cvt_pk_bf16_f32 v214, v140, v141
    v_exp_f32 v143, v143
    v_exp_f32 v144, v144
    v_cvt_pk_bf16_f32 v215, v142, v143
    v_exp_f32 v145, v145
    v_exp_f32 v146, v146
    v_mfma_f32_32x32x16_bf16 v[96:111], v[228:231], v[212:215], v[96:111]
    s_waitcnt lgkmcnt(0)
    v_exp_f32 v147, v147
    v_exp_f32 v148, v148
    v_exp_f32 v149, v149
    v_smfmac_f32_16x16x64_bf16 v[232:235], v[240:243], v[208:215], v244
    v_cvt_pk_bf16_f32 v208, v144, v145
    v_mfma_f32_32x32x16_bf16 v[128:143], v[216:219], v[192:195], 0
    v_cvt_pk_bf16_f32 v209, v146, v147
    v_exp_f32 v150, v150
    v_cvt_pk_bf16_f32 v210, v148, v149
    v_exp_f32 v151, v151
    v_mfma_f32_32x32x16_bf16 v[128:143], v[220:223], v[196:199], v[128:143]
    v_exp_f32 v152, v152
    v_cvt_pk_bf16_f32 v211, v150, v151
    v_exp_f32 v153, v153
    v_exp_f32 v154, v154
    v_mfma_f32_32x32x16_bf16 v[112:127], v[224:227], v[208:211], v[112:127]
    ds_read_b128 v[224:227], v250 offset:30720
    v_cvt_pk_bf16_f32 v212, v152, v153
    v_exp_f32 v155, v155
    v_exp_f32 v156, v156
    v_cvt_pk_bf16_f32 v213, v154, v155
    v_exp_f32 v157, v157
    v_exp_f32 v158, v158
    v_cvt_pk_bf16_f32 v214, v156, v157
    v_exp_f32 v159, v159
    v_exp_f32 v128, v128
    v_cvt_pk_bf16_f32 v215, v158, v159
    v_exp_f32 v129, v129
    v_exp_f32 v130, v130
    v_mfma_f32_32x32x16_bf16 v[112:127], v[228:231], v[212:215], v[112:127]
    s_waitcnt lgkmcnt(0)
    v_exp_f32 v131, v131
    v_exp_f32 v132, v132
    v_exp_f32 v133, v133
    v_smfmac_f32_16x16x64_bf16 v[236:239], v[240:243], v[208:215], v244
    ds_read_b128 v[228:231], v250 offset:31744
    v_cvt_pk_bf16_f32 v208, v128, v129
    v_mfma_f32_32x32x16_bf16 v[144:159], v[216:219], v[200:203], 0
    ds_read_b128 v[216:219], v250 offset:28672
    v_cvt_pk_bf16_f32 v209, v130, v131
    v_exp_f32 v134, v134
    v_exp_f32 v135, v135
    v_mfma_f32_32x32x16_bf16 v[144:159], v[220:223], v[204:207], v[144:159]
    ds_read_b128 v[220:223], v250 offset:29696
    v_cvt_pk_bf16_f32 v210, v132, v133
    v_cvt_pk_bf16_f32 v211, v134, v135
    v_exp_f32 v136, v136
    v_exp_f32 v137, v137
    v_mfma_f32_32x32x16_bf16 v[96:111], v[224:227], v[208:211], v[96:111]
    s_waitcnt lgkmcnt(2)
    v_exp_f32 v138, v138
    v_cvt_pk_bf16_f32 v212, v136, v137
    v_exp_f32 v139, v139
    v_exp_f32 v140, v140
    v_cvt_pk_bf16_f32 v213, v138, v139
    v_exp_f32 v141, v141
    v_exp_f32 v142, v142
    v_cvt_pk_bf16_f32 v214, v140, v141
    v_exp_f32 v143, v143
    v_exp_f32 v144, v144
    v_cvt_pk_bf16_f32 v215, v142, v143
    v_exp_f32 v145, v145
    v_exp_f32 v146, v146
    v_mfma_f32_32x32x16_bf16 v[96:111], v[228:231], v[212:215], v[96:111]
    s_waitcnt lgkmcnt(0)
    v_exp_f32 v147, v147
    v_exp_f32 v148, v148
    v_exp_f32 v149, v149
    v_smfmac_f32_16x16x64_bf16 v[232:235], v[240:243], v[208:215], v244
    v_cvt_pk_bf16_f32 v208, v144, v145
    v_mfma_f32_32x32x16_bf16 v[128:143], v[216:219], v[192:195], 0
    s_sub_u32 s50, s50, 1
    v_cvt_pk_bf16_f32 v209, v146, v147
    v_exp_f32 v150, v150
    v_cvt_pk_bf16_f32 v210, v148, v149
    v_exp_f32 v151, v151
    v_mfma_f32_32x32x16_bf16 v[128:143], v[220:223], v[196:199], v[128:143]
    s_cmp_lg_u32 s50, 0
    v_exp_f32 v152, v152
    v_cvt_pk_bf16_f32 v211, v150, v151
    v_exp_f32 v153, v153
    v_exp_f32 v154, v154
    v_mfma_f32_32x32x16_bf16 v[112:127], v[224:227], v[208:211], v[112:127]
    ds_read_b128 v[224:227], v250 offset:2048
    v_cvt_pk_bf16_f32 v212, v152, v153
    v_exp_f32 v155, v155
    v_exp_f32 v156, v156
    v_cvt_pk_bf16_f32 v213, v154, v155
    v_exp_f32 v157, v157
    v_exp_f32 v158, v158
    v_cvt_pk_bf16_f32 v214, v156, v157
    v_exp_f32 v159, v159
    s_cbranch_scc1 A_attonly
    v_exp_f32 v128, v128
    v_cvt_pk_bf16_f32 v215, v158, v159
    v_exp_f32 v129, v129
    v_exp_f32 v130, v130
    v_mfma_f32_32x32x16_bf16 v[112:127], v[228:231], v[212:215], v[112:127]
    s_waitcnt lgkmcnt(0)
    v_exp_f32 v131, v131
    v_exp_f32 v132, v132
    v_exp_f32 v133, v133
    v_smfmac_f32_16x16x64_bf16 v[236:239], v[240:243], v[208:215], v244
    ds_read_b128 v[228:231], v250 offset:3072
    v_cvt_pk_bf16_f32 v208, v128, v129
    v_mfma_f32_32x32x16_bf16 v[144:159], v[216:219], v[200:203], 0
    ds_read_b128 v[216:219], v250 offset:0
    v_cvt_pk_bf16_f32 v209, v130, v131
    v_exp_f32 v134, v134
    v_exp_f32 v135, v135
    v_mfma_f32_32x32x16_bf16 v[144:159], v[220:223], v[204:207], v[144:159]
    ds_read_b128 v[220:223], v250 offset:1024
    v_cvt_pk_bf16_f32 v210, v132, v133
    v_cvt_pk_bf16_f32 v211, v134, v135
    v_exp_f32 v136, v136
    v_exp_f32 v137, v137
    v_mfma_f32_32x32x16_bf16 v[96:111], v[224:227], v[208:211], v[96:111]
    s_waitcnt lgkmcnt(2)
    v_exp_f32 v138, v138
    v_cvt_pk_bf16_f32 v212, v136, v137
    v_exp_f32 v139, v139
    v_exp_f32 v140, v140
    v_cvt_pk_bf16_f32 v213, v138, v139
    v_exp_f32 v141, v141
    v_exp_f32 v142, v142
    v_cvt_pk_bf16_f32 v214, v140, v141
    v_exp_f32 v143, v143
    v_exp_f32 v144, v144
    v_cvt_pk_bf16_f32 v215, v142, v143
    v_exp_f32 v145, v145
    v_exp_f32 v146, v146
    v_mfma_f32_32x32x16_bf16 v[96:111], v[228:231], v[212:215], v[96:111]
    s_waitcnt lgkmcnt(0)
    v_exp_f32 v147, v147
    v_exp_f32 v148, v148
    v_exp_f32 v149, v149
    v_smfmac_f32_16x16x64_bf16 v[232:235], v[240:243], v[208:215], v244
    v_cvt_pk_bf16_f32 v208, v144, v145
    v_mfma_f32_32x32x16_bf16 v[128:143], v[216:219], v[192:195], 0
    v_cvt_pk_bf16_f32 v209, v146, v147
    v_exp_f32 v150, v150
    v_cvt_pk_bf16_f32 v210, v148, v149
    v_exp_f32 v151, v151
    v_mfma_f32_32x32x16_bf16 v[128:143], v[220:223], v[196:199], v[128:143]
    v_exp_f32 v152, v152
    v_cvt_pk_bf16_f32 v211, v150, v151
    v_exp_f32 v153, v153
    v_exp_f32 v154, v154
    v_mfma_f32_32x32x16_bf16 v[112:127], v[224:227], v[208:211], v[112:127]
    ds_read_b128 v[224:227], v250 offset:6144
    v_cvt_pk_bf16_f32 v212, v152, v153
    v_exp_f32 v155, v155
    v_exp_f32 v156, v156
    v_cvt_pk_bf16_f32 v213, v154, v155
    v_exp_f32 v157, v157
    v_exp_f32 v158, v158
    v_cvt_pk_bf16_f32 v214, v156, v157
    v_exp_f32 v159, v159
    v_exp_f32 v128, v128
    v_cvt_pk_bf16_f32 v215, v158, v159
    v_exp_f32 v129, v129
    v_exp_f32 v130, v130
    v_mfma_f32_32x32x16_bf16 v[112:127], v[228:231], v[212:215], v[112:127]
    s_waitcnt lgkmcnt(0)
    v_exp_f32 v131, v131
    v_exp_f32 v132, v132
    v_exp_f32 v133, v133
    v_smfmac_f32_16x16x64_bf16 v[236:239], v[240:243], v[208:215], v244
    ds_read_b128 v[228:231], v250 offset:7168
    v_cvt_pk_bf16_f32 v208, v128, v129
    v_mfma_f32_32x32x16_bf16 v[144:159], v[216:219], v[200:203], 0
    ds_read_b128 v[216:219], v250 offset:4096
    v_cvt_pk_bf16_f32 v209, v130, v131
    v_exp_f32 v134, v134
    v_exp_f32 v135, v135
    v_mfma_f32_32x32x16_bf16 v[144:159], v[220:223], v[204:207], v[144:159]
    ds_read_b128 v[220:223], v250 offset:5120
    v_cvt_pk_bf16_f32 v210, v132, v133
    v_cvt_pk_bf16_f32 v211, v134, v135
    v_exp_f32 v136, v136
    v_exp_f32 v137, v137
    v_mfma_f32_32x32x16_bf16 v[96:111], v[224:227], v[208:211], v[96:111]
    s_waitcnt lgkmcnt(2)
    v_exp_f32 v138, v138
    v_cvt_pk_bf16_f32 v212, v136, v137
    v_exp_f32 v139, v139
    v_exp_f32 v140, v140
    v_cvt_pk_bf16_f32 v213, v138, v139
    v_exp_f32 v141, v141
    v_exp_f32 v142, v142
    v_cvt_pk_bf16_f32 v214, v140, v141
    v_exp_f32 v143, v143
    v_exp_f32 v144, v144
    v_cvt_pk_bf16_f32 v215, v142, v143
    v_exp_f32 v145, v145
    v_exp_f32 v146, v146
    v_mfma_f32_32x32x16_bf16 v[96:111], v[228:231], v[212:215], v[96:111]
    s_waitcnt lgkmcnt(0)
    v_exp_f32 v147, v147
    v_exp_f32 v148, v148
    v_exp_f32 v149, v149
    v_smfmac_f32_16x16x64_bf16 v[232:235], v[240:243], v[208:215], v244
    s_barrier
    v_cvt_pk_bf16_f32 v208, v144, v145
    v_mfma_f32_32x32x16_bf16 v[128:143], v[216:219], v[192:195], 0
    v_cvt_pk_bf16_f32 v209, v146, v147
    v_exp_f32 v150, v150
    v_cvt_pk_bf16_f32 v210, v148, v149
    v_exp_f32 v151, v151
    v_mfma_f32_32x32x16_bf16 v[128:143], v[220:223], v[196:199], v[128:143]
    v_exp_f32 v152, v152
    v_cvt_pk_bf16_f32 v211, v150, v151
    v_exp_f32 v153, v153
    v_exp_f32 v154, v154
    v_mfma_f32_32x32x16_bf16 v[112:127], v[224:227], v[208:211], v[112:127]
    ds_read_b128 v[224:227], v250 offset:10240
    v_cvt_pk_bf16_f32 v212, v152, v153
    v_exp_f32 v155, v155
    v_exp_f32 v156, v156
    v_cvt_pk_bf16_f32 v213, v154, v155
    v_exp_f32 v157, v157
    v_exp_f32 v158, v158
    v_cvt_pk_bf16_f32 v214, v156, v157
    v_exp_f32 v159, v159
    v_exp_f32 v128, v128
    v_cvt_pk_bf16_f32 v215, v158, v159
    v_exp_f32 v129, v129
    v_exp_f32 v130, v130
    v_mfma_f32_32x32x16_bf16 v[112:127], v[228:231], v[212:215], v[112:127]
    s_waitcnt lgkmcnt(0)
    v_exp_f32 v131, v131
    v_exp_f32 v132, v132
    v_exp_f32 v133, v133
    v_smfmac_f32_16x16x64_bf16 v[236:239], v[240:243], v[208:215], v244
    ds_read_b128 v[228:231], v250 offset:11264
    v_cvt_pk_bf16_f32 v208, v128, v129
    v_mfma_f32_32x32x16_bf16 v[144:159], v[216:219], v[200:203], 0
    ds_read_b128 v[216:219], v250 offset:8192
    v_cvt_pk_bf16_f32 v209, v130, v131
    v_exp_f32 v134, v134
    v_exp_f32 v135, v135
    v_mfma_f32_32x32x16_bf16 v[144:159], v[220:223], v[204:207], v[144:159]
    ds_read_b128 v[220:223], v250 offset:9216
    v_cvt_pk_bf16_f32 v210, v132, v133
    v_cvt_pk_bf16_f32 v211, v134, v135
    v_exp_f32 v136, v136
    v_exp_f32 v137, v137
    v_mfma_f32_32x32x16_bf16 v[96:111], v[224:227], v[208:211], v[96:111]
    s_waitcnt lgkmcnt(2)
    buffer_load_dwordx4 v[0:3], v245, s[24:27], s56 offen offset:0 sc1
    v_exp_f32 v138, v138
    v_cvt_pk_bf16_f32 v212, v136, v137
    v_exp_f32 v139, v139
    v_exp_f32 v140, v140
    v_cvt_pk_bf16_f32 v213, v138, v139
    v_exp_f32 v141, v141
    v_exp_f32 v142, v142
    v_cvt_pk_bf16_f32 v214, v140, v141
    v_exp_f32 v143, v143
    v_exp_f32 v144, v144
    v_cvt_pk_bf16_f32 v215, v142, v143
    v_exp_f32 v145, v145
    v_exp_f32 v146, v146
    v_mfma_f32_32x32x16_bf16 v[96:111], v[228:231], v[212:215], v[96:111]
    s_waitcnt lgkmcnt(0)
    v_exp_f32 v147, v147
    v_exp_f32 v148, v148
    v_exp_f32 v149, v149
    v_smfmac_f32_16x16x64_bf16 v[232:235], v[240:243], v[208:215], v244
    buffer_load_dwordx4 v[4:7], v245, s[24:27], s56 offen offset:1024 sc1
    v_cvt_pk_bf16_f32 v208, v144, v145
    v_mfma_f32_32x32x16_bf16 v[128:143], v[216:219], v[192:195], 0
    buffer_load_dwordx4 v[8:11], v246, s[24:27], s56 offen offset:0 sc1
    v_cvt_pk_bf16_f32 v209, v146, v147
    v_exp_f32 v150, v150
    v_cvt_pk_bf16_f32 v210, v148, v149
    v_exp_f32 v151, v151
    v_mfma_f32_32x32x16_bf16 v[128:143], v[220:223], v[196:199], v[128:143]
    buffer_load_dwordx4 v[12:15], v246, s[24:27], s56 offen offset:1024 sc1
    v_exp_f32 v152, v152
    v_cvt_pk_bf16_f32 v211, v150, v151
    v_exp_f32 v153, v153
    v_exp_f32 v154, v154
    v_mfma_f32_32x32x16_bf16 v[112:127], v[224:227], v[208:211], v[112:127]
    ds_read_b128 v[224:227], v250 offset:14336
    v_cvt_pk_bf16_f32 v212, v152, v153
    v_exp_f32 v155, v155
    v_exp_f32 v156, v156
    v_cvt_pk_bf16_f32 v213, v154, v155
    v_exp_f32 v157, v157
    v_exp_f32 v158, v158
    v_cvt_pk_bf16_f32 v214, v156, v157
    v_exp_f32 v159, v159
    v_exp_f32 v128, v128
    v_cvt_pk_bf16_f32 v215, v158, v159
    v_exp_f32 v129, v129
    v_exp_f32 v130, v130
    v_mfma_f32_32x32x16_bf16 v[112:127], v[228:231], v[212:215], v[112:127]
    s_waitcnt lgkmcnt(0)
    v_exp_f32 v131, v131
    v_exp_f32 v132, v132
    v_exp_f32 v133, v133
    v_smfmac_f32_16x16x64_bf16 v[236:239], v[240:243], v[208:215], v244
    ds_read_b128 v[228:231], v250 offset:15360
    v_cvt_pk_bf16_f32 v208, v128, v129
    v_mfma_f32_32x32x16_bf16 v[144:159], v[216:219], v[200:203], 0
    ds_read_b128 v[216:219], v250 offset:12288
    v_cvt_pk_bf16_f32 v209, v130, v131
    v_exp_f32 v134, v134
    v_exp_f32 v135, v135
    v_mfma_f32_32x32x16_bf16 v[144:159], v[220:223], v[204:207], v[144:159]
    ds_read_b128 v[220:223], v250 offset:13312
    v_cvt_pk_bf16_f32 v210, v132, v133
    v_cvt_pk_bf16_f32 v211, v134, v135
    v_exp_f32 v136, v136
    v_exp_f32 v137, v137
    v_mfma_f32_32x32x16_bf16 v[96:111], v[224:227], v[208:211], v[96:111]
    s_waitcnt lgkmcnt(2)
    buffer_load_dwordx4 v[16:19], v245, s[24:27], s61 offen offset:0 sc1
    v_exp_f32 v138, v138
    v_cvt_pk_bf16_f32 v212, v136, v137
    v_exp_f32 v139, v139
    v_exp_f32 v140, v140
    v_cvt_pk_bf16_f32 v213, v138, v139
    v_exp_f32 v141, v141
    v_exp_f32 v142, v142
    v_cvt_pk_bf16_f32 v214, v140, v141
    v_exp_f32 v143, v143
    v_exp_f32 v144, v144
    v_cvt_pk_bf16_f32 v215, v142, v143
    v_exp_f32 v145, v145
    v_exp_f32 v146, v146
    v_mfma_f32_32x32x16_bf16 v[96:111], v[228:231], v[212:215], v[96:111]
    s_waitcnt lgkmcnt(0)
    v_exp_f32 v147, v147
    v_exp_f32 v148, v148
    v_exp_f32 v149, v149
    v_smfmac_f32_16x16x64_bf16 v[232:235], v[240:243], v[208:215], v244
    buffer_load_dwordx4 v[20:23], v245, s[24:27], s61 offen offset:1024 sc1
    v_cvt_pk_bf16_f32 v208, v144, v145
    v_mfma_f32_32x32x16_bf16 v[128:143], v[216:219], v[192:195], 0
    buffer_load_dwordx4 v[24:27], v246, s[24:27], s61 offen offset:0 sc1
    v_cvt_pk_bf16_f32 v209, v146, v147
    v_exp_f32 v150, v150
    v_cvt_pk_bf16_f32 v210, v148, v149
    v_exp_f32 v151, v151
    v_mfma_f32_32x32x16_bf16 v[128:143], v[220:223], v[196:199], v[128:143]
    buffer_load_dwordx4 v[28:31], v246, s[24:27], s61 offen offset:1024 sc1
    s_add_u32 s56, s56, 4096
    s_cmp_eq_u32 s56, s58
    s_cselect_b32 s56, s57, s56
    s_add_u32 s61, s56, s32
    v_exp_f32 v152, v152
    v_cvt_pk_bf16_f32 v211, v150, v151
    v_exp_f32 v153, v153
    v_exp_f32 v154, v154
    v_mfma_f32_32x32x16_bf16 v[112:127], v[224:227], v[208:211], v[112:127]
    ds_read_b128 v[224:227], v250 offset:18432
    v_cvt_pk_bf16_f32 v212, v152, v153
    v_exp_f32 v155, v155
    v_exp_f32 v156, v156
    v_cvt_pk_bf16_f32 v213, v154, v155
    v_exp_f32 v157, v157
    v_exp_f32 v158, v158
    v_cvt_pk_bf16_f32 v214, v156, v157
    v_exp_f32 v159, v159
    v_exp_f32 v128, v128
    v_cvt_pk_bf16_f32 v215, v158, v159
    v_exp_f32 v129, v129
    v_exp_f32 v130, v130
    v_mfma_f32_32x32x16_bf16 v[112:127], v[228:231], v[212:215], v[112:127]
    s_waitcnt lgkmcnt(0)
    v_exp_f32 v131, v131
    v_exp_f32 v132, v132
    v_exp_f32 v133, v133
    v_smfmac_f32_16x16x64_bf16 v[236:239], v[240:243], v[208:215], v244
    ds_read_b128 v[228:231], v250 offset:19456
    v_cvt_pk_bf16_f32 v208, v128, v129
    v_mfma_f32_32x32x16_bf16 v[144:159], v[216:219], v[200:203], 0
    ds_read_b128 v[216:219], v250 offset:16384
    v_cvt_pk_bf16_f32 v209, v130, v131
    v_exp_f32 v134, v134
    v_exp_f32 v135, v135
    v_mfma_f32_32x32x16_bf16 v[144:159], v[220:223], v[204:207], v[144:159]
    ds_read_b128 v[220:223], v250 offset:17408
    v_cvt_pk_bf16_f32 v210, v132, v133
    v_cvt_pk_bf16_f32 v211, v134, v135
    v_exp_f32 v136, v136
    v_exp_f32 v137, v137
    v_mfma_f32_32x32x16_bf16 v[96:111], v[224:227], v[208:211], v[96:111]
    s_waitcnt lgkmcnt(2)
    buffer_load_dwordx4 v[32:35], v245, s[24:27], s56 offen offset:0 sc1
    v_exp_f32 v138, v138
    v_cvt_pk_bf16_f32 v212, v136, v137
    v_exp_f32 v139, v139
    v_exp_f32 v140, v140
    v_cvt_pk_bf16_f32 v213, v138, v139
    v_exp_f32 v141, v141
    v_exp_f32 v142, v142
    v_cvt_pk_bf16_f32 v214, v140, v141
    v_exp_f32 v143, v143
    v_exp_f32 v144, v144
    v_cvt_pk_bf16_f32 v215, v142, v143
    v_exp_f32 v145, v145
    v_exp_f32 v146, v146
    v_mfma_f32_32x32x16_bf16 v[96:111], v[228:231], v[212:215], v[96:111]
    s_waitcnt lgkmcnt(0)
    v_exp_f32 v147, v147
    v_exp_f32 v148, v148
    v_exp_f32 v149, v149
    v_smfmac_f32_16x16x64_bf16 v[232:235], v[240:243], v[208:215], v244
    buffer_load_dwordx4 v[36:39], v245, s[24:27], s56 offen offset:1024 sc1
    v_cvt_pk_bf16_f32 v208, v144, v145
    v_mfma_f32_32x32x16_bf16 v[128:143], v[216:219], v[192:195], 0
    buffer_load_dwordx4 v[40:43], v246, s[24:27], s56 offen offset:0 sc1
    v_cvt_pk_bf16_f32 v209, v146, v147
    v_exp_f32 v150, v150
    v_cvt_pk_bf16_f32 v210, v148, v149
    v_exp_f32 v151, v151
    v_mfma_f32_32x32x16_bf16 v[128:143], v[220:223], v[196:199], v[128:143]
    buffer_load_dwordx4 v[44:47], v246, s[24:27], s56 offen offset:1024 sc1
    v_exp_f32 v152, v152
    v_cvt_pk_bf16_f32 v211, v150, v151
    v_exp_f32 v153, v153
    v_exp_f32 v154, v154
    v_mfma_f32_32x32x16_bf16 v[112:127], v[224:227], v[208:211], v[112:127]
    ds_read_b128 v[224:227], v250 offset:22528
    v_cvt_pk_bf16_f32 v212, v152, v153
    v_exp_f32 v155, v155
    v_exp_f32 v156, v156
    v_cvt_pk_bf16_f32 v213, v154, v155
    v_exp_f32 v157, v157
    v_exp_f32 v158, v158
    v_cvt_pk_bf16_f32 v214, v156, v157
    v_exp_f32 v159, v159
    v_exp_f32 v128, v128
    v_cvt_pk_bf16_f32 v215, v158, v159
    v_exp_f32 v129, v129
    v_exp_f32 v130, v130
    v_mfma_f32_32x32x16_bf16 v[112:127], v[228:231], v[212:215], v[112:127]
    s_waitcnt lgkmcnt(0)
    v_exp_f32 v131, v131
    v_exp_f32 v132, v132
    v_exp_f32 v133, v133
    v_smfmac_f32_16x16x64_bf16 v[236:239], v[240:243], v[208:215], v244
    ds_read_b128 v[228:231], v250 offset:23552
    v_cvt_pk_bf16_f32 v208, v128, v129
    v_mfma_f32_32x32x16_bf16 v[144:159], v[216:219], v[200:203], 0
    ds_read_b128 v[216:219], v250 offset:20480
    v_cvt_pk_bf16_f32 v209, v130, v131
    v_exp_f32 v134, v134
    v_exp_f32 v135, v135
    v_mfma_f32_32x32x16_bf16 v[144:159], v[220:223], v[204:207], v[144:159]
    ds_read_b128 v[220:223], v250 offset:21504
    v_cvt_pk_bf16_f32 v210, v132, v133
    v_cvt_pk_bf16_f32 v211, v134, v135
    v_exp_f32 v136, v136
    v_exp_f32 v137, v137
    v_mfma_f32_32x32x16_bf16 v[96:111], v[224:227], v[208:211], v[96:111]
    s_waitcnt lgkmcnt(2)
    buffer_load_dwordx4 v[48:51], v245, s[24:27], s61 offen offset:0 sc1
    v_exp_f32 v138, v138
    v_cvt_pk_bf16_f32 v212, v136, v137
    v_exp_f32 v139, v139
    v_exp_f32 v140, v140
    v_cvt_pk_bf16_f32 v213, v138, v139
    v_exp_f32 v141, v141
    v_exp_f32 v142, v142
    v_cvt_pk_bf16_f32 v214, v140, v141
    v_exp_f32 v143, v143
    v_exp_f32 v144, v144
    v_cvt_pk_bf16_f32 v215, v142, v143
    v_exp_f32 v145, v145
    v_exp_f32 v146, v146
    v_mfma_f32_32x32x16_bf16 v[96:111], v[228:231], v[212:215], v[96:111]
    s_waitcnt lgkmcnt(0)
    v_exp_f32 v147, v147
    v_exp_f32 v148, v148
    v_exp_f32 v149, v149
    v_smfmac_f32_16x16x64_bf16 v[232:235], v[240:243], v[208:215], v244
    s_barrier
    buffer_load_dwordx4 v[52:55], v245, s[24:27], s61 offen offset:1024 sc1
    v_cvt_pk_bf16_f32 v208, v144, v145
    v_mfma_f32_32x32x16_bf16 v[128:143], v[216:219], v[192:195], 0
    buffer_load_dwordx4 v[56:59], v246, s[24:27], s61 offen offset:0 sc1
    v_cvt_pk_bf16_f32 v209, v146, v147
    v_exp_f32 v150, v150
    v_cvt_pk_bf16_f32 v210, v148, v149
    v_exp_f32 v151, v151
    v_mfma_f32_32x32x16_bf16 v[128:143], v[220:223], v[196:199], v[128:143]
    buffer_load_dwordx4 v[60:63], v246, s[24:27], s61 offen offset:1024 sc1
    s_add_u32 s56, s56, 4096
    s_cmp_eq_u32 s56, s58
    s_cselect_b32 s56, s57, s56
    s_add_u32 s61, s56, s32
    v_exp_f32 v152, v152
    v_cvt_pk_bf16_f32 v211, v150, v151
    v_exp_f32 v153, v153
    v_exp_f32 v154, v154
    v_mfma_f32_32x32x16_bf16 v[112:127], v[224:227], v[208:211], v[112:127]
    ds_read_b128 v[224:227], v250 offset:26624
    v_cvt_pk_bf16_f32 v212, v152, v153
    v_exp_f32 v155, v155
    v_exp_f32 v156, v156
    v_cvt_pk_bf16_f32 v213, v154, v155
    v_exp_f32 v157, v157
    v_exp_f32 v158, v158
    v_cvt_pk_bf16_f32 v214, v156, v157
    v_exp_f32 v159, v159
    v_exp_f32 v128, v128
    v_cvt_pk_bf16_f32 v215, v158, v159
    v_exp_f32 v129, v129
    v_exp_f32 v130, v130
    v_mfma_f32_32x32x16_bf16 v[112:127], v[228:231], v[212:215], v[112:127]
    s_waitcnt lgkmcnt(0)
    v_exp_f32 v131, v131
    v_exp_f32 v132, v132
    v_exp_f32 v133, v133
    v_smfmac_f32_16x16x64_bf16 v[236:239], v[240:243], v[208:215], v244
    ds_read_b128 v[228:231], v250 offset:27648
    v_cvt_pk_bf16_f32 v208, v128, v129
    v_mfma_f32_32x32x16_bf16 v[144:159], v[216:219], v[200:203], 0
    ds_read_b128 v[216:219], v250 offset:24576
    v_cvt_pk_bf16_f32 v209, v130, v131
    v_exp_f32 v134, v134
    v_exp_f32 v135, v135
    v_mfma_f32_32x32x16_bf16 v[144:159], v[220:223], v[204:207], v[144:159]
    ds_read_b128 v[220:223], v250 offset:25600
    v_cvt_pk_bf16_f32 v210, v132, v133
    v_cvt_pk_bf16_f32 v211, v134, v135
    v_exp_f32 v136, v136
    v_exp_f32 v137, v137
    v_mfma_f32_32x32x16_bf16 v[96:111], v[224:227], v[208:211], v[96:111]
    s_waitcnt lgkmcnt(2)
    buffer_load_dwordx4 v[64:67], v245, s[24:27], s56 offen offset:0 sc1
    v_exp_f32 v138, v138
    v_cvt_pk_bf16_f32 v212, v136, v137
    v_exp_f32 v139, v139
    v_exp_f32 v140, v140
    v_cvt_pk_bf16_f32 v213, v138, v139
    v_exp_f32 v141, v141
    v_exp_f32 v142, v142
    v_cvt_pk_bf16_f32 v214, v140, v141
    v_exp_f32 v143, v143
    v_exp_f32 v144, v144
    v_cvt_pk_bf16_f32 v215, v142, v143
    v_exp_f32 v145, v145
    v_exp_f32 v146, v146
    v_mfma_f32_32x32x16_bf16 v[96:111], v[228:231], v[212:215], v[96:111]
    s_waitcnt lgkmcnt(0)
    v_exp_f32 v147, v147
    v_exp_f32 v148, v148
    v_exp_f32 v149, v149
    v_smfmac_f32_16x16x64_bf16 v[232:235], v[240:243], v[208:215], v244
    buffer_load_dwordx4 v[68:71], v245, s[24:27], s56 offen offset:1024 sc1
    v_cvt_pk_bf16_f32 v208, v144, v145
    v_mfma_f32_32x32x16_bf16 v[128:143], v[216:219], v[192:195], 0
    buffer_load_dwordx4 v[72:75], v246, s[24:27], s56 offen offset:0 sc1
    v_cvt_pk_bf16_f32 v209, v146, v147
    v_exp_f32 v150, v150
    v_cvt_pk_bf16_f32 v210, v148, v149
    v_exp_f32 v151, v151
    v_mfma_f32_32x32x16_bf16 v[128:143], v[220:223], v[196:199], v[128:143]
    buffer_load_dwordx4 v[76:79], v246, s[24:27], s56 offen offset:1024 sc1
    v_exp_f32 v152, v152
    v_cvt_pk_bf16_f32 v211, v150, v151
    v_exp_f32 v153, v153
    v_exp_f32 v154, v154
    v_mfma_f32_32x32x16_bf16 v[112:127], v[224:227], v[208:211], v[112:127]
    ds_read_b128 v[224:227], v250 offset:30720
    v_cvt_pk_bf16_f32 v212, v152, v153
    v_exp_f32 v155, v155
    v_exp_f32 v156, v156
    v_cvt_pk_bf16_f32 v213, v154, v155
    v_exp_f32 v157, v157
    v_exp_f32 v158, v158
    v_cvt_pk_bf16_f32 v214, v156, v157
    v_exp_f32 v159, v159
    v_exp_f32 v128, v128
    v_cvt_pk_bf16_f32 v215, v158, v159
    v_exp_f32 v129, v129
    v_exp_f32 v130, v130
    v_mfma_f32_32x32x16_bf16 v[112:127], v[228:231], v[212:215], v[112:127]
    s_waitcnt lgkmcnt(0)
    v_exp_f32 v131, v131
    v_exp_f32 v132, v132
    v_exp_f32 v133, v133
    v_smfmac_f32_16x16x64_bf16 v[236:239], v[240:243], v[208:215], v244
    ds_read_b128 v[228:231], v250 offset:31744
    v_cvt_pk_bf16_f32 v208, v128, v129
    v_mfma_f32_32x32x16_bf16 v[144:159], v[216:219], v[200:203], 0
    ds_read_b128 v[216:219], v250 offset:28672
    v_cvt_pk_bf16_f32 v209, v130, v131
    v_exp_f32 v134, v134
    v_exp_f32 v135, v135
    v_mfma_f32_32x32x16_bf16 v[144:159], v[220:223], v[204:207], v[144:159]
    ds_read_b128 v[220:223], v250 offset:29696
    v_cvt_pk_bf16_f32 v210, v132, v133
    v_cvt_pk_bf16_f32 v211, v134, v135
    v_exp_f32 v136, v136
    v_exp_f32 v137, v137
    v_mfma_f32_32x32x16_bf16 v[96:111], v[224:227], v[208:211], v[96:111]
    s_branch PG7_go
    .p2align 12
PG7:
    s_setpc_b64 s[72:73]
    s_nop 0
PG7_go:
    s_waitcnt lgkmcnt(2)
    buffer_load_dwordx4 v[80:83], v245, s[24:27], s61 offen offset:0 sc1
    v_exp_f32 v138, v138
    v_cvt_pk_bf16_f32 v212, v136, v137
    v_exp_f32 v139, v139
    v_exp_f32 v140, v140
    v_cvt_pk_bf16_f32 v213, v138, v139
    v_exp_f32 v141, v141
    v_exp_f32 v142, v142
    v_cvt_pk_bf16_f32 v214, v140, v141
    v_exp_f32 v143, v143
    v_exp_f32 v144, v144
    v_cvt_pk_bf16_f32 v215, v142, v143
    v_exp_f32 v145, v145
    v_exp_f32 v146, v146
    v_mfma_f32_32x32x16_bf16 v[96:111], v[228:231], v[212:215], v[96:111]
    s_waitcnt lgkmcnt(0)
    v_exp_f32 v147, v147
    v_exp_f32 v148, v148
    v_exp_f32 v149, v149
    v_smfmac_f32_16x16x64_bf16 v[232:235], v[240:243], v[208:215], v244
    buffer_load_dwordx4 v[84:87], v245, s[24:27], s61 offen offset:1024 sc1
    v_cvt_pk_bf16_f32 v208, v144, v145
    buffer_load_dwordx4 v[88:91], v246, s[24:27], s61 offen offset:0 sc1
    v_cvt_pk_bf16_f32 v209, v146, v147
    v_exp_f32 v150, v150
    v_cvt_pk_bf16_f32 v210, v148, v149
    v_exp_f32 v151, v151
    buffer_load_dwordx4 v[92:95], v246, s[24:27], s61 offen offset:1024 sc1
    s_add_u32 s56, s56, 4096
    s_cmp_eq_u32 s56, s58
    s_cselect_b32 s56, s57, s56
    s_add_u32 s61, s56, s32
    v_exp_f32 v152, v152
    v_cvt_pk_bf16_f32 v211, v150, v151
    v_exp_f32 v153, v153
    v_exp_f32 v154, v154
    v_mfma_f32_32x32x16_bf16 v[112:127], v[224:227], v[208:211], v[112:127]
    v_cvt_pk_bf16_f32 v212, v152, v153
    v_exp_f32 v155, v155
    v_exp_f32 v156, v156
    v_cvt_pk_bf16_f32 v213, v154, v155
    v_exp_f32 v157, v157
    v_exp_f32 v158, v158
    v_cvt_pk_bf16_f32 v214, v156, v157
    v_exp_f32 v159, v159
    s_nop 0
    v_cvt_pk_bf16_f32 v215, v158, v159
    s_nop 1
    v_smfmac_f32_16x16x64_bf16 v[236:239], v[240:243], v[208:215], v244
    v_mfma_f32_32x32x16_bf16 v[112:127], v[228:231], v[212:215], v[112:127]
    v_bfe_u32 v253, v251, 3, 2
    v_and_b32 v254, 3, v251
    v_lshlrev_b32 v254, 3, v254
    v_lshl_add_u32 v253, v253, 5, v254
    v_lshrrev_b32 v254, 2, v251
    v_lshl_add_u32 v252, v254, 7, v253
    s_and_b32 s46, s3, 1
    s_lshl_b32 s46, s46, 13
    v_add_u32 v252, s46, v252
    v_xor_b32 v253, 32, v252
    v_xor_b32 v254, 64, v252
    v_xor_b32 v255, 96, v252
    ds_read_b64_tr_b16 v[128:129], v252 offset:0
    ds_read_b64_tr_b16 v[130:131], v252 offset:2048
    ds_read_b64_tr_b16 v[132:133], v252 offset:4096
    ds_read_b64_tr_b16 v[134:135], v252 offset:6144
    ds_read_b64_tr_b16 v[136:137], v253 offset:0
    ds_read_b64_tr_b16 v[138:139], v253 offset:2048
    ds_read_b64_tr_b16 v[140:141], v253 offset:4096
    ds_read_b64_tr_b16 v[142:143], v253 offset:6144
    ds_read_b64_tr_b16 v[144:145], v254 offset:0
    ds_read_b64_tr_b16 v[146:147], v254 offset:2048
    ds_read_b64_tr_b16 v[148:149], v254 offset:4096
    ds_read_b64_tr_b16 v[150:151], v254 offset:6144
    .p2align 3
    v_pk_mul_f32 v[234:235], v[96:97], 0 op_sel_hi:[1,0]
    v_pk_mul_f32 v[238:239], v[112:113], 0 op_sel_hi:[1,0]
    v_pk_fma_f32 v[234:235], v[98:99], 0, v[234:235] op_sel_hi:[1,0,1]
    v_pk_fma_f32 v[238:239], v[114:115], 0, v[238:239] op_sel_hi:[1,0,1]
    v_pk_fma_f32 v[234:235], v[100:101], 0, v[234:235] op_sel_hi:[1,0,1]
    v_pk_fma_f32 v[238:239], v[116:117], 0, v[238:239] op_sel_hi:[1,0,1]
    v_pk_fma_f32 v[234:235], v[102:103], 0, v[234:235] op_sel_hi:[1,0,1]
    v_pk_fma_f32 v[238:239], v[118:119], 0, v[238:239] op_sel_hi:[1,0,1]
    v_pk_fma_f32 v[234:235], v[104:105], 0, v[234:235] op_sel_hi:[1,0,1]
    v_pk_fma_f32 v[238:239], v[120:121], 0, v[238:239] op_sel_hi:[1,0,1]
    v_pk_fma_f32 v[234:235], v[106:107], 0, v[234:235] op_sel_hi:[1,0,1]
    v_pk_fma_f32 v[238:239], v[122:123], 0, v[238:239] op_sel_hi:[1,0,1]
    v_pk_fma_f32 v[234:235], v[108:109], 0, v[234:235] op_sel_hi:[1,0,1]
    v_pk_fma_f32 v[238:239], v[124:125], 0, v[238:239] op_sel_hi:[1,0,1]
    v_pk_fma_f32 v[234:235], v[110:111], 0, v[234:235] op_sel_hi:[1,0,1]
    v_pk_fma_f32 v[238:239], v[126:127], 0, v[238:239] op_sel_hi:[1,0,1]
    v_add_f32 v232, v232, v233
    v_add_f32 v234, v234, v235
    v_add_f32 v236, v236, v237
    v_add_f32 v238, v238, v239
    v_add_f32 v234, v234, v232
    v_add_f32 v238, v238, v236
    v_mov_b32 v233, 0x5d800000
    s_mov_b32 s64, 0x21800000
    v_med3_f32 v235, v234, s64, v233
    v_med3_f32 v239, v238, s64, v233
    v_cmp_neq_f32 vcc, v234, v235
    v_cmp_neq_f32 s[64:65], v238, v239
    s_or_b64 vcc, vcc, s[64:65]
    s_cbranch_scc1 A_fallback
A_fallback_back:
    s_mov_b32 s50, 0
    s_waitcnt vmcnt(16) lgkmcnt(8)
    v_mfma_f32_16x16x32_bf16 v[160:163], v[128:131], v[0:3], 0
    ds_read_b64_tr_b16 v[152:153], v255 offset:0
    v_rcp_f32 v234, v232
    v_rcp_f32 v238, v236
    v_and_b32 v249, 0xf0, v245
    v_mfma_f32_16x16x32_bf16 v[160:163], v[132:135], v[4:7], v[160:163]
    ds_read_b64_tr_b16 v[154:155], v255 offset:2048
    v_lshrrev_b32 v250, 5, v251
    v_lshl_add_u32 v249, v250, 8, v249
    v_bfe_u32 v250, v251, 4, 1
    v_mfma_f32_16x16x32_bf16 v[176:179], v[128:131], v[8:11], 0
    ds_read_b64_tr_b16 v[156:157], v255 offset:4096
    v_mul_u32_u24 v250, 90112, v250
    v_add_u32 v249, v249, v250
    v_mul_f32 v234, v234, v247
    v_mfma_f32_16x16x32_bf16 v[176:179], v[132:135], v[12:15], v[176:179]
    ds_read_b64_tr_b16 v[158:159], v255 offset:6144
    v_mul_f32 v238, v238, v248
    v_mul_f32 v96, v96, v234
    v_mul_f32 v97, v97, v234
    v_mfma_f32_16x16x32_bf16 v[192:195], v[128:131], v[16:19], 0
    v_mul_f32 v98, v98, v234
    v_mul_f32 v99, v99, v234
    v_mul_f32 v100, v100, v234
    v_mul_f32 v101, v101, v234
    v_mul_f32 v102, v102, v234
    v_mfma_f32_16x16x32_bf16 v[192:195], v[132:135], v[20:23], v[192:195]
    v_mul_f32 v103, v103, v234
    v_cvt_pk_bf16_f32 v96, v96, v97
    v_cvt_pk_bf16_f32 v97, v98, v99
    v_cvt_pk_bf16_f32 v98, v100, v101
    v_cvt_pk_bf16_f32 v99, v102, v103
    v_mfma_f32_16x16x32_bf16 v[208:211], v[128:131], v[24:27], 0
    buffer_store_dwordx4 v[96:99], v249, s[24:27], s20 offen offset:0 sc1
    v_mul_f32 v104, v104, v234
    v_mul_f32 v105, v105, v234
    v_mul_f32 v106, v106, v234
    v_mul_f32 v107, v107, v234
    v_mfma_f32_16x16x32_bf16 v[208:211], v[132:135], v[28:31], v[208:211]
    s_waitcnt lgkmcnt(8)
    v_mul_f32 v108, v108, v234
    v_mul_f32 v109, v109, v234
    v_mul_f32 v110, v110, v234
    v_mul_f32 v111, v111, v234
    v_cvt_pk_bf16_f32 v104, v104, v105
    v_mfma_f32_16x16x32_bf16 v[164:167], v[136:139], v[0:3], 0
    ds_read_b64_tr_b16 v[128:129], v252 offset:16384
    v_cvt_pk_bf16_f32 v105, v106, v107
    v_cvt_pk_bf16_f32 v106, v108, v109
    v_cvt_pk_bf16_f32 v107, v110, v111
    v_mfma_f32_16x16x32_bf16 v[164:167], v[140:143], v[4:7], v[164:167]
    ds_read_b64_tr_b16 v[130:131], v252 offset:18432
    buffer_store_dwordx4 v[104:107], v249, s[24:27], s20 offen offset:512 sc1
    v_mul_f32 v112, v112, v238
    v_mul_f32 v113, v113, v238
    v_mfma_f32_16x16x32_bf16 v[180:183], v[136:139], v[8:11], 0
    ds_read_b64_tr_b16 v[132:133], v252 offset:20480
    v_mul_f32 v114, v114, v238
    v_mul_f32 v115, v115, v238
    v_mul_f32 v116, v116, v238
    v_mfma_f32_16x16x32_bf16 v[180:183], v[140:143], v[12:15], v[180:183]
    ds_read_b64_tr_b16 v[134:135], v252 offset:22528
    v_mul_f32 v117, v117, v238
    v_mul_f32 v118, v118, v238
    v_mul_f32 v119, v119, v238
    v_mfma_f32_16x16x32_bf16 v[196:199], v[136:139], v[16:19], 0
    v_cvt_pk_bf16_f32 v112, v112, v113
    v_cvt_pk_bf16_f32 v113, v114, v115
    v_cvt_pk_bf16_f32 v114, v116, v117
    v_cvt_pk_bf16_f32 v115, v118, v119
    buffer_store_dwordx4 v[112:115], v249, s[24:27], s21 offen offset:0 sc1
    v_mfma_f32_16x16x32_bf16 v[196:199], v[140:143], v[20:23], v[196:199]
    v_mul_f32 v120, v120, v238
    v_mul_f32 v121, v121, v238
    v_mul_f32 v122, v122, v238
    v_mul_f32 v123, v123, v238
    v_mul_f32 v124, v124, v238
    v_mfma_f32_16x16x32_bf16 v[212:215], v[136:139], v[24:27], 0
    v_mul_f32 v125, v125, v238
    v_mul_f32 v126, v126, v238
    v_mul_f32 v127, v127, v238
    v_cvt_pk_bf16_f32 v120, v120, v121
    v_mfma_f32_16x16x32_bf16 v[212:215], v[140:143], v[28:31], v[212:215]
    s_waitcnt lgkmcnt(8)
    v_cvt_pk_bf16_f32 v121, v122, v123
    v_cvt_pk_bf16_f32 v122, v124, v125
    v_cvt_pk_bf16_f32 v123, v126, v127
    buffer_store_dwordx4 v[120:123], v249, s[24:27], s21 offen offset:512 sc1
    v_mfma_f32_16x16x32_bf16 v[168:171], v[144:147], v[0:3], 0
    ds_read_b64_tr_b16 v[136:137], v253 offset:16384
    v_mfma_f32_16x16x32_bf16 v[168:171], v[148:151], v[4:7], v[168:171]
    ds_read_b64_tr_b16 v[138:139], v253 offset:18432
    v_mfma_f32_16x16x32_bf16 v[184:187], v[144:147], v[8:11], 0
    ds_read_b64_tr_b16 v[140:141], v253 offset:20480
    v_mfma_f32_16x16x32_bf16 v[184:187], v[148:151], v[12:15], v[184:187]
    ds_read_b64_tr_b16 v[142:143], v253 offset:22528
    v_mfma_f32_16x16x32_bf16 v[200:203], v[144:147], v[16:19], 0
    v_mfma_f32_16x16x32_bf16 v[200:203], v[148:151], v[20:23], v[200:203]
    v_mfma_f32_16x16x32_bf16 v[216:219], v[144:147], v[24:27], 0
    v_mfma_f32_16x16x32_bf16 v[216:219], v[148:151], v[28:31], v[216:219]
    s_waitcnt lgkmcnt(8)
    v_mfma_f32_16x16x32_bf16 v[172:175], v[152:155], v[0:3], 0
    ds_read_b64_tr_b16 v[144:145], v254 offset:16384
    v_mfma_f32_16x16x32_bf16 v[172:175], v[156:159], v[4:7], v[172:175]
    ds_read_b64_tr_b16 v[146:147], v254 offset:18432
    v_mfma_f32_16x16x32_bf16 v[188:191], v[152:155], v[8:11], 0
    ds_read_b64_tr_b16 v[148:149], v254 offset:20480
    v_mfma_f32_16x16x32_bf16 v[188:191], v[156:159], v[12:15], v[188:191]
    ds_read_b64_tr_b16 v[150:151], v254 offset:22528
    v_mfma_f32_16x16x32_bf16 v[204:207], v[152:155], v[16:19], 0
    v_mfma_f32_16x16x32_bf16 v[204:207], v[156:159], v[20:23], v[204:207]
    v_mfma_f32_16x16x32_bf16 v[220:223], v[152:155], v[24:27], 0
    v_mfma_f32_16x16x32_bf16 v[220:223], v[156:159], v[28:31], v[220:223]
    .p2align 3
B_loop:
    s_waitcnt vmcnt(8) lgkmcnt(8)
    v_mfma_f32_16x16x32_bf16 v[160:163], v[128:131], v[32:35], v[160:163]
    ds_read_b64_tr_b16 v[152:153], v255 offset:16384
    v_mfma_f32_16x16x32_bf16 v[160:163], v[132:135], v[36:39], v[160:163]
    ds_read_b64_tr_b16 v[154:155], v255 offset:18432
    v_mfma_f32_16x16x32_bf16 v[176:179], v[128:131], v[40:43], v[176:179]
    ds_read_b64_tr_b16 v[156:157], v255 offset:20480
    v_mfma_f32_16x16x32_bf16 v[176:179], v[132:135], v[44:47], v[176:179]
    ds_read_b64_tr_b16 v[158:159], v255 offset:22528
    v_mfma_f32_16x16x32_bf16 v[192:195], v[128:131], v[48:51], v[192:195]
    buffer_load_dwordx4 v[96:99], v245, s[24:27], s56 offen offset:0 sc1
    v_mfma_f32_16x16x32_bf16 v[192:195], v[132:135], v[52:55], v[192:195]
    v_mfma_f32_16x16x32_bf16 v[208:211], v[128:131], v[56:59], v[208:211]
    buffer_load_dwordx4 v[100:103], v245, s[24:27], s56 offen offset:1024 sc1
    v_mfma_f32_16x16x32_bf16 v[208:211], v[132:135], v[60:63], v[208:211]
    s_waitcnt lgkmcnt(8)
    v_mfma_f32_16x16x32_bf16 v[164:167], v[136:139], v[32:35], v[164:167]
    ds_read_b64_tr_b16 v[128:129], v252 offset:32768
    v_mfma_f32_16x16x32_bf16 v[164:167], v[140:143], v[36:39], v[164:167]
    ds_read_b64_tr_b16 v[130:131], v252 offset:34816
    v_mfma_f32_16x16x32_bf16 v[180:183], v[136:139], v[40:43], v[180:183]
    ds_read_b64_tr_b16 v[132:133], v252 offset:36864
    v_mfma_f32_16x16x32_bf16 v[180:183], v[140:143], v[44:47], v[180:183]
    ds_read_b64_tr_b16 v[134:135], v252 offset:38912
    v_mfma_f32_16x16x32_bf16 v[196:199], v[136:139], v[48:51], v[196:199]
    buffer_load_dwordx4 v[104:107], v246, s[24:27], s56 offen offset:0 sc1
    v_mfma_f32_16x16x32_bf16 v[196:199], v[140:143], v[52:55], v[196:199]
    v_mfma_f32_16x16x32_bf16 v[212:215], v[136:139], v[56:59], v[212:215]
    buffer_load_dwordx4 v[108:111], v246, s[24:27], s56 offen offset:1024 sc1
    v_mfma_f32_16x16x32_bf16 v[212:215], v[140:143], v[60:63], v[212:215]
    s_waitcnt lgkmcnt(8)
    v_mfma_f32_16x16x32_bf16 v[168:171], v[144:147], v[32:35], v[168:171]
    ds_read_b64_tr_b16 v[136:137], v253 offset:32768
    s_add_u32 s56, s56, 4096
    v_mfma_f32_16x16x32_bf16 v[168:171], v[148:151], v[36:39], v[168:171]
    ds_read_b64_tr_b16 v[138:139], v253 offset:34816
    s_cmp_eq_u32 s56, s58
    v_mfma_f32_16x16x32_bf16 v[184:187], v[144:147], v[40:43], v[184:187]
    ds_read_b64_tr_b16 v[140:141], v253 offset:36864
    s_cselect_b32 s56, s57, s56
    v_mfma_f32_16x16x32_bf16 v[184:187], v[148:151], v[44:47], v[184:187]
    ds_read_b64_tr_b16 v[142:143], v253 offset:38912
    v_mfma_f32_16x16x32_bf16 v[200:203], v[144:147], v[48:51], v[200:203]
    buffer_load_dwordx4 v[112:115], v245, s[24:27], s61 offen offset:0 sc1
    v_mfma_f32_16x16x32_bf16 v[200:203], v[148:151], v[52:55], v[200:203]
    v_mfma_f32_16x16x32_bf16 v[216:219], v[144:147], v[56:59], v[216:219]
    buffer_load_dwordx4 v[116:119], v245, s[24:27], s61 offen offset:1024 sc1
    v_mfma_f32_16x16x32_bf16 v[216:219], v[148:151], v[60:63], v[216:219]
    s_waitcnt lgkmcnt(8)
    v_mfma_f32_16x16x32_bf16 v[172:175], v[152:155], v[32:35], v[172:175]
    ds_read_b64_tr_b16 v[144:145], v254 offset:32768
    v_mfma_f32_16x16x32_bf16 v[172:175], v[156:159], v[36:39], v[172:175]
    ds_read_b64_tr_b16 v[146:147], v254 offset:34816
    v_mfma_f32_16x16x32_bf16 v[188:191], v[152:155], v[40:43], v[188:191]
    ds_read_b64_tr_b16 v[148:149], v254 offset:36864
    v_mfma_f32_16x16x32_bf16 v[188:191], v[156:159], v[44:47], v[188:191]
    ds_read_b64_tr_b16 v[150:151], v254 offset:38912
    v_mfma_f32_16x16x32_bf16 v[204:207], v[152:155], v[48:51], v[204:207]
    buffer_load_dwordx4 v[120:123], v246, s[24:27], s61 offen offset:0 sc1
    v_mfma_f32_16x16x32_bf16 v[204:207], v[156:159], v[52:55], v[204:207]
    v_mfma_f32_16x16x32_bf16 v[220:223], v[152:155], v[56:59], v[220:223]
    buffer_load_dwordx4 v[124:127], v246, s[24:27], s61 offen offset:1024 sc1
    v_mfma_f32_16x16x32_bf16 v[220:223], v[156:159], v[60:63], v[220:223]
    s_add_u32 s61, s56, s32
    s_waitcnt vmcnt(8) lgkmcnt(8)
    v_mfma_f32_16x16x32_bf16 v[160:163], v[128:131], v[64:67], v[160:163]
    ds_read_b64_tr_b16 v[152:153], v255 offset:32768
    v_mfma_f32_16x16x32_bf16 v[160:163], v[132:135], v[68:71], v[160:163]
    ds_read_b64_tr_b16 v[154:155], v255 offset:34816
    v_mfma_f32_16x16x32_bf16 v[176:179], v[128:131], v[72:75], v[176:179]
    ds_read_b64_tr_b16 v[156:157], v255 offset:36864
    s_barrier
    v_mfma_f32_16x16x32_bf16 v[176:179], v[132:135], v[76:79], v[176:179]
    ds_read_b64_tr_b16 v[158:159], v255 offset:38912
    v_mfma_f32_16x16x32_bf16 v[192:195], v[128:131], v[80:83], v[192:195]
    buffer_load_dwordx4 v[0:3], v245, s[24:27], s56 offen offset:0 sc1
    v_mfma_f32_16x16x32_bf16 v[192:195], v[132:135], v[84:87], v[192:195]
    v_mfma_f32_16x16x32_bf16 v[208:211], v[128:131], v[88:91], v[208:211]
    buffer_load_dwordx4 v[4:7], v245, s[24:27], s56 offen offset:1024 sc1
    v_mfma_f32_16x16x32_bf16 v[208:211], v[132:135], v[92:95], v[208:211]
    s_waitcnt lgkmcnt(8)
    v_mfma_f32_16x16x32_bf16 v[164:167], v[136:139], v[64:67], v[164:167]
    ds_read_b64_tr_b16 v[128:129], v252 offset:49152
    v_mfma_f32_16x16x32_bf16 v[164:167], v[140:143], v[68:71], v[164:167]
    ds_read_b64_tr_b16 v[130:131], v252 offset:51200
    v_mfma_f32_16x16x32_bf16 v[180:183], v[136:139], v[72:75], v[180:183]
    ds_read_b64_tr_b16 v[132:133], v252 offset:53248
    v_mfma_f32_16x16x32_bf16 v[180:183], v[140:143], v[76:79], v[180:183]
    ds_read_b64_tr_b16 v[134:135], v252 offset:55296
    v_mfma_f32_16x16x32_bf16 v[196:199], v[136:139], v[80:83], v[196:199]
    buffer_load_dwordx4 v[8:11], v246, s[24:27], s56 offen offset:0 sc1
    v_mfma_f32_16x16x32_bf16 v[196:199], v[140:143], v[84:87], v[196:199]
    v_mfma_f32_16x16x32_bf16 v[212:215], v[136:139], v[88:91], v[212:215]
    buffer_load_dwordx4 v[12:15], v246, s[24:27], s56 offen offset:1024 sc1
    v_mfma_f32_16x16x32_bf16 v[212:215], v[140:143], v[92:95], v[212:215]
    s_waitcnt lgkmcnt(8)
    v_mfma_f32_16x16x32_bf16 v[168:171], v[144:147], v[64:67], v[168:171]
    ds_read_b64_tr_b16 v[136:137], v253 offset:49152
    s_add_u32 s56, s56, 4096
    v_mfma_f32_16x16x32_bf16 v[168:171], v[148:151], v[68:71], v[168:171]
    ds_read_b64_tr_b16 v[138:139], v253 offset:51200
    s_cmp_eq_u32 s56, s58
    v_mfma_f32_16x16x32_bf16 v[184:187], v[144:147], v[72:75], v[184:187]
    ds_read_b64_tr_b16 v[140:141], v253 offset:53248
    s_cselect_b32 s56, s57, s56
    v_mfma_f32_16x16x32_bf16 v[184:187], v[148:151], v[76:79], v[184:187]
    ds_read_b64_tr_b16 v[142:143], v253 offset:55296
    v_mfma_f32_16x16x32_bf16 v[200:203], v[144:147], v[80:83], v[200:203]
    buffer_load_dwordx4 v[16:19], v245, s[24:27], s61 offen offset:0 sc1
    v_mfma_f32_16x16x32_bf16 v[200:203], v[148:151], v[84:87], v[200:203]
    v_mfma_f32_16x16x32_bf16 v[216:219], v[144:147], v[88:91], v[216:219]
    buffer_load_dwordx4 v[20:23], v245, s[24:27], s61 offen offset:1024 sc1
    v_mfma_f32_16x16x32_bf16 v[216:219], v[148:151], v[92:95], v[216:219]
    s_waitcnt lgkmcnt(8)
    v_mfma_f32_16x16x32_bf16 v[172:175], v[152:155], v[64:67], v[172:175]
    ds_read_b64_tr_b16 v[144:145], v254 offset:49152
    v_mfma_f32_16x16x32_bf16 v[172:175], v[156:159], v[68:71], v[172:175]
    ds_read_b64_tr_b16 v[146:147], v254 offset:51200
    v_mfma_f32_16x16x32_bf16 v[188:191], v[152:155], v[72:75], v[188:191]
    ds_read_b64_tr_b16 v[148:149], v254 offset:53248
    v_mfma_f32_16x16x32_bf16 v[188:191], v[156:159], v[76:79], v[188:191]
    ds_read_b64_tr_b16 v[150:151], v254 offset:55296
    v_mfma_f32_16x16x32_bf16 v[204:207], v[152:155], v[80:83], v[204:207]
    buffer_load_dwordx4 v[24:27], v246, s[24:27], s61 offen offset:0 sc1
    v_mfma_f32_16x16x32_bf16 v[204:207], v[156:159], v[84:87], v[204:207]
    v_mfma_f32_16x16x32_bf16 v[220:223], v[152:155], v[88:91], v[220:223]
    buffer_load_dwordx4 v[28:31], v246, s[24:27], s61 offen offset:1024 sc1
    v_mfma_f32_16x16x32_bf16 v[220:223], v[156:159], v[92:95], v[220:223]
    s_add_u32 s61, s56, s32
    s_waitcnt vmcnt(8) lgkmcnt(8)
    v_mfma_f32_16x16x32_bf16 v[160:163], v[128:131], v[96:99], v[160:163]
    ds_read_b64_tr_b16 v[152:153], v255 offset:49152
    v_xor_b32 v252, 0x10000, v252
    v_mfma_f32_16x16x32_bf16 v[160:163], v[132:135], v[100:103], v[160:163]
    ds_read_b64_tr_b16 v[154:155], v255 offset:51200
    v_xor_b32 v253, 0x10000, v253
    v_mfma_f32_16x16x32_bf16 v[176:179], v[128:131], v[104:107], v[176:179]
    ds_read_b64_tr_b16 v[156:157], v255 offset:53248
    v_xor_b32 v254, 0x10000, v254
    v_mfma_f32_16x16x32_bf16 v[176:179], v[132:135], v[108:111], v[176:179]
    ds_read_b64_tr_b16 v[158:159], v255 offset:55296
    v_mfma_f32_16x16x32_bf16 v[192:195], v[128:131], v[112:115], v[192:195]
    buffer_load_dwordx4 v[32:35], v245, s[24:27], s56 offen offset:0 sc1
    v_mfma_f32_16x16x32_bf16 v[192:195], v[132:135], v[116:119], v[192:195]
    v_xor_b32 v255, 0x10000, v255
    v_mfma_f32_16x16x32_bf16 v[208:211], v[128:131], v[120:123], v[208:211]
    buffer_load_dwordx4 v[36:39], v245, s[24:27], s56 offen offset:1024 sc1
    v_mfma_f32_16x16x32_bf16 v[208:211], v[132:135], v[124:127], v[208:211]
    s_waitcnt lgkmcnt(8)
    v_mfma_f32_16x16x32_bf16 v[164:167], v[136:139], v[96:99], v[164:167]
    ds_read_b64_tr_b16 v[128:129], v252 offset:0
    s_add_u32 s46, s56, 4096
    v_mfma_f32_16x16x32_bf16 v[164:167], v[140:143], v[100:103], v[164:167]
    ds_read_b64_tr_b16 v[130:131], v252 offset:2048
    s_bitcmp1_b32 s66, s50
    v_mfma_f32_16x16x32_bf16 v[180:183], v[136:139], v[104:107], v[180:183]
    ds_read_b64_tr_b16 v[132:133], v252 offset:4096
    s_cselect_b32 s58, s46, s58
    v_mfma_f32_16x16x32_bf16 v[180:183], v[140:143], v[108:111], v[180:183]
    ds_read_b64_tr_b16 v[134:135], v252 offset:6144
    s_cselect_b32 s57, s59, s57
    v_mfma_f32_16x16x32_bf16 v[196:199], v[136:139], v[112:115], v[196:199]
    buffer_load_dwordx4 v[40:43], v246, s[24:27], s56 offen offset:0 sc1
    v_mfma_f32_16x16x32_bf16 v[196:199], v[140:143], v[116:119], v[196:199]
    v_mfma_f32_16x16x32_bf16 v[212:215], v[136:139], v[120:123], v[212:215]
    buffer_load_dwordx4 v[44:47], v246, s[24:27], s56 offen offset:1024 sc1
    v_mfma_f32_16x16x32_bf16 v[212:215], v[140:143], v[124:127], v[212:215]
    s_waitcnt lgkmcnt(8)
    v_mfma_f32_16x16x32_bf16 v[168:171], v[144:147], v[96:99], v[168:171]
    ds_read_b64_tr_b16 v[136:137], v253 offset:0
    s_add_u32 s56, s56, 4096
    v_mfma_f32_16x16x32_bf16 v[168:171], v[148:151], v[100:103], v[168:171]
    ds_read_b64_tr_b16 v[138:139], v253 offset:2048
    s_cmp_eq_u32 s56, s58
    v_mfma_f32_16x16x32_bf16 v[184:187], v[144:147], v[104:107], v[184:187]
    ds_read_b64_tr_b16 v[140:141], v253 offset:4096
    s_cselect_b32 s56, s57, s56
    v_mfma_f32_16x16x32_bf16 v[184:187], v[148:151], v[108:111], v[184:187]
    ds_read_b64_tr_b16 v[142:143], v253 offset:6144
    v_mfma_f32_16x16x32_bf16 v[200:203], v[144:147], v[112:115], v[200:203]
    buffer_load_dwordx4 v[48:51], v245, s[24:27], s61 offen offset:0 sc1
    v_mfma_f32_16x16x32_bf16 v[200:203], v[148:151], v[116:119], v[200:203]
    v_mfma_f32_16x16x32_bf16 v[216:219], v[144:147], v[120:123], v[216:219]
    buffer_load_dwordx4 v[52:55], v245, s[24:27], s61 offen offset:1024 sc1
    v_mfma_f32_16x16x32_bf16 v[216:219], v[148:151], v[124:127], v[216:219]
    s_waitcnt lgkmcnt(8)
    v_mfma_f32_16x16x32_bf16 v[172:175], v[152:155], v[96:99], v[172:175]
    ds_read_b64_tr_b16 v[144:145], v254 offset:0
    v_mfma_f32_16x16x32_bf16 v[172:175], v[156:159], v[100:103], v[172:175]
    ds_read_b64_tr_b16 v[146:147], v254 offset:2048
    v_mfma_f32_16x16x32_bf16 v[188:191], v[152:155], v[104:107], v[188:191]
    ds_read_b64_tr_b16 v[148:149], v254 offset:4096
    v_mfma_f32_16x16x32_bf16 v[188:191], v[156:159], v[108:111], v[188:191]
    ds_read_b64_tr_b16 v[150:151], v254 offset:6144
    v_mfma_f32_16x16x32_bf16 v[204:207], v[152:155], v[112:115], v[204:207]
    buffer_load_dwordx4 v[56:59], v246, s[24:27], s61 offen offset:0 sc1
    v_mfma_f32_16x16x32_bf16 v[204:207], v[156:159], v[116:119], v[204:207]
    v_mfma_f32_16x16x32_bf16 v[220:223], v[152:155], v[120:123], v[220:223]
    buffer_load_dwordx4 v[60:63], v246, s[24:27], s61 offen offset:1024 sc1
    v_mfma_f32_16x16x32_bf16 v[220:223], v[156:159], v[124:127], v[220:223]
    s_add_u32 s61, s56, s32
    s_waitcnt vmcnt(8) lgkmcnt(8)
    v_mfma_f32_16x16x32_bf16 v[160:163], v[128:131], v[0:3], v[160:163]
    ds_read_b64_tr_b16 v[152:153], v255 offset:0
    v_mfma_f32_16x16x32_bf16 v[160:163], v[132:135], v[4:7], v[160:163]
    ds_read_b64_tr_b16 v[154:155], v255 offset:2048
    v_mfma_f32_16x16x32_bf16 v[176:179], v[128:131], v[8:11], v[176:179]
    ds_read_b64_tr_b16 v[156:157], v255 offset:4096
    s_barrier
    v_mfma_f32_16x16x32_bf16 v[176:179], v[132:135], v[12:15], v[176:179]
    ds_read_b64_tr_b16 v[158:159], v255 offset:6144
    v_mfma_f32_16x16x32_bf16 v[192:195], v[128:131], v[16:19], v[192:195]
    buffer_load_dwordx4 v[64:67], v245, s[24:27], s56 offen offset:0 sc1
    v_mfma_f32_16x16x32_bf16 v[192:195], v[132:135], v[20:23], v[192:195]
    v_mfma_f32_16x16x32_bf16 v[208:211], v[128:131], v[24:27], v[208:211]
    buffer_load_dwordx4 v[68:71], v245, s[24:27], s56 offen offset:1024 sc1
    v_mfma_f32_16x16x32_bf16 v[208:211], v[132:135], v[28:31], v[208:211]
    s_waitcnt lgkmcnt(8)
    v_mfma_f32_16x16x32_bf16 v[164:167], v[136:139], v[0:3], v[164:167]
    ds_read_b64_tr_b16 v[128:129], v252 offset:16384
    s_bitcmp1_b32 s66, s50
    v_mfma_f32_16x16x32_bf16 v[164:167], v[140:143], v[4:7], v[164:167]
    ds_read_b64_tr_b16 v[130:131], v252 offset:18432
    s_cselect_b32 s58, s67, s58
    v_mfma_f32_16x16x32_bf16 v[180:183], v[136:139], v[8:11], v[180:183]
    ds_read_b64_tr_b16 v[132:133], v252 offset:20480
    s_cselect_b32 s57, s60, s57
    v_mfma_f32_16x16x32_bf16 v[180:183], v[140:143], v[12:15], v[180:183]
    ds_read_b64_tr_b16 v[134:135], v252 offset:22528
    s_cselect_b32 s59, s68, s59
    v_mfma_f32_16x16x32_bf16 v[196:199], v[136:139], v[16:19], v[196:199]
    buffer_load_dwordx4 v[72:75], v246, s[24:27], s56 offen offset:0 sc1
    v_mfma_f32_16x16x32_bf16 v[196:199], v[140:143], v[20:23], v[196:199]
    v_mfma_f32_16x16x32_bf16 v[212:215], v[136:139], v[24:27], v[212:215]
    buffer_load_dwordx4 v[76:79], v246, s[24:27], s56 offen offset:1024 sc1
    v_mfma_f32_16x16x32_bf16 v[212:215], v[140:143], v[28:31], v[212:215]
    s_waitcnt lgkmcnt(8)
    v_mfma_f32_16x16x32_bf16 v[168:171], v[144:147], v[0:3], v[168:171]
    ds_read_b64_tr_b16 v[136:137], v253 offset:16384
    s_add_u32 s56, s56, 4096
    v_mfma_f32_16x16x32_bf16 v[168:171], v[148:151], v[4:7], v[168:171]
    ds_read_b64_tr_b16 v[138:139], v253 offset:18432
    s_cmp_eq_u32 s56, s58
    v_mfma_f32_16x16x32_bf16 v[184:187], v[144:147], v[8:11], v[184:187]
    ds_read_b64_tr_b16 v[140:141], v253 offset:20480
    s_cselect_b32 s56, s57, s56
    v_mfma_f32_16x16x32_bf16 v[184:187], v[148:151], v[12:15], v[184:187]
    ds_read_b64_tr_b16 v[142:143], v253 offset:22528
    v_mfma_f32_16x16x32_bf16 v[200:203], v[144:147], v[16:19], v[200:203]
    buffer_load_dwordx4 v[80:83], v245, s[24:27], s61 offen offset:0 sc1
    v_mfma_f32_16x16x32_bf16 v[200:203], v[148:151], v[20:23], v[200:203]
    v_mfma_f32_16x16x32_bf16 v[216:219], v[144:147], v[24:27], v[216:219]
    buffer_load_dwordx4 v[84:87], v245, s[24:27], s61 offen offset:1024 sc1
    v_mfma_f32_16x16x32_bf16 v[216:219], v[148:151], v[28:31], v[216:219]
    s_waitcnt lgkmcnt(8)
    v_mfma_f32_16x16x32_bf16 v[172:175], v[152:155], v[0:3], v[172:175]
    ds_read_b64_tr_b16 v[144:145], v254 offset:16384
    s_add_u32 s50, s50, 1
    v_mfma_f32_16x16x32_bf16 v[172:175], v[156:159], v[4:7], v[172:175]
    ds_read_b64_tr_b16 v[146:147], v254 offset:18432
    v_mfma_f32_16x16x32_bf16 v[188:191], v[152:155], v[8:11], v[188:191]
    ds_read_b64_tr_b16 v[148:149], v254 offset:20480
    v_mfma_f32_16x16x32_bf16 v[188:191], v[156:159], v[12:15], v[188:191]
    ds_read_b64_tr_b16 v[150:151], v254 offset:22528
    v_mfma_f32_16x16x32_bf16 v[204:207], v[152:155], v[16:19], v[204:207]
    buffer_load_dwordx4 v[88:91], v246, s[24:27], s61 offen offset:0 sc1
    v_mfma_f32_16x16x32_bf16 v[204:207], v[156:159], v[20:23], v[204:207]
    v_mfma_f32_16x16x32_bf16 v[220:223], v[152:155], v[24:27], v[220:223]
    buffer_load_dwordx4 v[92:95], v246, s[24:27], s61 offen offset:1024 sc1
    v_mfma_f32_16x16x32_bf16 v[220:223], v[156:159], v[28:31], v[220:223]
    s_add_u32 s61, s56, s32
    s_cmp_lg_u32 s50, 5
    s_cbranch_scc1 B_loop
    s_waitcnt vmcnt(8) lgkmcnt(8)
    v_mfma_f32_16x16x32_bf16 v[192:195], v[128:131], v[48:51], v[192:195]
    ds_read_b64_tr_b16 v[152:153], v255 offset:16384
    v_mfma_f32_16x16x32_bf16 v[192:195], v[132:135], v[52:55], v[192:195]
    ds_read_b64_tr_b16 v[154:155], v255 offset:18432
    v_mfma_f32_16x16x32_bf16 v[208:211], v[128:131], v[56:59], v[208:211]
    ds_read_b64_tr_b16 v[156:157], v255 offset:20480
    v_mfma_f32_16x16x32_bf16 v[208:211], v[132:135], v[60:63], v[208:211]
    ds_read_b64_tr_b16 v[158:159], v255 offset:22528
    s_waitcnt lgkmcnt(4)
    v_mfma_f32_16x16x32_bf16 v[196:199], v[136:139], v[48:51], v[196:199]
    s_lshl_b32 s46, s3, 13
    v_mfma_f32_16x16x32_bf16 v[196:199], v[140:143], v[52:55], v[196:199]
    v_add_u32 v228, s46, v245
    v_mfma_f32_16x16x32_bf16 v[212:215], v[136:139], v[56:59], v[212:215]
    v_xor_b32 v229, 0x2000, v228
    v_mfma_f32_16x16x32_bf16 v[212:215], v[140:143], v[60:63], v[212:215]
    v_and_b32 v224, 15, v251
    v_mul_u32_u24 v224, 144, v224
    v_mfma_f32_16x16x32_bf16 v[200:203], v[144:147], v[48:51], v[200:203]
    ds_write_b128 v228, v[192:195] offset:0
    v_mfma_f32_16x16x32_bf16 v[200:203], v[148:151], v[52:55], v[200:203]
    v_bfe_u32 v227, v251, 4, 1
    v_lshl_add_u32 v224, v227, 5, v224
    v_mfma_f32_16x16x32_bf16 v[216:219], v[144:147], v[56:59], v[216:219]
    ds_write_b128 v228, v[208:211] offset:4096
    v_mfma_f32_16x16x32_bf16 v[216:219], v[148:151], v[60:63], v[216:219]
    s_waitcnt lgkmcnt(2)
    v_mfma_f32_16x16x32_bf16 v[204:207], v[152:155], v[48:51], v[204:207]
    ds_write_b128 v228, v[196:199] offset:1024
    v_mfma_f32_16x16x32_bf16 v[204:207], v[156:159], v[52:55], v[204:207]
    v_lshrrev_b32 v227, 5, v251
    v_lshl_add_u32 v224, v227, 4, v224
    v_mfma_f32_16x16x32_bf16 v[220:223], v[152:155], v[56:59], v[220:223]
    ds_write_b128 v228, v[212:215] offset:5120
    v_mfma_f32_16x16x32_bf16 v[220:223], v[156:159], v[60:63], v[220:223]
    v_add_u32 v224, s15, v224
    v_lshrrev_b32 v226, 3, v251
    v_mfma_f32_16x16x32_bf16 v[160:163], v[128:131], v[32:35], v[160:163]
    ds_write_b128 v228, v[200:203] offset:2048
    v_mfma_f32_16x16x32_bf16 v[160:163], v[132:135], v[36:39], v[160:163]
    v_and_b32 v227, 0x70, v245
    v_mul_u32_u24 v225, 144, v226
    v_mfma_f32_16x16x32_bf16 v[176:179], v[128:131], v[40:43], v[176:179]
    ds_write_b128 v228, v[216:219] offset:6144
    v_mfma_f32_16x16x32_bf16 v[176:179], v[132:135], v[44:47], v[176:179]
    v_add3_u32 v225, v225, v227, s15
    v_lshl_add_u32 v226, v226, 11, v227
    v_mfma_f32_16x16x32_bf16 v[164:167], v[136:139], v[32:35], v[164:167]
    ds_write_b128 v228, v[204:207] offset:3072
    v_mfma_f32_16x16x32_bf16 v[164:167], v[140:143], v[36:39], v[164:167]
    v_mfma_f32_16x16x32_bf16 v[180:183], v[136:139], v[40:43], v[180:183]
    ds_write_b128 v228, v[220:223] offset:7168
    v_mfma_f32_16x16x32_bf16 v[180:183], v[140:143], v[44:47], v[180:183]
    v_mfma_f32_16x16x32_bf16 v[168:171], v[144:147], v[32:35], v[168:171]
    v_mfma_f32_16x16x32_bf16 v[168:171], v[148:151], v[36:39], v[168:171]
    v_mfma_f32_16x16x32_bf16 v[184:187], v[144:147], v[40:43], v[184:187]
    s_waitcnt lgkmcnt(0)
    v_mfma_f32_16x16x32_bf16 v[184:187], v[148:151], v[44:47], v[184:187]
    s_barrier
    v_mfma_f32_16x16x32_bf16 v[172:175], v[152:155], v[32:35], v[172:175]
    ds_read_b128 v[0:3], v229 offset:0
    ds_read_b128 v[4:7], v229 offset:1024
    v_mfma_f32_16x16x32_bf16 v[172:175], v[156:159], v[36:39], v[172:175]
    ds_read_b128 v[8:11], v229 offset:2048
    ds_read_b128 v[12:15], v229 offset:3072
    v_mfma_f32_16x16x32_bf16 v[188:191], v[152:155], v[40:43], v[188:191]
    ds_read_b128 v[16:19], v229 offset:4096
    ds_read_b128 v[20:23], v229 offset:5120
    v_mfma_f32_16x16x32_bf16 v[188:191], v[156:159], v[44:47], v[188:191]
    ds_read_b128 v[24:27], v229 offset:6144
    ds_read_b128 v[28:31], v229 offset:7168
    s_waitcnt lgkmcnt(7)
    v_pk_add_f32 v[160:161], v[160:161], v[0:1]
    v_pk_add_f32 v[162:163], v[162:163], v[2:3]
    s_waitcnt lgkmcnt(6)
    v_pk_add_f32 v[164:165], v[164:165], v[4:5]
    v_pk_add_f32 v[166:167], v[166:167], v[6:7]
    s_waitcnt lgkmcnt(5)
    v_pk_add_f32 v[168:169], v[168:169], v[8:9]
    v_pk_add_f32 v[170:171], v[170:171], v[10:11]
    s_waitcnt lgkmcnt(4)
    v_pk_add_f32 v[172:173], v[172:173], v[12:13]
    v_pk_add_f32 v[174:175], v[174:175], v[14:15]
    v_cvt_pk_bf16_f32 v192, v160, v161
    v_cvt_pk_bf16_f32 v193, v162, v163
    v_cvt_pk_bf16_f32 v194, v164, v165
    v_cvt_pk_bf16_f32 v195, v166, v167
    v_cvt_pk_bf16_f32 v196, v168, v169
    s_branch PG8_go
    .p2align 12
PG8:
    s_setpc_b64 s[72:73]
    s_nop 0
PG8_go:
    v_cvt_pk_bf16_f32 v197, v170, v171
    v_cvt_pk_bf16_f32 v198, v172, v173
    v_cvt_pk_bf16_f32 v199, v174, v175
    v_permlane16_swap_b32 v192, v194
    v_permlane16_swap_b32 v193, v195
    ds_write_b128 v224, v[192:195] offset:0
    v_permlane16_swap_b32 v196, v198
    v_permlane16_swap_b32 v197, v199
    ds_write_b128 v224, v[196:199] offset:64
    ds_read_b128 v[208:211], v225 offset:0
    ds_read_b128 v[212:215], v225 offset:1152
    s_waitcnt lgkmcnt(7)
    v_pk_add_f32 v[176:177], v[176:177], v[16:17]
    v_pk_add_f32 v[178:179], v[178:179], v[18:19]
    s_waitcnt lgkmcnt(6)
    v_pk_add_f32 v[180:181], v[180:181], v[20:21]
    v_pk_add_f32 v[182:183], v[182:183], v[22:23]
    s_waitcnt lgkmcnt(5)
    v_pk_add_f32 v[184:185], v[184:185], v[24:25]
    v_pk_add_f32 v[186:187], v[186:187], v[26:27]
    s_waitcnt lgkmcnt(4)
    v_pk_add_f32 v[188:189], v[188:189], v[28:29]
    v_pk_add_f32 v[190:191], v[190:191], v[30:31]
    v_cvt_pk_bf16_f32 v200, v176, v177
    v_cvt_pk_bf16_f32 v201, v178, v179
    v_cvt_pk_bf16_f32 v202, v180, v181
    v_cvt_pk_bf16_f32 v203, v182, v183
    v_cvt_pk_bf16_f32 v204, v184, v185
    v_cvt_pk_bf16_f32 v205, v186, v187
    v_cvt_pk_bf16_f32 v206, v188, v189
    v_cvt_pk_bf16_f32 v207, v190, v191
    v_permlane16_swap_b32 v200, v202
    v_permlane16_swap_b32 v201, v203
    ds_write_b128 v224, v[200:203] offset:2304
    v_permlane16_swap_b32 v204, v206
    v_permlane16_swap_b32 v205, v207
    ds_write_b128 v224, v[204:207] offset:2368
    ds_read_b128 v[216:219], v225 offset:2304
    ds_read_b128 v[220:223], v225 offset:3456
    s_waitcnt lgkmcnt(5)
    buffer_store_dwordx4 v[208:211], v226, s[8:11], s23 offen nt
    s_add_u32 s23, s23, 16384
    s_waitcnt lgkmcnt(4)
    buffer_store_dwordx4 v[212:215], v226, s[8:11], s23 offen nt
    s_add_u32 s23, s23, 16384
    s_waitcnt lgkmcnt(1)
    buffer_store_dwordx4 v[216:219], v226, s[8:11], s23 offen nt
    s_add_u32 s23, s23, 16384
    s_waitcnt lgkmcnt(0)
    buffer_store_dwordx4 v[220:223], v226, s[8:11], s23 offen nt
    s_endpgm
A_exit:
    s_endpgm
PGA_norm:
    s_setpc_b64 s[72:73]
    s_nop 0
A_norm:
    s_waitcnt lgkmcnt(6)
    v_mfma_f32_16x16x32_bf16 v[96:99], v[192:195], v[160:163], v[96:99]
    ds_read_b64_tr_b16 v[200:201], v233 offset:32768
    v_mfma_f32_16x16x32_bf16 v[96:99], v[196:199], v[164:167], v[96:99]
    ds_read_b64_tr_b16 v[202:203], v233 offset:33792
    s_waitcnt lgkmcnt(6)
    v_mfma_f32_16x16x32_bf16 v[100:103], v[192:195], v[168:171], v[100:103]
    ds_read_b64_tr_b16 v[204:205], v233 offset:40960
    v_mfma_f32_16x16x32_bf16 v[100:103], v[196:199], v[172:175], v[100:103]
    ds_read_b64_tr_b16 v[206:207], v233 offset:41984
    s_waitcnt lgkmcnt(6)
    v_mfma_f32_16x16x32_bf16 v[104:107], v[192:195], v[176:179], v[104:107]
    ds_read_b64_tr_b16 v[208:209], v234 offset:32768
    v_mfma_f32_16x16x32_bf16 v[104:107], v[196:199], v[180:183], v[104:107]
    ds_read_b64_tr_b16 v[210:211], v234 offset:33792
    s_waitcnt lgkmcnt(6)
    v_mfma_f32_16x16x32_bf16 v[108:111], v[192:195], v[184:187], v[108:111]
    ds_read_b64_tr_b16 v[212:213], v234 offset:40960
    v_mfma_f32_16x16x32_bf16 v[108:111], v[196:199], v[188:191], v[108:111]
    ds_read_b64_tr_b16 v[214:215], v234 offset:41984
    s_waitcnt lgkmcnt(6)
    v_mfma_f32_16x16x32_bf16 v[112:115], v[200:203], v[160:163], v[112:115]
    ds_read_b64_tr_b16 v[192:193], v235 offset:32768
    s_waitcnt lgkmcnt(5)
    v_mfma_f32_16x16x32_bf16 v[112:115], v[204:207], v[164:167], v[112:115]
    ds_read_b64_tr_b16 v[194:195], v235 offset:33792
    v_mfma_f32_16x16x32_bf16 v[116:119], v[200:203], v[168:171], v[116:119]
    ds_read_b64_tr_b16 v[196:197], v235 offset:40960
    v_mfma_f32_16x16x32_bf16 v[116:119], v[204:207], v[172:175], v[116:119]
    ds_read_b64_tr_b16 v[198:199], v235 offset:41984
    v_mfma_f32_16x16x32_bf16 v[120:123], v[200:203], v[176:179], v[120:123]
    ds_read_b128 v[216:219], v248 offset:0
    v_mfma_f32_16x16x32_bf16 v[120:123], v[204:207], v[180:183], v[120:123]
    ds_read_b128 v[224:227], v248 offset:512
    v_mfma_f32_16x16x32_bf16 v[124:127], v[200:203], v[184:187], v[124:127]
    ds_read_b128 v[220:223], v248 offset:64
    v_mfma_f32_16x16x32_bf16 v[124:127], v[204:207], v[188:191], v[124:127]
    ds_read_b128 v[228:231], v248 offset:576
    s_waitcnt lgkmcnt(6)
    v_mfma_f32_16x16x32_bf16 v[128:131], v[208:211], v[160:163], v[128:131]
    ds_read_b64_tr_b16 v[200:201], v250 offset:0
    v_mfma_f32_16x16x32_bf16 v[128:131], v[212:215], v[164:167], v[128:131]
    ds_read_b64_tr_b16 v[202:203], v250 offset:512
    v_mfma_f32_16x16x32_bf16 v[132:135], v[208:211], v[168:171], v[132:135]
    ds_read_b64_tr_b16 v[204:205], v250 offset:4096
    v_mfma_f32_16x16x32_bf16 v[132:135], v[212:215], v[172:175], v[132:135]
    ds_read_b64_tr_b16 v[206:207], v250 offset:4608
    s_waitcnt lgkmcnt(6)
    v_fma_f32 v0, v0, v216, v224
    v_mfma_f32_16x16x32_bf16 v[136:139], v[208:211], v[176:179], v[136:139]
    v_fma_f32 v1, v1, v217, v225
    v_fma_f32 v2, v2, v218, v226
    v_mfma_f32_16x16x32_bf16 v[136:139], v[212:215], v[180:183], v[136:139]
    v_fma_f32 v3, v3, v219, v227
    s_waitcnt lgkmcnt(4)
    v_fma_f32 v4, v4, v220, v228
    v_mfma_f32_16x16x32_bf16 v[140:143], v[208:211], v[184:187], v[140:143]
    v_fma_f32 v5, v5, v221, v229
    v_fma_f32 v6, v6, v222, v230
    v_mfma_f32_16x16x32_bf16 v[140:143], v[212:215], v[188:191], v[140:143]
    v_fma_f32 v7, v7, v223, v231
    v_cvt_pk_bf16_f32 v0, v0, v1
    v_mfma_f32_16x16x32_bf16 v[144:147], v[192:195], v[160:163], v[144:147]
    ds_read_b64_tr_b16 v[208:209], v236 offset:0
    v_cvt_pk_bf16_f32 v1, v2, v3
    v_mfma_f32_16x16x32_bf16 v[144:147], v[196:199], v[164:167], v[144:147]
    ds_read_b64_tr_b16 v[210:211], v236 offset:512
    v_cvt_pk_bf16_f32 v2, v4, v5
    v_mfma_f32_16x16x32_bf16 v[148:151], v[192:195], v[168:171], v[148:151]
    ds_read_b64_tr_b16 v[212:213], v236 offset:4096
    v_cvt_pk_bf16_f32 v3, v6, v7
    v_mfma_f32_16x16x32_bf16 v[148:151], v[196:199], v[172:175], v[148:151]
    ds_read_b64_tr_b16 v[214:215], v236 offset:4608
    buffer_store_dwordx4 v[0:3], v244, s[24:27], s13 offen offset:0 sc1
    v_mfma_f32_16x16x32_bf16 v[152:155], v[192:195], v[176:179], v[152:155]
    s_add_u32 s51, s51, 1
    v_fma_f32 v16, v16, v216, v224
    v_fma_f32 v17, v17, v217, v225
    v_mfma_f32_16x16x32_bf16 v[152:155], v[196:199], v[180:183], v[152:155]
    s_cmp_eq_u32 s51, 3
    v_fma_f32 v18, v18, v218, v226
    v_fma_f32 v19, v19, v219, v227
    v_mfma_f32_16x16x32_bf16 v[156:159], v[192:195], v[184:187], v[156:159]
    s_cselect_b32 s52, s54, s53
    v_fma_f32 v20, v20, v220, v228
    v_fma_f32 v21, v21, v221, v229
    v_mfma_f32_16x16x32_bf16 v[156:159], v[196:199], v[188:191], v[156:159]
    s_cselect_b32 s51, 0, s51
    v_fma_f32 v22, v22, v222, v230
    v_fma_f32 v23, v23, v223, v231
    s_waitcnt lgkmcnt(2)
    v_mfma_f32_16x16x32_bf16 v[64:67], v[200:203], v[160:163], v[64:67]
    s_waitcnt lgkmcnt(0)
    v_cvt_pk_bf16_f32 v16, v16, v17
    v_cvt_pk_bf16_f32 v17, v18, v19
    v_mfma_f32_16x16x32_bf16 v[64:67], v[204:207], v[164:167], v[64:67]
    s_barrier
    v_cvt_pk_bf16_f32 v18, v20, v21
    v_cvt_pk_bf16_f32 v19, v22, v23
    v_mfma_f32_16x16x32_bf16 v[68:71], v[200:203], v[168:171], v[68:71]
    ds_read_b64_tr_b16 v[192:193], v232 offset:49152
    buffer_store_dwordx4 v[16:19], v244, s[24:27], s13 offen offset:1024 sc1
    v_mfma_f32_16x16x32_bf16 v[68:71], v[204:207], v[172:175], v[68:71]
    ds_read_b64_tr_b16 v[194:195], v232 offset:50176
    v_fma_f32 v32, v32, v216, v224
    v_mfma_f32_16x16x32_bf16 v[72:75], v[200:203], v[176:179], v[72:75]
    ds_read_b64_tr_b16 v[196:197], v232 offset:57344
    v_fma_f32 v33, v33, v217, v225
    v_fma_f32 v34, v34, v218, v226
    v_mfma_f32_16x16x32_bf16 v[72:75], v[204:207], v[180:183], v[72:75]
    ds_read_b64_tr_b16 v[198:199], v232 offset:58368
    v_fma_f32 v35, v35, v219, v227
    v_fma_f32 v36, v36, v220, v228
    v_mfma_f32_16x16x32_bf16 v[76:79], v[200:203], v[184:187], v[76:79]
    v_add_u32 v250, s52, v250
    v_add_u32 v236, s52, v236
    v_fma_f32 v37, v37, v221, v229
    v_fma_f32 v38, v38, v222, v230
    v_fma_f32 v39, v39, v223, v231
    v_mfma_f32_16x16x32_bf16 v[76:79], v[204:207], v[188:191], v[76:79]
    v_cvt_pk_bf16_f32 v32, v32, v33
    v_cvt_pk_bf16_f32 v33, v34, v35
    v_mfma_f32_16x16x32_bf16 v[80:83], v[208:211], v[160:163], v[80:83]
    ds_read_b128 v[160:163], v245 offset:49152
    v_cvt_pk_bf16_f32 v34, v36, v37
    v_cvt_pk_bf16_f32 v35, v38, v39
    v_mfma_f32_16x16x32_bf16 v[80:83], v[212:215], v[164:167], v[80:83]
    ds_read_b128 v[164:167], v246 offset:49152
    buffer_store_dwordx4 v[32:35], v244, s[24:27], s13 offen offset:2048 sc1
    v_fma_f32 v48, v48, v216, v224
    v_mfma_f32_16x16x32_bf16 v[84:87], v[208:211], v[168:171], v[84:87]
    ds_read_b128 v[168:171], v245 offset:51200
    v_fma_f32 v49, v49, v217, v225
    v_fma_f32 v50, v50, v218, v226
    v_mfma_f32_16x16x32_bf16 v[84:87], v[212:215], v[172:175], v[84:87]
    ds_read_b128 v[172:175], v246 offset:51200
    v_fma_f32 v51, v51, v219, v227
    v_fma_f32 v52, v52, v220, v228
    v_mfma_f32_16x16x32_bf16 v[88:91], v[208:211], v[176:179], v[88:91]
    ds_read_b128 v[176:179], v245 offset:53248
    v_fma_f32 v53, v53, v221, v229
    v_fma_f32 v54, v54, v222, v230
    v_mfma_f32_16x16x32_bf16 v[88:91], v[212:215], v[180:183], v[88:91]
    ds_read_b128 v[180:183], v246 offset:53248
    v_fma_f32 v55, v55, v223, v231
    v_cvt_pk_bf16_f32 v48, v48, v49
    v_mfma_f32_16x16x32_bf16 v[92:95], v[208:211], v[184:187], v[92:95]
    ds_read_b128 v[184:187], v245 offset:55296
    v_cvt_pk_bf16_f32 v49, v50, v51
    v_cvt_pk_bf16_f32 v50, v52, v53
    v_mfma_f32_16x16x32_bf16 v[92:95], v[212:215], v[188:191], v[92:95]
    ds_read_b128 v[188:191], v246 offset:55296
    v_cvt_pk_bf16_f32 v51, v54, v55
    buffer_store_dwordx4 v[48:51], v244, s[24:27], s13 offen offset:3072 sc1
    s_waitcnt lgkmcnt(6)
    v_mfma_f32_16x16x32_bf16 v[96:99], v[192:195], v[160:163], v[96:99]
    ds_read_b64_tr_b16 v[200:201], v233 offset:49152
    v_mfma_f32_16x16x32_bf16 v[96:99], v[196:199], v[164:167], v[96:99]
    ds_read_b64_tr_b16 v[202:203], v233 offset:50176
    s_waitcnt lgkmcnt(6)
    v_mfma_f32_16x16x32_bf16 v[100:103], v[192:195], v[168:171], v[100:103]
    ds_read_b64_tr_b16 v[204:205], v233 offset:57344
    v_mfma_f32_16x16x32_bf16 v[100:103], v[196:199], v[172:175], v[100:103]
    ds_read_b64_tr_b16 v[206:207], v233 offset:58368
    s_waitcnt lgkmcnt(6)
    v_mfma_f32_16x16x32_bf16 v[104:107], v[192:195], v[176:179], v[104:107]
    ds_read_b64_tr_b16 v[208:209], v234 offset:49152
    v_mfma_f32_16x16x32_bf16 v[104:107], v[196:199], v[180:183], v[104:107]
    ds_read_b64_tr_b16 v[210:211], v234 offset:50176
    s_waitcnt lgkmcnt(6)
    v_mfma_f32_16x16x32_bf16 v[108:111], v[192:195], v[184:187], v[108:111]
    ds_read_b64_tr_b16 v[212:213], v234 offset:57344
    v_mfma_f32_16x16x32_bf16 v[108:111], v[196:199], v[188:191], v[108:111]
    ds_read_b64_tr_b16 v[214:215], v234 offset:58368
    s_waitcnt lgkmcnt(6)
    v_mfma_f32_16x16x32_bf16 v[112:115], v[200:203], v[160:163], v[112:115]
    ds_read_b64_tr_b16 v[192:193], v235 offset:49152
    s_waitcnt lgkmcnt(5)
    v_mfma_f32_16x16x32_bf16 v[112:115], v[204:207], v[164:167], v[112:115]
    ds_read_b64_tr_b16 v[194:195], v235 offset:50176
    v_mfma_f32_16x16x32_bf16 v[116:119], v[200:203], v[168:171], v[116:119]
    ds_read_b64_tr_b16 v[196:197], v235 offset:57344
    v_mfma_f32_16x16x32_bf16 v[116:119], v[204:207], v[172:175], v[116:119]
    ds_read_b64_tr_b16 v[198:199], v235 offset:58368
    v_mfma_f32_16x16x32_bf16 v[120:123], v[200:203], v[176:179], v[120:123]
    ds_read_b128 v[216:219], v248 offset:128
    v_mfma_f32_16x16x32_bf16 v[120:123], v[204:207], v[180:183], v[120:123]
    ds_read_b128 v[224:227], v248 offset:640
    v_mfma_f32_16x16x32_bf16 v[124:127], v[200:203], v[184:187], v[124:127]
    ds_read_b128 v[220:223], v248 offset:192
    v_mfma_f32_16x16x32_bf16 v[124:127], v[204:207], v[188:191], v[124:127]
    ds_read_b128 v[228:231], v248 offset:704
    s_waitcnt lgkmcnt(6)
    v_mfma_f32_16x16x32_bf16 v[128:131], v[208:211], v[160:163], v[128:131]
    ds_read_b64_tr_b16 v[200:201], v250 offset:0
    v_mfma_f32_16x16x32_bf16 v[128:131], v[212:215], v[164:167], v[128:131]
    ds_read_b64_tr_b16 v[202:203], v250 offset:512
    v_mfma_f32_16x16x32_bf16 v[132:135], v[208:211], v[168:171], v[132:135]
    ds_read_b64_tr_b16 v[204:205], v250 offset:4096
    v_mfma_f32_16x16x32_bf16 v[132:135], v[212:215], v[172:175], v[132:135]
    ds_read_b64_tr_b16 v[206:207], v250 offset:4608
    s_waitcnt lgkmcnt(6)
    v_fma_f32 v8, v8, v216, v224
    v_fma_f32 v9, v9, v217, v225
    v_mfma_f32_16x16x32_bf16 v[136:139], v[208:211], v[176:179], v[136:139]
    v_fma_f32 v10, v10, v218, v226
    v_fma_f32 v11, v11, v219, v227
    s_waitcnt lgkmcnt(4)
    v_fma_f32 v12, v12, v220, v228
    v_mfma_f32_16x16x32_bf16 v[136:139], v[212:215], v[180:183], v[136:139]
    v_fma_f32 v13, v13, v221, v229
    v_fma_f32 v14, v14, v222, v230
    v_fma_f32 v15, v15, v223, v231
    v_mfma_f32_16x16x32_bf16 v[140:143], v[208:211], v[184:187], v[140:143]
    v_cvt_pk_bf16_f32 v8, v8, v9
    v_cvt_pk_bf16_f32 v9, v10, v11
    v_cvt_pk_bf16_f32 v10, v12, v13
    v_mfma_f32_16x16x32_bf16 v[140:143], v[212:215], v[188:191], v[140:143]
    v_cvt_pk_bf16_f32 v11, v14, v15
    buffer_store_dwordx4 v[8:11], v244, s[24:27], s14 offen offset:0 sc1
    v_fma_f32 v24, v24, v216, v224
    v_mfma_f32_16x16x32_bf16 v[144:147], v[192:195], v[160:163], v[144:147]
    ds_read_b64_tr_b16 v[208:209], v236 offset:0
    v_fma_f32 v25, v25, v217, v225
    v_fma_f32 v26, v26, v218, v226
    v_mfma_f32_16x16x32_bf16 v[144:147], v[196:199], v[164:167], v[144:147]
    ds_read_b64_tr_b16 v[210:211], v236 offset:512
    v_fma_f32 v27, v27, v219, v227
    v_fma_f32 v28, v28, v220, v228
    v_mfma_f32_16x16x32_bf16 v[148:151], v[192:195], v[168:171], v[148:151]
    ds_read_b64_tr_b16 v[212:213], v236 offset:4096
    v_fma_f32 v29, v29, v221, v229
    v_fma_f32 v30, v30, v222, v230
    v_mfma_f32_16x16x32_bf16 v[148:151], v[196:199], v[172:175], v[148:151]
    ds_read_b64_tr_b16 v[214:215], v236 offset:4608
    v_fma_f32 v31, v31, v223, v231
    v_cvt_pk_bf16_f32 v24, v24, v25
    v_mfma_f32_16x16x32_bf16 v[152:155], v[192:195], v[176:179], v[152:155]
    s_add_u32 s51, s51, 1
    v_cvt_pk_bf16_f32 v25, v26, v27
    v_cvt_pk_bf16_f32 v26, v28, v29
    v_cvt_pk_bf16_f32 v27, v30, v31
    v_mfma_f32_16x16x32_bf16 v[152:155], v[196:199], v[180:183], v[152:155]
    s_cmp_eq_u32 s51, 3
    buffer_store_dwordx4 v[24:27], v244, s[24:27], s14 offen offset:1024 sc1
    v_fma_f32 v40, v40, v216, v224
    v_fma_f32 v41, v41, v217, v225
    v_mfma_f32_16x16x32_bf16 v[156:159], v[192:195], v[184:187], v[156:159]
    s_cselect_b32 s52, s54, s53
    v_fma_f32 v42, v42, v218, v226
    v_fma_f32 v43, v43, v219, v227
    v_fma_f32 v44, v44, v220, v228
    v_mfma_f32_16x16x32_bf16 v[156:159], v[196:199], v[188:191], v[156:159]
    s_cselect_b32 s51, 0, s51
    v_fma_f32 v45, v45, v221, v229
    v_fma_f32 v46, v46, v222, v230
    v_fma_f32 v47, v47, v223, v231
    s_waitcnt lgkmcnt(2)
    v_mfma_f32_16x16x32_bf16 v[64:67], v[200:203], v[160:163], v[64:67]
    s_waitcnt lgkmcnt(0)
    v_cvt_pk_bf16_f32 v40, v40, v41
    v_cvt_pk_bf16_f32 v41, v42, v43
    v_cvt_pk_bf16_f32 v42, v44, v45
    v_mfma_f32_16x16x32_bf16 v[64:67], v[204:207], v[164:167], v[64:67]
    s_barrier
    v_cvt_pk_bf16_f32 v43, v46, v47
    buffer_store_dwordx4 v[40:43], v244, s[24:27], s14 offen offset:2048 sc1
    v_fma_f32 v56, v56, v216, v224
    v_mfma_f32_16x16x32_bf16 v[68:71], v[200:203], v[168:171], v[68:71]
    ds_read_b64_tr_b16 v[192:193], v232 offset:0
    s_sub_u32 s50, s50, 1
    v_fma_f32 v57, v57, v217, v225
    v_mfma_f32_16x16x32_bf16 v[68:71], v[204:207], v[172:175], v[68:71]
    ds_read_b64_tr_b16 v[194:195], v232 offset:1024
    s_cmp_lg_u32 s50, 0
    v_fma_f32 v58, v58, v218, v226
    v_fma_f32 v59, v59, v219, v227
    v_mfma_f32_16x16x32_bf16 v[72:75], v[200:203], v[176:179], v[72:75]
    ds_read_b64_tr_b16 v[196:197], v232 offset:8192
    v_fma_f32 v60, v60, v220, v228
    v_fma_f32 v61, v61, v221, v229
    v_mfma_f32_16x16x32_bf16 v[72:75], v[204:207], v[180:183], v[72:75]
    ds_read_b64_tr_b16 v[198:199], v232 offset:9216
    v_fma_f32 v62, v62, v222, v230
    v_fma_f32 v63, v63, v223, v231
    v_mfma_f32_16x16x32_bf16 v[76:79], v[200:203], v[184:187], v[76:79]
    v_add_u32 v250, s52, v250
    v_add_u32 v236, s52, v236
    v_cvt_pk_bf16_f32 v56, v56, v57
    v_cvt_pk_bf16_f32 v57, v58, v59
    v_cvt_pk_bf16_f32 v58, v60, v61
    v_mfma_f32_16x16x32_bf16 v[76:79], v[204:207], v[188:191], v[76:79]
    v_cvt_pk_bf16_f32 v59, v62, v63
    buffer_store_dwordx4 v[56:59], v244, s[24:27], s14 offen offset:3072 sc1
    v_mfma_f32_16x16x32_bf16 v[80:83], v[208:211], v[160:163], v[80:83]
    ds_read_b128 v[160:163], v245 offset:0
    v_lshlrev_b32 v216, 16, v240
    v_lshlrev_b32 v217, 16, v240
    v_mfma_f32_16x16x32_bf16 v[80:83], v[212:215], v[164:167], v[80:83]
    ds_read_b128 v[164:167], v246 offset:0
    v_lshlrev_b32 v218, 16, v240
    v_lshlrev_b32 v219, 16, v240
    v_mfma_f32_16x16x32_bf16 v[84:87], v[208:211], v[168:171], v[84:87]
    ds_read_b128 v[168:171], v245 offset:2048
    v_lshlrev_b32 v220, 16, v241
    v_lshlrev_b32 v221, 16, v241
    v_mfma_f32_16x16x32_bf16 v[84:87], v[212:215], v[172:175], v[84:87]
    ds_read_b128 v[172:175], v246 offset:2048
    v_lshlrev_b32 v222, 16, v241
    v_lshlrev_b32 v223, 16, v241
    v_mfma_f32_16x16x32_bf16 v[88:91], v[208:211], v[176:179], v[88:91]
    ds_read_b128 v[176:179], v245 offset:4096
    v_lshlrev_b32 v252, 16, v242
    v_lshlrev_b32 v253, 16, v242
    v_mfma_f32_16x16x32_bf16 v[88:91], v[212:215], v[180:183], v[88:91]
    ds_read_b128 v[180:183], v246 offset:4096
    v_lshlrev_b32 v254, 16, v242
    v_lshlrev_b32 v255, 16, v242
    v_mfma_f32_16x16x32_bf16 v[92:95], v[208:211], v[184:187], v[92:95]
    ds_read_b128 v[184:187], v245 offset:6144
    v_lshlrev_b32 v240, 16, v243
    v_lshlrev_b32 v241, 16, v243
    v_mfma_f32_16x16x32_bf16 v[92:95], v[212:215], v[188:191], v[92:95]
    ds_read_b128 v[188:191], v246 offset:6144
    v_lshlrev_b32 v242, 16, v243
    v_lshlrev_b32 v243, 16, v243
    s_branch A_p2
PGA_l2:
    s_setpc_b64 s[72:73]
    s_nop 0
A_l2:
    s_mov_b32 s51, 0
    s_sub_u32 s7, s7, 3584
    s_waitcnt vmcnt(8)
    s_barrier
    s_cmp_lg_u32 s3, 0
    s_cbranch_scc1 A_pollc_i
    buffer_load_dword v13, v12, s[28:31], s48 offen sc1
A_pollc_i:
    s_lshr_b64 s[44:45], s[36:37], s52
    s_and_b32 s60, s44, 15
    s_add_u32 s52, s52, 4
    s_lshl_b32 s60, s60, 17
    s_add_u32 s60, s60, s50
    s_add_u32 m0, s57, 0
    s_nop 0
    buffer_load_dwordx4 v9, s[16:19], s60 offen lds
    s_add_u32 m0, s57, 1024
    s_nop 0
    buffer_load_dwordx4 v10, s[16:19], s60 offen lds
    s_lshr_b64 s[44:45], s[36:37], s51
    s_and_b32 s59, s44, 15
    s_add_u32 s51, s51, 4
    s_lshl_b32 s58, s59, 7
    s_add_u32 s58, s58, s6
    s_mul_i32 s59, s59, 458752
    s_add_u32 s59, s59, s7
    s_add_u32 m0, s56, 0
    s_nop 0
    buffer_load_dwordx4 v20, s[8:11], s58 offen lds
    s_add_u32 m0, s56, 1024
    s_nop 0
    buffer_load_dwordx4 v21, s[8:11], s58 offen lds
    s_add_u32 m0, s56, 2048
    s_nop 0
    buffer_load_dwordx4 v22, s[8:11], s58 offen lds
    s_add_u32 m0, s56, 3072
    s_nop 0
    buffer_load_dwordx4 v23, s[8:11], s58 offen lds
    v_lshrrev_b32 v15, 4, v11
    v_and_b32 v17, 15, v11
    v_lshlrev_b32 v14, 4, v17
    v_lshl_add_u32 v14, v15, 10, v14
    s_lshl_b32 s47, s3, 7
    s_add_u32 s47, s47, 155648
    v_lshl_add_u32 v17, v17, 3, s47
    s_waitcnt vmcnt(6)
    s_barrier
    s_add_u32 m0, s56, 65536
    s_nop 0
    buffer_load_dwordx4 v5, s[12:15], s59 offen lds
    s_add_u32 m0, s56, 66560
    s_nop 0
    buffer_load_dwordx4 v6, s[12:15], s59 offen lds
    s_add_u32 m0, s56, 67584
    s_nop 0
    buffer_load_dwordx4 v7, s[12:15], s59 offen lds
    s_add_u32 m0, s56, 68608
    s_nop 0
    buffer_load_dwordx4 v8, s[12:15], s59 offen lds
    s_add_u32 s57, s57, 8192
    s_cmp_ge_u32 s57, 155648
    s_cselect_b32 s46, 24576, 0
    s_sub_u32 s57, s57, s46
    s_add_u32 s56, s56, 16384
    s_and_b32 s56, s56, 0xffff
    s_cmp_lg_u32 s3, 0
    s_cbranch_scc1 A_pollc_out
    s_mov_b32 s47, 65536
    s_waitcnt vmcnt(10)
A_pollc:
    v_cmp_ne_u32 vcc, 1, v13
    s_sub_u32 s47, s47, 1
    s_cbranch_scc1 A_pollc_out
    s_nop 1
    s_cbranch_vccz A_pollc_out
    s_sleep 2
    buffer_load_dword v13, v12, s[28:31], s48 offen sc1
    s_waitcnt vmcnt(0)
    s_branch A_pollc
A_pollc_out:
    s_lshl_b32 s46, s4, 15
    s_lshl_b32 s47, s3, 8
    s_add_u32 s46, s46, s47
    s_add_u32 s46, s46, 4521984
    s_add_u32 s64, s46, 0
    s_add_u32 s65, s46, 4096
    s_add_u32 s66, s46, 8192
    s_add_u32 s67, s46, 12288
    s_add_u32 s68, s46, 16384
    s_add_u32 s69, s46, 20480
    s_add_u32 s70, s46, 24576
    s_mov_b32 s61, 2
A_seg2:
    s_lshr_b64 s[44:45], s[36:37], s52
    s_and_b32 s60, s44, 15
    s_add_u32 s52, s52, 4
    s_lshl_b32 s60, s60, 17
    s_add_u32 s60, s60, s50
    s_add_u32 m0, s57, 0
    s_nop 0
    buffer_load_dwordx4 v9, s[16:19], s60 offen lds
    s_add_u32 m0, s57, 1024
    s_nop 0
    buffer_load_dwordx4 v10, s[16:19], s60 offen lds
    s_lshr_b64 s[44:45], s[36:37], s51
    s_and_b32 s59, s44, 15
    s_add_u32 s51, s51, 4
    s_lshl_b32 s58, s59, 7
    s_add_u32 s58, s58, s6
    s_mul_i32 s59, s59, 458752
    s_add_u32 s59, s59, s7
    s_add_u32 m0, s56, 0
    s_nop 0
    buffer_load_dwordx4 v20, s[8:11], s58 offen lds
    s_add_u32 m0, s56, 1024
    s_nop 0
    buffer_load_dwordx4 v21, s[8:11], s58 offen lds
    s_add_u32 m0, s56, 2048
    s_nop 0
    buffer_load_dwordx4 v22, s[8:11], s58 offen lds
    s_add_u32 m0, s56, 3072
    s_nop 0
    buffer_load_dwordx4 v23, s[8:11], s58 offen lds
    s_add_u32 m0, s56, 65536
    s_nop 0
    buffer_load_dwordx4 v5, s[12:15], s59 offen lds
    s_add_u32 m0, s56, 66560
    s_nop 0
    buffer_load_dwordx4 v6, s[12:15], s59 offen lds
    s_add_u32 m0, s56, 67584
    s_nop 0
    buffer_load_dwordx4 v7, s[12:15], s59 offen lds
    s_add_u32 m0, s56, 68608
    s_nop 0
    buffer_load_dwordx4 v8, s[12:15], s59 offen lds
    s_add_u32 s57, s57, 8192
    s_cmp_ge_u32 s57, 155648
    s_cselect_b32 s46, 24576, 0
    s_sub_u32 s57, s57, s46
    s_add_u32 s56, s56, 16384
    s_and_b32 s56, s56, 0xffff
    s_sub_u32 s61, s61, 1
    s_cmp_lg_u32 s61, 0
    s_cbranch_scc1 A_seg2
WARM_B:
    s_cmp_lg_u32 s3, 0
    s_cbranch_scc1 WARM_B_1
    s_call_b64 s[72:73], PG9
    s_branch WARM_B_done
WARM_B_1:
    s_cmp_lg_u32 s3, 1
    s_cbranch_scc1 WARM_B_2
    s_call_b64 s[72:73], PGA_norm
    s_branch WARM_B_done
WARM_B_2:
    s_cmp_lg_u32 s3, 2
    s_cbranch_scc1 WARM_B_3
    s_call_b64 s[72:73], PG2
    s_branch WARM_B_done
WARM_B_3:
    s_call_b64 s[72:73], PG3
WARM_B_done:
    s_waitcnt vmcnt(20)
    s_barrier
    s_lshr_b64 s[44:45], s[36:37], s51
    s_and_b32 s59, s44, 15
    s_add_u32 s51, s51, 4
    s_lshl_b32 s58, s59, 7
    s_add_u32 s58, s58, s6
    s_mul_i32 s59, s59, 458752
    s_add_u32 s59, s59, s7
    s_add_u32 m0, s56, 0
    s_nop 0
    buffer_load_dwordx4 v20, s[8:11], s58 offen lds
    s_add_u32 m0, s56, 1024
    s_nop 0
    buffer_load_dwordx4 v21, s[8:11], s58 offen lds
    s_add_u32 m0, s56, 2048
    s_nop 0
    buffer_load_dwordx4 v22, s[8:11], s58 offen lds
    s_add_u32 m0, s56, 3072
    s_nop 0
    buffer_load_dwordx4 v23, s[8:11], s58 offen lds
    s_add_u32 m0, s56, 65536
    s_nop 0
    buffer_load_dwordx4 v5, s[12:15], s59 offen lds
    s_add_u32 m0, s56, 66560
    s_nop 0
    buffer_load_dwordx4 v6, s[12:15], s59 offen lds
    s_add_u32 m0, s56, 67584
    s_nop 0
    buffer_load_dwordx4 v7, s[12:15], s59 offen lds
    s_add_u32 m0, s56, 68608
    s_nop 0
    buffer_load_dwordx4 v8, s[12:15], s59 offen lds
    s_add_u32 s56, s56, 16384
    s_and_b32 s56, s56, 0xffff
WARM_D:
    s_cmp_lg_u32 s3, 0
    s_cbranch_scc1 WARM_D_1
    s_call_b64 s[72:73], PGA_sub_fill
    s_branch WARM_D_done
    s_nop 0
    s_nop 0
    s_nop 0
    s_nop 0
WARM_D_1:
    s_cmp_lg_u32 s3, 1
    s_cbranch_scc1 WARM_D_2
    s_call_b64 s[72:73], PG4
    s_branch WARM_D_done
WARM_D_2:
    s_cmp_lg_u32 s3, 2
    s_cbranch_scc1 WARM_D_3
    s_call_b64 s[72:73], PG5
    s_branch WARM_D_done
WARM_D_3:
    s_call_b64 s[72:73], PG10
WARM_D_done:
    s_mov_b32 s61, 3
A_seg3:
    s_waitcnt vmcnt(18)
    s_barrier
    s_lshr_b64 s[44:45], s[36:37], s52
    s_and_b32 s60, s44, 15
    s_add_u32 s52, s52, 4
    s_lshl_b32 s60, s60, 17
    s_add_u32 s60, s60, s50
    s_add_u32 m0, s57, 0
    s_nop 0
    buffer_load_dwordx4 v9, s[16:19], s60 offen lds
    s_add_u32 m0, s57, 1024
    s_nop 0
    buffer_load_dwordx4 v10, s[16:19], s60 offen lds
    s_lshr_b64 s[44:45], s[36:37], s51
    s_and_b32 s59, s44, 15
    s_add_u32 s51, s51, 4
    s_lshl_b32 s58, s59, 7
    s_add_u32 s58, s58, s6
    s_mul_i32 s59, s59, 458752
    s_add_u32 s59, s59, s7
    s_add_u32 m0, s56, 0
    s_nop 0
    buffer_load_dwordx4 v20, s[8:11], s58 offen lds
    s_add_u32 m0, s56, 1024
    s_nop 0
    buffer_load_dwordx4 v21, s[8:11], s58 offen lds
    s_add_u32 m0, s56, 2048
    s_nop 0
    buffer_load_dwordx4 v22, s[8:11], s58 offen lds
    s_add_u32 m0, s56, 3072
    s_nop 0
    buffer_load_dwordx4 v23, s[8:11], s58 offen lds
    s_add_u32 m0, s56, 65536
    s_branch PG9_go
    .p2align 12
PG9:
    s_setpc_b64 s[72:73]
    s_nop 0
PG9_go:
    s_nop 0
    buffer_load_dwordx4 v5, s[12:15], s59 offen lds
    s_add_u32 m0, s56, 66560
    s_nop 0
    buffer_load_dwordx4 v6, s[12:15], s59 offen lds
    s_add_u32 m0, s56, 67584
    s_nop 0
    buffer_load_dwordx4 v7, s[12:15], s59 offen lds
    s_add_u32 m0, s56, 68608
    s_nop 0
    buffer_load_dwordx4 v8, s[12:15], s59 offen lds
    s_add_u32 s57, s57, 8192
    s_cmp_ge_u32 s57, 155648
    s_cselect_b32 s46, 24576, 0
    s_sub_u32 s57, s57, s46
    s_add_u32 s56, s56, 16384
    s_and_b32 s56, s56, 0xffff
    s_sub_u32 s61, s61, 1
    s_cmp_lg_u32 s61, 0
    s_cbranch_scc1 A_seg3
    s_waitcnt vmcnt(18)
    s_barrier
    s_lshr_b64 s[44:45], s[36:37], s52
    s_and_b32 s60, s44, 15
    s_add_u32 s52, s52, 4
    s_lshl_b32 s60, s60, 17
    s_add_u32 s60, s60, s50
    s_add_u32 m0, s57, 0
    s_nop 0
    buffer_load_dwordx4 v9, s[16:19], s60 offen lds
    s_add_u32 m0, s57, 1024
    s_nop 0
    buffer_load_dwordx4 v10, s[16:19], s60 offen lds
    s_add_u32 s57, s57, 8192
    s_cmp_ge_u32 s57, 155648
    s_cselect_b32 s46, 24576, 0
    s_sub_u32 s57, s57, s46
    buffer_load_dwordx4 v[32:35], v14, s[24:27], s64 offen sc1
    buffer_load_dwordx4 v[36:39], v14, s[24:27], s65 offen sc1
    buffer_load_dwordx4 v[40:43], v14, s[24:27], s66 offen sc1
    buffer_load_dwordx4 v[44:47], v14, s[24:27], s67 offen sc1
    buffer_load_dwordx4 v[48:51], v14, s[24:27], s68 offen sc1
    buffer_load_dwordx4 v[52:55], v14, s[24:27], s69 offen sc1
    buffer_load_dwordx4 v[56:59], v14, s[24:27], s70 offen sc1
    s_waitcnt vmcnt(17)
    s_barrier
    s_setprio 2
    s_lshr_b64 s[44:45], s[36:37], s52
    s_and_b32 s60, s44, 15
    s_add_u32 s52, s52, 4
    s_lshl_b32 s60, s60, 17
    s_add_u32 s60, s60, s50
    s_add_u32 m0, s57, 0
    s_nop 0
    buffer_load_dwordx4 v9, s[16:19], s60 offen lds
    s_add_u32 m0, s57, 1024
    s_nop 0
    buffer_load_dwordx4 v10, s[16:19], s60 offen lds
    s_lshr_b64 s[44:45], s[36:37], s51
    s_and_b32 s59, s44, 15
    s_add_u32 s51, s51, 4
    s_lshl_b32 s58, s59, 7
    s_add_u32 s58, s58, s6
    s_mul_i32 s59, s59, 458752
    s_add_u32 s59, s59, s7
    s_add_u32 m0, s56, 0
    s_nop 0
    buffer_load_dwordx4 v20, s[8:11], s58 offen lds
    s_waitcnt vmcnt(3)
    v_add_f32 v32, v32, v48
    v_add_f32 v33, v33, v49
    v_add_f32 v34, v34, v50
    v_add_f32 v35, v35, v51
    v_add_f32 v36, v36, v52
    v_add_f32 v37, v37, v53
    v_add_f32 v38, v38, v54
    v_add_f32 v39, v39, v55
    v_add_f32 v40, v40, v56
    v_add_f32 v41, v41, v57
    v_add_f32 v42, v42, v58
    v_add_f32 v43, v43, v59
    s_add_u32 m0, s56, 1024
    s_nop 0
    buffer_load_dwordx4 v21, s[8:11], s58 offen lds
    v_add_f32 v32, v32, v40
    v_add_f32 v33, v33, v41
    v_add_f32 v34, v34, v42
    v_add_f32 v35, v35, v43
    v_add_f32 v36, v36, v44
    v_add_f32 v37, v37, v45
    v_add_f32 v38, v38, v46
    v_add_f32 v39, v39, v47
    v_add_f32 v32, v32, v36
    v_add_f32 v33, v33, v37
    v_add_f32 v34, v34, v38
    v_add_f32 v35, v35, v39
    v_mov_b32 v36, v32
    s_add_u32 m0, s56, 2048
    s_nop 0
    buffer_load_dwordx4 v22, s[8:11], s58 offen lds
    v_mov_b32 v37, v33
    v_mov_b32 v38, v34
    v_mov_b32 v39, v35
    v_permlane32_swap_b32 v32, v36
    v_permlane32_swap_b32 v33, v37
    v_permlane32_swap_b32 v34, v38
    v_permlane32_swap_b32 v35, v39
    v_add_f32 v32, v32, v36
    v_add_f32 v33, v33, v37
    v_add_f32 v34, v34, v38
    v_add_f32 v35, v35, v39
    v_mov_b32 v36, v32
    v_mov_b32 v37, v33
    s_add_u32 m0, s56, 3072
    s_nop 0
    buffer_load_dwordx4 v23, s[8:11], s58 offen lds
    v_mov_b32 v38, v34
    v_mov_b32 v39, v35
    v_permlane16_swap_b32 v32, v36
    v_permlane16_swap_b32 v33, v37
    v_permlane16_swap_b32 v34, v38
    v_permlane16_swap_b32 v35, v39
    v_add_f32 v32, v32, v36
    v_add_f32 v33, v33, v37
    v_add_f32 v34, v34, v38
    v_add_f32 v35, v35, v39
    v_mul_f32 v32, 0x3a124925, v32
    v_mul_f32 v33, 0x3a124925, v33
    v_mul_f32 v34, 0x3a124925, v34
    s_add_u32 m0, s56, 65536
    s_nop 0
    buffer_load_dwordx4 v5, s[12:15], s59 offen lds
    v_mul_f32 v35, 0x3a124925, v35
    v_fma_f32 v33, -v32, v32, v33
    v_fma_f32 v35, -v34, v34, v35
    v_cmp_u_f32 vcc, v33, v35
    v_max_f32 v33, 0, v33
    v_max_f32 v35, 0, v35
    v_add_f32 v33, 0x3727c5ac, v33
    v_add_f32 v35, 0x3727c5ac, v35
    v_rsq_f32 v40, v33
    v_rsq_f32 v41, v35
    s_nop 0
    v_mul_f32 v42, -v32, v40
    v_mul_f32 v43, -v34, v41
    s_cbranch_vccnz A_gather
A_have:
    s_mov_b64 exec, 0xffff
    ds_write_b64 v17, v[40:41]
    ds_write_b64 v17, v[42:43] offset:512
    s_mov_b64 exec, -1
    s_setprio 0
    s_add_u32 m0, s56, 66560
    s_nop 0
    buffer_load_dwordx4 v6, s[12:15], s59 offen lds
    s_add_u32 m0, s56, 67584
    s_nop 0
    buffer_load_dwordx4 v7, s[12:15], s59 offen lds
    s_add_u32 m0, s56, 68608
    s_nop 0
    buffer_load_dwordx4 v8, s[12:15], s59 offen lds
    s_add_u32 s57, s57, 8192
    s_cmp_ge_u32 s57, 155648
    s_cselect_b32 s46, 24576, 0
    s_sub_u32 s57, s57, s46
    s_add_u32 s56, s56, 16384
    s_and_b32 s56, s56, 0xffff
    s_waitcnt lgkmcnt(0)
    s_mov_b32 s61, 4
A_seg4:
    s_waitcnt vmcnt(10)
    s_barrier
    s_lshr_b64 s[44:45], s[36:37], s52
    s_and_b32 s60, s44, 15
    s_add_u32 s52, s52, 4
    s_lshl_b32 s60, s60, 17
    s_add_u32 s60, s60, s50
    s_add_u32 m0, s57, 0
    s_nop 0
    buffer_load_dwordx4 v9, s[16:19], s60 offen lds
    s_add_u32 m0, s57, 1024
    s_nop 0
    buffer_load_dwordx4 v10, s[16:19], s60 offen lds
    s_lshr_b64 s[44:45], s[36:37], s51
    s_and_b32 s59, s44, 15
    s_add_u32 s51, s51, 4
    s_lshl_b32 s58, s59, 7
    s_add_u32 s58, s58, s6
    s_mul_i32 s59, s59, 458752
    s_add_u32 s59, s59, s7
    s_add_u32 m0, s56, 0
    s_nop 0
    buffer_load_dwordx4 v20, s[8:11], s58 offen lds
    s_add_u32 m0, s56, 1024
    s_nop 0
    buffer_load_dwordx4 v21, s[8:11], s58 offen lds
    s_add_u32 m0, s56, 2048
    s_nop 0
    buffer_load_dwordx4 v22, s[8:11], s58 offen lds
    s_add_u32 m0, s56, 3072
    s_nop 0
    buffer_load_dwordx4 v23, s[8:11], s58 offen lds
    s_add_u32 m0, s56, 65536
    s_nop 0
    buffer_load_dwordx4 v5, s[12:15], s59 offen lds
    s_add_u32 m0, s56, 66560
    s_nop 0
    buffer_load_dwordx4 v6, s[12:15], s59 offen lds
    s_add_u32 m0, s56, 67584
    s_nop 0
    buffer_load_dwordx4 v7, s[12:15], s59 offen lds
    s_add_u32 m0, s56, 68608
    s_nop 0
    buffer_load_dwordx4 v8, s[12:15], s59 offen lds
    s_add_u32 s57, s57, 8192
    s_cmp_ge_u32 s57, 155648
    s_cselect_b32 s46, 24576, 0
    s_sub_u32 s57, s57, s46
    s_add_u32 s56, s56, 16384
    s_and_b32 s56, s56, 0xffff
    s_sub_u32 s61, s61, 1
    s_cmp_lg_u32 s61, 0
    s_cbranch_scc1 A_seg4
    s_waitcnt vmcnt(10)
    s_barrier
    s_lshl_b32 s46, s4, 7
    s_add_u32 s46, s46, s5
    s_lshl_b32 s46, s46, 8
    s_add_u32 s46, s46, 4550656
    s_cmp_lg_u32 s3, 0
    s_cbranch_scc1 A_setz
    v_mov_b32 v16, 1
    s_mov_b64 exec, 1
    buffer_store_dword v16, off, s[24:27], s46 sc1
    s_mov_b64 exec, -1
A_setz:
    s_lshr_b64 s[44:45], s[36:37], s52
    s_and_b32 s60, s44, 15
    s_add_u32 s52, s52, 4
    s_lshl_b32 s60, s60, 17
    s_add_u32 s60, s60, s50
    s_add_u32 m0, s57, 0
    s_nop 0
    buffer_load_dwordx4 v9, s[16:19], s60 offen lds
    s_add_u32 m0, s57, 1024
    s_nop 0
    buffer_load_dwordx4 v10, s[16:19], s60 offen lds
    s_lshr_b64 s[44:45], s[36:37], s51
    s_and_b32 s59, s44, 15
    s_add_u32 s51, s51, 4
    s_lshl_b32 s58, s59, 7
    s_add_u32 s58, s58, s6
    s_mul_i32 s59, s59, 458752
    s_add_u32 s59, s59, s7
    s_add_u32 m0, s56, 0
    s_nop 0
    buffer_load_dwordx4 v20, s[8:11], s58 offen lds
    s_add_u32 m0, s56, 1024
    s_nop 0
    buffer_load_dwordx4 v21, s[8:11], s58 offen lds
    s_add_u32 m0, s56, 2048
    s_nop 0
    buffer_load_dwordx4 v22, s[8:11], s58 offen lds
    s_add_u32 m0, s56, 3072
    s_nop 0
    buffer_load_dwordx4 v23, s[8:11], s58 offen lds
    s_add_u32 m0, s56, 65536
    s_nop 0
    buffer_load_dwordx4 v5, s[12:15], s59 offen lds
    s_add_u32 m0, s56, 66560
    s_nop 0
    buffer_load_dwordx4 v6, s[12:15], s59 offen lds
    s_add_u32 m0, s56, 67584
    s_nop 0
    buffer_load_dwordx4 v7, s[12:15], s59 offen lds
    s_add_u32 m0, s56, 68608
    s_nop 0
    buffer_load_dwordx4 v8, s[12:15], s59 offen lds
    s_add_u32 s57, s57, 8192
    s_cmp_ge_u32 s57, 155648
    s_cselect_b32 s46, 24576, 0
    s_sub_u32 s57, s57, s46
    s_add_u32 s56, s56, 16384
    s_and_b32 s56, s56, 0xffff
    v_and_b32 v12, 15, v11
    v_lshlrev_b32 v12, 15, v12
    s_lshl_b32 s48, s5, 8
    s_add_u32 s48, s48, 4550656
    s_mov_b32 s61, 2
A_seg5:
    s_waitcnt vmcnt(10)
    s_barrier
    s_lshr_b64 s[44:45], s[36:37], s52
    s_and_b32 s60, s44, 15
    s_add_u32 s52, s52, 4
    s_lshl_b32 s60, s60, 17
    s_add_u32 s60, s60, s50
    s_add_u32 m0, s57, 0
    s_nop 0
    buffer_load_dwordx4 v9, s[16:19], s60 offen lds
    s_add_u32 m0, s57, 1024
    s_nop 0
    buffer_load_dwordx4 v10, s[16:19], s60 offen lds
    s_lshr_b64 s[44:45], s[36:37], s51
    s_and_b32 s59, s44, 15
    s_add_u32 s51, s51, 4
    s_lshl_b32 s58, s59, 7
    s_add_u32 s58, s58, s6
    s_mul_i32 s59, s59, 458752
    s_add_u32 s59, s59, s7
    s_add_u32 m0, s56, 0
    s_nop 0
    buffer_load_dwordx4 v20, s[8:11], s58 offen lds
    s_add_u32 m0, s56, 1024
    s_nop 0
    buffer_load_dwordx4 v21, s[8:11], s58 offen lds
    s_add_u32 m0, s56, 2048
    s_nop 0
    buffer_load_dwordx4 v22, s[8:11], s58 offen lds
    s_add_u32 m0, s56, 3072
    s_nop 0
    buffer_load_dwordx4 v23, s[8:11], s58 offen lds
    s_add_u32 m0, s56, 65536
    s_nop 0
    buffer_load_dwordx4 v5, s[12:15], s59 offen lds
    s_add_u32 m0, s56, 66560
    s_nop 0
    buffer_load_dwordx4 v6, s[12:15], s59 offen lds
    s_add_u32 m0, s56, 67584
    s_nop 0
    buffer_load_dwordx4 v7, s[12:15], s59 offen lds
    s_add_u32 m0, s56, 68608
    s_nop 0
    buffer_load_dwordx4 v8, s[12:15], s59 offen lds
    s_add_u32 s57, s57, 8192
    s_cmp_ge_u32 s57, 155648
    s_cselect_b32 s46, 24576, 0
    s_sub_u32 s57, s57, s46
    s_add_u32 s56, s56, 16384
    s_and_b32 s56, s56, 0xffff
    s_sub_u32 s61, s61, 1
    s_cmp_lg_u32 s61, 0
    s_cbranch_scc1 A_seg5
    s_waitcnt vmcnt(10)
    s_barrier
    s_cmp_lg_u32 s3, 0
    s_cbranch_scc1 A_pollz_i
    buffer_load_dword v13, v12, s[24:27], s48 offen sc1
A_pollz_i:
    s_lshr_b64 s[44:45], s[36:37], s52
    s_and_b32 s60, s44, 15
    s_add_u32 s52, s52, 4
    s_lshl_b32 s60, s60, 17
    s_add_u32 s60, s60, s50
    s_add_u32 m0, s57, 0
    s_nop 0
    buffer_load_dwordx4 v9, s[16:19], s60 offen lds
    s_add_u32 m0, s57, 1024
    s_nop 0
    buffer_load_dwordx4 v10, s[16:19], s60 offen lds
    s_lshr_b64 s[44:45], s[36:37], s51
    s_and_b32 s59, s44, 15
    s_add_u32 s51, s51, 4
    s_lshl_b32 s58, s59, 7
    s_add_u32 s58, s58, s6
    s_mul_i32 s59, s59, 458752
    s_add_u32 s59, s59, s7
    s_add_u32 m0, s56, 0
    s_nop 0
    buffer_load_dwordx4 v20, s[8:11], s58 offen lds
    s_add_u32 m0, s56, 1024
    s_nop 0
    buffer_load_dwordx4 v21, s[8:11], s58 offen lds
    s_add_u32 m0, s56, 2048
    s_nop 0
    buffer_load_dwordx4 v22, s[8:11], s58 offen lds
    s_add_u32 m0, s56, 3072
    s_nop 0
    buffer_load_dwordx4 v23, s[8:11], s58 offen lds
    s_add_u32 m0, s56, 65536
    s_nop 0
    buffer_load_dwordx4 v5, s[12:15], s59 offen lds
    s_add_u32 m0, s56, 66560
    s_nop 0
    buffer_load_dwordx4 v6, s[12:15], s59 offen lds
    s_add_u32 m0, s56, 67584
    s_nop 0
    buffer_load_dwordx4 v7, s[12:15], s59 offen lds
    s_add_u32 m0, s56, 68608
    s_nop 0
    buffer_load_dwordx4 v8, s[12:15], s59 offen lds
    s_add_u32 s57, s57, 8192
    s_cmp_ge_u32 s57, 155648
    s_cselect_b32 s46, 24576, 0
    s_sub_u32 s57, s57, s46
    s_add_u32 s56, s56, 16384
    s_and_b32 s56, s56, 0xffff
    s_mov_b32 s51, 0
    s_lshl_b32 s6, s6, 1
    s_lshl_b32 s7, s5, 19
    s_lshl_b32 s46, s3, 12
    s_add_u32 s7, s7, s46
    s_add_u32 s7, s7, 5242880
    s_mul_i32 s53, s4, 1
    s_add_u32 s53, s53, s55
    s_lshl_b32 s60, s3, 11
    s_add_u32 s57, s60, 131072
    s_add_u32 s60, s60, 4198400
    s_load_dwordx2 s[8:9], s[0:1], 32
    s_load_dwordx2 s[12:13], s[0:1], 72
    s_mul_i32 s62, s55, 7
    s_lshr_b32 s62, s62, 1
    s_mul_i32 s63, s55, 2
    s_waitcnt lgkmcnt(0)
    s_mov_b32 s10, 0x200000
    s_mov_b32 s11, 0x20000
    s_mov_b32 s14, 0x380000
    s_mov_b32 s15, 0x20000
    s_add_u32 s54, s62, 16
    s_cmp_ge_u32 s54, 28
    s_cselect_b32 s46, 28, 0
    s_sub_u32 s54, s54, s46
    s_lshl_b32 s54, s54, 17
    s_cmp_lg_u32 s3, 0
    s_cbranch_scc1 A_pollz_out
    s_mov_b32 s47, 65536
    s_waitcnt vmcnt(10)
A_pollz:
    v_cmp_ne_u32 vcc, 1, v13
    s_sub_u32 s47, s47, 1
    s_cbranch_scc1 A_pollz_out
    s_nop 1
    s_cbranch_vccz A_pollz_out
    s_sleep 2
    buffer_load_dword v13, v12, s[24:27], s48 offen sc1
    s_waitcnt vmcnt(0)
    s_branch A_pollz
A_pollz_out:
    v_bfe_u32 v12, v11, 1, 4
    v_and_b32 v13, 1, v11
    v_lshl_add_u32 v12, v12, 7, v13
    v_lshlrev_b32 v12, 8, v12
    v_lshlrev_b32 v14, 2, v11
    s_mov_b32 s48, 4554240
    s_waitcnt vmcnt(10)
    s_barrier
    s_add_u32 s59, s51, s53
    s_and_b32 s59, s59, 3
    s_and_b32 s46, s51, 28
    s_or_b32 s59, s59, s46
    s_add_u32 s51, s51, 1
    s_lshl_b32 s58, s59, 7
    s_add_u32 s58, s58, s6
    s_mul_i32 s59, s59, 16384
    s_add_u32 s59, s59, s7
    s_add_u32 m0, s56, 0
    s_nop 0
    buffer_load_dwordx4 v24, s[20:23], s58 offen lds
    s_add_u32 m0, s56, 1024
    s_nop 0
    buffer_load_dwordx4 v25, s[20:23], s58 offen lds
    s_add_u32 m0, s56, 2048
    s_nop 0
    buffer_load_dwordx4 v26, s[20:23], s58 offen lds
    s_add_u32 m0, s56, 3072
    s_nop 0
    buffer_load_dwordx4 v27, s[20:23], s58 offen lds
    s_add_u32 m0, s56, 65536
    s_nop 0
    buffer_load_dwordx4 v28, s[24:27], s59 offen offset:0 sc1 lds
    buffer_load_dwordx4 v28, s[24:27], s59 offen offset:1024 sc1 lds
    buffer_load_dwordx4 v28, s[24:27], s59 offen offset:2048 sc1 lds
    buffer_load_dwordx4 v28, s[24:27], s59 offen offset:3072 sc1 lds
    s_add_u32 s56, s56, 16384
    s_and_b32 s56, s56, 0xffff
    s_mov_b32 s61, 10
A_seg7:
    s_waitcnt vmcnt(8)
    s_barrier
    s_add_u32 s59, s51, s53
    s_and_b32 s59, s59, 3
    s_and_b32 s46, s51, 28
    s_or_b32 s59, s59, s46
    s_add_u32 s51, s51, 1
    s_lshl_b32 s58, s59, 7
    s_add_u32 s58, s58, s6
    s_mul_i32 s59, s59, 16384
    s_add_u32 s59, s59, s7
    s_add_u32 m0, s56, 0
    s_nop 0
    buffer_load_dwordx4 v24, s[20:23], s58 offen lds
    s_add_u32 m0, s56, 1024
    s_nop 0
    buffer_load_dwordx4 v25, s[20:23], s58 offen lds
    s_add_u32 m0, s56, 2048
    s_nop 0
    buffer_load_dwordx4 v26, s[20:23], s58 offen lds
    s_add_u32 m0, s56, 3072
    s_nop 0
    buffer_load_dwordx4 v27, s[20:23], s58 offen lds
    s_add_u32 m0, s56, 65536
    s_nop 0
    buffer_load_dwordx4 v28, s[24:27], s59 offen offset:0 sc1 lds
    buffer_load_dwordx4 v28, s[24:27], s59 offen offset:1024 sc1 lds
    buffer_load_dwordx4 v28, s[24:27], s59 offen offset:2048 sc1 lds
    buffer_load_dwordx4 v28, s[24:27], s59 offen offset:3072 sc1 lds
    s_add_u32 s56, s56, 16384
    s_and_b32 s56, s56, 0xffff
    s_sub_u32 s61, s61, 1
    s_cmp_lg_u32 s61, 0
    s_cbranch_scc1 A_seg7
    s_waitcnt vmcnt(8)
    s_barrier
    s_cmp_lg_u32 s3, 0
    s_cbranch_scc1 A_pollkv_i
    buffer_load_dword v13, v12, s[24:27], s48 offen sc1
A_pollkv_i:
    s_add_u32 s59, s51, s53
    s_and_b32 s59, s59, 3
    s_and_b32 s46, s51, 28
    s_or_b32 s59, s59, s46
    s_add_u32 s51, s51, 1
    s_lshl_b32 s58, s59, 7
    s_add_u32 s58, s58, s6
    s_mul_i32 s59, s59, 16384
    s_add_u32 s59, s59, s7
    s_add_u32 m0, s56, 0
    s_nop 0
    buffer_load_dwordx4 v24, s[20:23], s58 offen lds
    s_add_u32 m0, s56, 1024
    s_nop 0
    buffer_load_dwordx4 v25, s[20:23], s58 offen lds
    s_add_u32 m0, s56, 2048
    s_nop 0
    buffer_load_dwordx4 v26, s[20:23], s58 offen lds
    s_add_u32 m0, s56, 3072
    s_nop 0
    buffer_load_dwordx4 v27, s[20:23], s58 offen lds
    s_add_u32 m0, s56, 65536
    s_nop 0
    buffer_load_dwordx4 v28, s[24:27], s59 offen offset:0 sc1 lds
    buffer_load_dwordx4 v28, s[24:27], s59 offen offset:1024 sc1 lds
    buffer_load_dwordx4 v28, s[24:27], s59 offen offset:2048 sc1 lds
    buffer_load_dwordx4 v28, s[24:27], s59 offen offset:3072 sc1 lds
    s_add_u32 s56, s56, 16384
    s_and_b32 s56, s56, 0xffff
    s_cmp_lg_u32 s3, 0
    s_cbranch_scc1 A_pollkv_out
    s_mov_b32 s47, 65536
    s_waitcnt vmcnt(8)
A_pollkv:
    v_cmp_ne_u32 vcc, 1, v13
    s_sub_u32 s47, s47, 1
    s_cbranch_scc1 A_pollkv_out
    s_nop 1
    s_cbranch_vccz A_pollkv_out
    s_sleep 2
    buffer_load_dword v13, v12, s[24:27], s48 offen sc1
    s_waitcnt vmcnt(0)
    s_branch A_pollkv
A_pollkv_out:
    s_waitcnt vmcnt(8)
    s_barrier
    s_cmp_ge_u32 s3, 2
    s_cbranch_scc1 A_ft_g
    s_lshl_b32 s46, s3, 10
    s_add_u32 m0, s46, 155648
    s_add_u32 s46, s46, 4194304
    buffer_load_dwordx4 v28, s[24:27], s46 offen sc1 lds
    s_branch A_ft_e
A_ft_g:
    s_lshl_b32 s46, s3, 8
    s_add_u32 m0, s46, 157184
    s_lshl_b32 s47, s4, 9
    s_add_u32 s46, s46, s47
    s_add_u32 s46, s46, 4488704
    buffer_load_dword v14, s[24:27], s46 offen sc1 lds
A_ft_e:
    s_call_b64 s[66:67], A_sub_fill
    s_waitcnt vmcnt(11)
    s_barrier
    s_add_u32 s59, s51, s53
    s_and_b32 s59, s59, 3
    s_and_b32 s46, s51, 28
    s_or_b32 s59, s59, s46
    s_add_u32 s51, s51, 1
    s_lshl_b32 s58, s59, 7
    s_add_u32 s58, s58, s6
    s_mul_i32 s59, s59, 16384
    s_add_u32 s59, s59, s7
    s_add_u32 m0, s56, 0
    s_nop 0
    buffer_load_dwordx4 v24, s[20:23], s58 offen lds
    s_add_u32 m0, s56, 1024
    s_nop 0
    buffer_load_dwordx4 v25, s[20:23], s58 offen lds
    s_add_u32 m0, s56, 2048
    s_nop 0
    buffer_load_dwordx4 v26, s[20:23], s58 offen lds
    s_add_u32 m0, s56, 3072
    s_nop 0
    buffer_load_dwordx4 v27, s[20:23], s58 offen lds
    s_add_u32 m0, s56, 65536
    s_nop 0
    buffer_load_dwordx4 v28, s[24:27], s59 offen offset:0 sc1 lds
    buffer_load_dwordx4 v28, s[24:27], s59 offen offset:1024 sc1 lds
    buffer_load_dwordx4 v28, s[24:27], s59 offen offset:2048 sc1 lds
    buffer_load_dwordx4 v28, s[24:27], s59 offen offset:3072 sc1 lds
    s_add_u32 s56, s56, 16384
    s_and_b32 s56, s56, 0xffff
    s_waitcnt vmcnt(8)
    s_barrier
    s_mov_b32 m0, s57
    s_nop 0
    buffer_load_dwordx4 v28, s[24:27], s60 offen offset:0 sc1 lds
    buffer_load_dwordx4 v28, s[24:27], s60 offen offset:1024 sc1 lds
    s_add_u32 s60, s60, 8192
    s_add_u32 s57, s57, 8192
    s_and_b32 s57, s57, 163839
    s_call_b64 s[66:67], A_sub_fill
    s_waitcnt vmcnt(0)
    s_barrier
    s_call_b64 s[66:67], A_sub_fill
    s_call_b64 s[66:67], A_sub_fill
WARM_C:
    s_cmp_lg_u32 s3, 0
    s_cbranch_scc1 WARM_C_1
    s_call_b64 s[72:73], PG6
    s_branch WARM_C_done
    s_nop 0
    s_nop 0
WARM_C_1:
    s_cmp_lg_u32 s3, 1
    s_cbranch_scc1 WARM_C_2
    s_call_b64 s[72:73], PG7
    s_branch WARM_C_done
WARM_C_2:
    s_cmp_lg_u32 s3, 2
    s_cbranch_scc1 WARM_C_3
    s_call_b64 s[72:73], PG8
    s_branch WARM_C_done
WARM_C_3:
WARM_C_done:
    s_waitcnt vmcnt(0)
    s_barrier
    s_call_b64 s[66:67], A_sub_fill
    s_call_b64 s[66:67], A_sub_fill
    s_waitcnt vmcnt(0)
    s_barrier
    s_call_b64 s[66:67], A_sub_fill
    s_call_b64 s[66:67], A_sub_fill
    buffer_load_dwordx4 v[32:35], v29, s[12:15], s54 offen
    buffer_load_dwordx4 v[36:39], v30, s[12:15], s54 offen
    s_add_u32 s54, s54, 131072
    s_cmp_eq_u32 s54, 3670016
    s_cselect_b32 s54, 0, s54
    buffer_load_dwordx4 v[40:43], v29, s[12:15], s54 offen
    buffer_load_dwordx4 v[44:47], v30, s[12:15], s54 offen
    s_add_u32 s54, s54, 131072
    s_cmp_eq_u32 s54, 3670016
    s_cselect_b32 s54, 0, s54
    buffer_load_dwordx4 v[48:51], v29, s[12:15], s54 offen
    buffer_load_dwordx4 v[52:55], v30, s[12:15], s54 offen
    s_add_u32 s54, s54, 131072
    s_cmp_eq_u32 s54, 3670016
    s_cselect_b32 s54, 0, s54
    s_waitcnt vmcnt(6)
    s_barrier
    s_call_b64 s[66:67], A_sub_fill
    s_call_b64 s[66:67], A_sub_fill
    buffer_load_dwordx4 v[56:59], v29, s[12:15], s54 offen
    buffer_load_dwordx4 v[60:63], v30, s[12:15], s54 offen
    s_add_u32 s54, s54, 131072
    s_cmp_eq_u32 s54, 3670016
    s_cselect_b32 s54, 0, s54
    buffer_load_dwordx4 v[64:67], v29, s[12:15], s54 offen
    buffer_load_dwordx4 v[68:71], v30, s[12:15], s54 offen
    s_add_u32 s54, s54, 131072
    s_cmp_eq_u32 s54, 3670016
    s_cselect_b32 s54, 0, s54
    buffer_load_dwordx4 v[72:75], v29, s[12:15], s54 offen
    buffer_load_dwordx4 v[76:79], v30, s[12:15], s54 offen
    s_add_u32 s54, s54, 131072
    s_cmp_eq_u32 s54, 3670016
    s_cselect_b32 s54, 0, s54
    s_waitcnt vmcnt(6)
    s_barrier
    s_call_b64 s[66:67], A_sub_fill
    s_call_b64 s[66:67], A_sub_fill
    buffer_load_dwordx4 v[80:83], v29, s[12:15], s54 offen
    buffer_load_dwordx4 v[84:87], v30, s[12:15], s54 offen
    s_add_u32 s54, s54, 131072
    s_cmp_eq_u32 s54, 3670016
    s_cselect_b32 s54, 0, s54
    buffer_load_dwordx4 v[88:91], v29, s[12:15], s54 offen
    buffer_load_dwordx4 v[92:95], v30, s[12:15], s54 offen
    s_add_u32 s54, s54, 131072
    s_cmp_eq_u32 s54, 3670016
    s_cselect_b32 s54, 0, s54
    buffer_load_dwordx4 v[96:99], v29, s[12:15], s54 offen
    buffer_load_dwordx4 v[100:103], v30, s[12:15], s54 offen
    s_add_u32 s54, s54, 131072
    s_cmp_eq_u32 s54, 3670016
    s_cselect_b32 s54, 0, s54
    s_waitcnt vmcnt(6)
    s_barrier
    s_call_b64 s[66:67], A_sub_fill
    s_call_b64 s[66:67], A_sub_fill
    buffer_load_dwordx4 v[104:107], v29, s[12:15], s54 offen
    buffer_load_dwordx4 v[108:111], v30, s[12:15], s54 offen
    s_add_u32 s54, s54, 131072
    s_cmp_eq_u32 s54, 3670016
    s_cselect_b32 s54, 0, s54
    buffer_load_dwordx4 v[112:115], v29, s[12:15], s54 offen
    buffer_load_dwordx4 v[116:119], v30, s[12:15], s54 offen
    s_add_u32 s54, s54, 131072
    s_cmp_eq_u32 s54, 3670016
    s_cselect_b32 s54, 0, s54
    buffer_load_dwordx4 v[120:123], v29, s[12:15], s54 offen
    buffer_load_dwordx4 v[124:127], v30, s[12:15], s54 offen
    s_add_u32 s54, s54, 131072
    s_cmp_eq_u32 s54, 3670016
    s_cselect_b32 s54, 0, s54
    s_waitcnt vmcnt(6)
    s_barrier
    s_call_b64 s[66:67], A_sub_fill
    s_call_b64 s[66:67], A_sub_fill
    s_lshl_b32 s54, s63, 17
    buffer_load_dwordx4 v[128:131], v29, s[8:11], s54 offen
    buffer_load_dwordx4 v[132:135], v30, s[8:11], s54 offen
    s_add_u32 s54, s54, 131072
    s_cmp_eq_u32 s54, 2097152
    s_cselect_b32 s54, 0, s54
    buffer_load_dwordx4 v[136:139], v29, s[8:11], s54 offen
    buffer_load_dwordx4 v[140:143], v30, s[8:11], s54 offen
    s_branch PG10_go
    .p2align 12
PG10:
    s_setpc_b64 s[72:73]
    s_nop 0
PG10_go:
    s_add_u32 s54, s54, 131072
    s_cmp_eq_u32 s54, 2097152
    s_cselect_b32 s54, 0, s54
    buffer_load_dwordx4 v[144:147], v29, s[8:11], s54 offen
    buffer_load_dwordx4 v[148:151], v30, s[8:11], s54 offen
    s_add_u32 s54, s54, 131072
    s_cmp_eq_u32 s54, 2097152
    s_cselect_b32 s54, 0, s54
    s_waitcnt vmcnt(6)
    s_barrier
    s_call_b64 s[66:67], A_sub_fill
    s_call_b64 s[66:67], A_sub_fill
    buffer_load_dwordx4 v[152:155], v29, s[8:11], s54 offen
    buffer_load_dwordx4 v[156:159], v30, s[8:11], s54 offen
    s_add_u32 s54, s54, 131072
    s_cmp_eq_u32 s54, 2097152
    s_cselect_b32 s54, 0, s54
    buffer_load_dwordx4 v[160:163], v29, s[8:11], s54 offen
    buffer_load_dwordx4 v[164:167], v30, s[8:11], s54 offen
    s_add_u32 s54, s54, 131072
    s_cmp_eq_u32 s54, 2097152
    s_cselect_b32 s54, 0, s54
    buffer_load_dwordx4 v[168:171], v29, s[8:11], s54 offen
    buffer_load_dwordx4 v[172:175], v30, s[8:11], s54 offen
    s_add_u32 s54, s54, 131072
    s_cmp_eq_u32 s54, 2097152
    s_cselect_b32 s54, 0, s54
    s_waitcnt vmcnt(6)
    s_barrier
    s_call_b64 s[66:67], A_sub_fill
    s_mov_b32 m0, s57
    s_nop 0
    buffer_load_dwordx4 v28, s[24:27], s60 offen offset:0 sc1 lds
    buffer_load_dwordx4 v28, s[24:27], s60 offen offset:1024 sc1 lds
    s_add_u32 s60, s60, 8192
    s_add_u32 s57, s57, 8192
    s_and_b32 s57, s57, 163839
    buffer_load_dwordx4 v[176:179], v29, s[8:11], s54 offen
    buffer_load_dwordx4 v[180:183], v30, s[8:11], s54 offen
    s_add_u32 s54, s54, 131072
    s_cmp_eq_u32 s54, 2097152
    s_cselect_b32 s54, 0, s54
    buffer_load_dwordx4 v[184:187], v29, s[8:11], s54 offen
    buffer_load_dwordx4 v[188:191], v30, s[8:11], s54 offen
    s_add_u32 s54, s54, 131072
    s_cmp_eq_u32 s54, 2097152
    s_cselect_b32 s54, 0, s54
    buffer_load_dwordx4 v[192:195], v29, s[8:11], s54 offen
    buffer_load_dwordx4 v[196:199], v30, s[8:11], s54 offen
    s_add_u32 s54, s54, 131072
    s_cmp_eq_u32 s54, 2097152
    s_cselect_b32 s54, 0, s54
    buffer_load_dwordx4 v[200:203], v29, s[8:11], s54 offen
    buffer_load_dwordx4 v[204:207], v30, s[8:11], s54 offen
    s_add_u32 s54, s54, 131072
    s_cmp_eq_u32 s54, 2097152
    s_cselect_b32 s54, 0, s54
    buffer_load_dwordx4 v[208:211], v29, s[8:11], s54 offen
    buffer_load_dwordx4 v[212:215], v30, s[8:11], s54 offen
    s_add_u32 s54, s54, 131072
    s_cmp_eq_u32 s54, 2097152
    s_cselect_b32 s54, 0, s54
    buffer_load_dwordx4 v[216:219], v29, s[8:11], s54 offen
    buffer_load_dwordx4 v[220:223], v30, s[8:11], s54 offen
    s_add_u32 s54, s54, 131072
    s_cmp_eq_u32 s54, 2097152
    s_cselect_b32 s54, 0, s54
A_loader_tail:
    s_lshl_b32 s56, s3, 11
    s_lshl_b32 s58, s62, 17
    v_min_u32 v12, 13, v11
    v_lshlrev_b32 v12, 8, v12
    s_lshl_b32 s48, s4, 15
    s_add_u32 s48, s48, 4550660
    s_waitcnt vmcnt(12)
    s_barrier
    s_mov_b32 m0, s57
    s_nop 0
    buffer_load_dwordx4 v28, s[24:27], s60 offen offset:0 sc1 lds
    buffer_load_dwordx4 v28, s[24:27], s60 offen offset:1024 sc1 lds
    s_add_u32 s60, s60, 8192
    s_add_u32 s57, s57, 8192
    s_and_b32 s57, s57, 163839
    s_mov_b32 m0, s57
    s_nop 0
    buffer_load_dwordx4 v28, s[24:27], s60 offen offset:0 sc1 lds
    buffer_load_dwordx4 v28, s[24:27], s60 offen offset:1024 sc1 lds
    s_add_u32 s60, s60, 8192
    s_add_u32 s57, s57, 8192
    s_and_b32 s57, s57, 163839
    buffer_load_dwordx4 v[224:227], v29, s[8:11], s54 offen
    buffer_load_dwordx4 v[228:231], v30, s[8:11], s54 offen
    s_add_u32 s54, s54, 131072
    s_cmp_eq_u32 s54, 2097152
    s_cselect_b32 s54, 0, s54
    buffer_load_dwordx4 v[232:235], v29, s[8:11], s54 offen
    buffer_load_dwordx4 v[236:239], v30, s[8:11], s54 offen
    s_add_u32 s54, s54, 131072
    s_cmp_eq_u32 s54, 2097152
    s_cselect_b32 s54, 0, s54
    buffer_load_dwordx4 v[240:243], v29, s[8:11], s54 offen
    buffer_load_dwordx4 v[244:247], v30, s[8:11], s54 offen
    s_add_u32 s54, s54, 131072
    s_cmp_eq_u32 s54, 2097152
    s_cselect_b32 s54, 0, s54
    buffer_load_dwordx4 v[248:251], v29, s[8:11], s54 offen
    buffer_load_dwordx4 v[252:255], v30, s[8:11], s54 offen
    s_add_u32 s54, s54, 131072
    s_cmp_eq_u32 s54, 2097152
    s_cselect_b32 s54, 0, s54
    s_waitcnt vmcnt(8)
    s_barrier
    s_mov_b32 m0, s57
    s_nop 0
    buffer_load_dwordx4 v28, s[24:27], s60 offen offset:0 sc1 lds
    buffer_load_dwordx4 v28, s[24:27], s60 offen offset:1024 sc1 lds
    s_add_u32 s60, s60, 8192
    s_add_u32 s57, s57, 8192
    s_and_b32 s57, s57, 163839
    s_mov_b32 m0, s57
    s_nop 0
    buffer_load_dwordx4 v28, s[24:27], s60 offen offset:0 sc1 lds
    buffer_load_dwordx4 v28, s[24:27], s60 offen offset:1024 sc1 lds
    s_add_u32 s60, s60, 8192
    s_add_u32 s57, s57, 8192
    s_and_b32 s57, s57, 163839
    s_waitcnt vmcnt(0)
    s_barrier
    s_cmp_ge_u32 s5, 14
    s_cbranch_scc1 A_seth
    s_lshl_b32 s46, s4, 7
    s_add_u32 s46, s46, s5
    s_lshl_b32 s46, s46, 8
    s_add_u32 s46, s46, 4550660
    s_cmp_lg_u32 s3, 0
    s_cbranch_scc1 A_seth
    v_mov_b32 v16, 1
    s_mov_b64 exec, 1
    buffer_store_dword v16, off, s[24:27], s46 sc1
    s_mov_b64 exec, -1
A_seth:
    s_mov_b32 m0, s57
    s_nop 0
    buffer_load_dwordx4 v28, s[24:27], s60 offen offset:0 sc1 lds
    buffer_load_dwordx4 v28, s[24:27], s60 offen offset:1024 sc1 lds
    s_add_u32 s60, s60, 8192
    s_add_u32 s57, s57, 8192
    s_and_b32 s57, s57, 163839
    s_mov_b32 m0, s57
    s_nop 0
    buffer_load_dwordx4 v28, s[24:27], s60 offen offset:0 sc1 lds
    buffer_load_dwordx4 v28, s[24:27], s60 offen offset:1024 sc1 lds
    s_add_u32 s60, s60, 8192
    s_add_u32 s57, s57, 8192
    s_and_b32 s57, s57, 163839
    s_add_u32 m0, s56, 0
    s_nop 0
    buffer_load_dwordx4 v29, s[12:15], s58 offen lds
    s_add_u32 m0, s56, 1024
    s_nop 0
    buffer_load_dwordx4 v30, s[12:15], s58 offen lds
    s_add_u32 s58, s58, 131072
    s_cmp_ge_u32 s58, 3670016
    s_cselect_b32 s46, 3670016, 0
    s_sub_u32 s58, s58, s46
    s_add_u32 s56, s56, 8192
    s_and_b32 s56, s56, 0x1ffff
    s_add_u32 m0, s56, 0
    s_nop 0
    buffer_load_dwordx4 v29, s[12:15], s58 offen lds
    s_add_u32 m0, s56, 1024
    s_nop 0
    buffer_load_dwordx4 v30, s[12:15], s58 offen lds
    s_add_u32 s58, s58, 131072
    s_cmp_ge_u32 s58, 3670016
    s_cselect_b32 s46, 3670016, 0
    s_sub_u32 s58, s58, s46
    s_add_u32 s56, s56, 8192
    s_and_b32 s56, s56, 0x1ffff
    s_add_u32 m0, s56, 0
    s_nop 0
    buffer_load_dwordx4 v29, s[12:15], s58 offen lds
    s_add_u32 m0, s56, 1024
    s_nop 0
    buffer_load_dwordx4 v30, s[12:15], s58 offen lds
    s_add_u32 s58, s58, 131072
    s_cmp_ge_u32 s58, 3670016
    s_cselect_b32 s46, 3670016, 0
    s_sub_u32 s58, s58, s46
    s_add_u32 s56, s56, 8192
    s_and_b32 s56, s56, 0x1ffff
    s_add_u32 m0, s56, 0
    s_nop 0
    buffer_load_dwordx4 v29, s[12:15], s58 offen lds
    s_add_u32 m0, s56, 1024
    s_nop 0
    buffer_load_dwordx4 v30, s[12:15], s58 offen lds
    s_add_u32 s58, s58, 131072
    s_cmp_ge_u32 s58, 3670016
    s_cselect_b32 s46, 3670016, 0
    s_sub_u32 s58, s58, s46
    s_add_u32 s56, s56, 8192
    s_and_b32 s56, s56, 0x1ffff
    s_add_u32 m0, s56, 0
    s_nop 0
    buffer_load_dwordx4 v29, s[12:15], s58 offen lds
    s_add_u32 m0, s56, 1024
    s_nop 0
    buffer_load_dwordx4 v30, s[12:15], s58 offen lds
    s_add_u32 s58, s58, 131072
    s_cmp_ge_u32 s58, 3670016
    s_cselect_b32 s46, 3670016, 0
    s_sub_u32 s58, s58, s46
    s_add_u32 s56, s56, 8192
    s_and_b32 s56, s56, 0x1ffff
    s_add_u32 m0, s56, 0
    s_nop 0
    buffer_load_dwordx4 v29, s[12:15], s58 offen lds
    s_add_u32 m0, s56, 1024
    s_nop 0
    buffer_load_dwordx4 v30, s[12:15], s58 offen lds
    s_add_u32 s58, s58, 131072
    s_cmp_ge_u32 s58, 3670016
    s_cselect_b32 s46, 3670016, 0
    s_sub_u32 s58, s58, s46
    s_add_u32 s56, s56, 8192
    s_and_b32 s56, s56, 0x1ffff
    s_waitcnt vmcnt(12)
    s_barrier
    s_mov_b32 m0, s57
    s_nop 0
    buffer_load_dwordx4 v28, s[24:27], s60 offen offset:0 sc1 lds
    buffer_load_dwordx4 v28, s[24:27], s60 offen offset:1024 sc1 lds
    s_add_u32 s60, s60, 8192
    s_add_u32 s57, s57, 8192
    s_and_b32 s57, s57, 163839
    s_mov_b32 m0, s57
    s_nop 0
    buffer_load_dwordx4 v28, s[24:27], s60 offen offset:0 sc1 lds
    buffer_load_dwordx4 v28, s[24:27], s60 offen offset:1024 sc1 lds
    s_add_u32 s60, s60, 8192
    s_add_u32 s57, s57, 8192
    s_and_b32 s57, s57, 163839
    s_add_u32 m0, s56, 0
    s_nop 0
    buffer_load_dwordx4 v29, s[12:15], s58 offen lds
    s_add_u32 m0, s56, 1024
    s_nop 0
    buffer_load_dwordx4 v30, s[12:15], s58 offen lds
    s_add_u32 s58, s58, 131072
    s_cmp_ge_u32 s58, 3670016
    s_cselect_b32 s46, 3670016, 0
    s_sub_u32 s58, s58, s46
    s_add_u32 s56, s56, 8192
    s_and_b32 s56, s56, 0x1ffff
    s_add_u32 m0, s56, 0
    s_nop 0
    buffer_load_dwordx4 v29, s[12:15], s58 offen lds
    s_add_u32 m0, s56, 1024
    s_nop 0
    buffer_load_dwordx4 v30, s[12:15], s58 offen lds
    s_add_u32 s58, s58, 131072
    s_cmp_ge_u32 s58, 3670016
    s_cselect_b32 s46, 3670016, 0
    s_sub_u32 s58, s58, s46
    s_add_u32 s56, s56, 8192
    s_and_b32 s56, s56, 0x1ffff
    s_add_u32 m0, s56, 0
    s_nop 0
    buffer_load_dwordx4 v29, s[12:15], s58 offen lds
    s_add_u32 m0, s56, 1024
    s_nop 0
    buffer_load_dwordx4 v30, s[12:15], s58 offen lds
    s_add_u32 s58, s58, 131072
    s_cmp_ge_u32 s58, 3670016
    s_cselect_b32 s46, 3670016, 0
    s_sub_u32 s58, s58, s46
    s_add_u32 s56, s56, 8192
    s_and_b32 s56, s56, 0x1ffff
    s_add_u32 m0, s56, 0
    s_nop 0
    buffer_load_dwordx4 v29, s[12:15], s58 offen lds
    s_add_u32 m0, s56, 1024
    s_nop 0
    buffer_load_dwordx4 v30, s[12:15], s58 offen lds
    s_add_u32 s58, s58, 131072
    s_cmp_ge_u32 s58, 3670016
    s_cselect_b32 s46, 3670016, 0
    s_sub_u32 s58, s58, s46
    s_add_u32 s56, s56, 8192
    s_and_b32 s56, s56, 0x1ffff
    s_add_u32 m0, s56, 0
    s_nop 0
    buffer_load_dwordx4 v29, s[12:15], s58 offen lds
    s_add_u32 m0, s56, 1024
    s_nop 0
    buffer_load_dwordx4 v30, s[12:15], s58 offen lds
    s_add_u32 s58, s58, 131072
    s_cmp_ge_u32 s58, 3670016
    s_cselect_b32 s46, 3670016, 0
    s_sub_u32 s58, s58, s46
    s_add_u32 s56, s56, 8192
    s_and_b32 s56, s56, 0x1ffff
    s_add_u32 m0, s56, 0
    s_nop 0
    buffer_load_dwordx4 v29, s[12:15], s58 offen lds
    s_add_u32 m0, s56, 1024
    s_nop 0
    buffer_load_dwordx4 v30, s[12:15], s58 offen lds
    s_add_u32 s58, s58, 131072
    s_cmp_ge_u32 s58, 3670016
    s_cselect_b32 s46, 3670016, 0
    s_sub_u32 s58, s58, s46
    s_add_u32 s56, s56, 8192
    s_and_b32 s56, s56, 0x1ffff
    s_waitcnt vmcnt(12)
    s_barrier
    s_mov_b32 m0, s57
    s_nop 0
    buffer_load_dwordx4 v28, s[24:27], s60 offen offset:0 sc1 lds
    buffer_load_dwordx4 v28, s[24:27], s60 offen offset:1024 sc1 lds
    s_add_u32 s60, s60, 8192
    s_add_u32 s57, s57, 8192
    s_and_b32 s57, s57, 163839
    s_mov_b32 m0, s57
    s_nop 0
    buffer_load_dwordx4 v28, s[24:27], s60 offen offset:0 sc1 lds
    buffer_load_dwordx4 v28, s[24:27], s60 offen offset:1024 sc1 lds
    s_add_u32 s60, s60, 8192
    s_add_u32 s57, s57, 8192
    s_and_b32 s57, s57, 163839
    s_add_u32 m0, s56, 0
    s_nop 0
    buffer_load_dwordx4 v29, s[12:15], s58 offen lds
    s_add_u32 m0, s56, 1024
    s_nop 0
    buffer_load_dwordx4 v30, s[12:15], s58 offen lds
    s_add_u32 s58, s58, 131072
    s_cmp_ge_u32 s58, 3670016
    s_cselect_b32 s46, 3670016, 0
    s_sub_u32 s58, s58, s46
    s_add_u32 s56, s56, 8192
    s_and_b32 s56, s56, 0x1ffff
    s_add_u32 m0, s56, 0
    s_nop 0
    buffer_load_dwordx4 v29, s[12:15], s58 offen lds
    s_add_u32 m0, s56, 1024
    s_nop 0
    buffer_load_dwordx4 v30, s[12:15], s58 offen lds
    s_add_u32 s58, s58, 131072
    s_cmp_ge_u32 s58, 3670016
    s_cselect_b32 s46, 3670016, 0
    s_sub_u32 s58, s58, s46
    s_add_u32 s56, s56, 8192
    s_and_b32 s56, s56, 0x1ffff
    s_add_u32 m0, s56, 0
    s_nop 0
    buffer_load_dwordx4 v29, s[12:15], s58 offen lds
    s_add_u32 m0, s56, 1024
    s_nop 0
    buffer_load_dwordx4 v30, s[12:15], s58 offen lds
    s_add_u32 s58, s58, 131072
    s_cmp_ge_u32 s58, 3670016
    s_cselect_b32 s46, 3670016, 0
    s_sub_u32 s58, s58, s46
    s_add_u32 s56, s56, 8192
    s_and_b32 s56, s56, 0x1ffff
    s_add_u32 m0, s56, 0
    s_nop 0
    buffer_load_dwordx4 v29, s[12:15], s58 offen lds
    s_add_u32 m0, s56, 1024
    s_nop 0
    buffer_load_dwordx4 v30, s[12:15], s58 offen lds
    s_add_u32 s58, s58, 131072
    s_cmp_ge_u32 s58, 3670016
    s_cselect_b32 s46, 3670016, 0
    s_sub_u32 s58, s58, s46
    s_add_u32 s56, s56, 8192
    s_and_b32 s56, s56, 0x1ffff
    s_cmp_lg_u32 s3, 0
    s_cbranch_scc1 A_pollh_i
    buffer_load_dword v13, v12, s[24:27], s48 offen sc1
A_pollh_i:
    s_cmp_lg_u32 s3, 0
    s_cbranch_scc1 A_pollh_out
    s_mov_b32 s47, 65536
    s_waitcnt vmcnt(0)
A_pollh:
    v_cmp_ne_u32 vcc, 1, v13
    s_sub_u32 s47, s47, 1
    s_cbranch_scc1 A_pollh_out
    s_nop 1
    s_cbranch_vccz A_pollh_out
    s_sleep 4
    buffer_load_dword v13, v12, s[24:27], s48 offen sc1
    s_waitcnt vmcnt(0)
    s_branch A_pollh
A_pollh_out:
    s_waitcnt vmcnt(8)
    s_barrier
    s_mov_b32 m0, s57
    s_nop 0
    buffer_load_dwordx4 v28, s[24:27], s60 offen offset:0 sc1 lds
    buffer_load_dwordx4 v28, s[24:27], s60 offen offset:1024 sc1 lds
    s_add_u32 s60, s60, 8192
    s_add_u32 s57, s57, 8192
    s_and_b32 s57, s57, 163839
    s_waitcnt vmcnt(0)
    s_lshl_b32 s46, s3, 11
    v_add_u32 v1, s46, v28
    v_add_u32 v2, 0x10000, v1
    s_barrier
    s_barrier
    ds_write_b128 v1, v[32:35] offset:0
    ds_write_b128 v1, v[36:39] offset:1024
    ds_write_b128 v1, v[40:43] offset:8192
    ds_write_b128 v1, v[44:47] offset:9216
    ds_write_b128 v1, v[48:51] offset:16384
    ds_write_b128 v1, v[52:55] offset:17408
    ds_write_b128 v1, v[56:59] offset:24576
    ds_write_b128 v1, v[60:63] offset:25600
    s_waitcnt lgkmcnt(0)
    s_barrier
    s_lshl_b32 s46, s4, 7
    s_add_u32 s46, s46, s5
    s_lshl_b32 s46, s46, 8
    s_add_u32 s46, s46, 4550664
    s_cmp_lg_u32 s3, 0
    s_cbranch_scc1 A_seto
    v_mov_b32 v16, 1
    s_mov_b64 exec, 1
    buffer_store_dword v16, off, s[24:27], s46 sc1
    s_mov_b64 exec, -1
A_seto:
    ds_write_b128 v1, v[64:67] offset:32768
    ds_write_b128 v1, v[68:71] offset:33792
    ds_write_b128 v1, v[72:75] offset:40960
    ds_write_b128 v1, v[76:79] offset:41984
    ds_write_b128 v1, v[80:83] offset:49152
    ds_write_b128 v1, v[84:87] offset:50176
    ds_write_b128 v1, v[88:91] offset:57344
    ds_write_b128 v1, v[92:95] offset:58368
    s_waitcnt lgkmcnt(0)
    s_barrier
    ds_write_b128 v2, v[96:99] offset:0
    ds_write_b128 v2, v[100:103] offset:1024
    ds_write_b128 v2, v[104:107] offset:8192
    ds_write_b128 v2, v[108:111] offset:9216
    ds_write_b128 v2, v[112:115] offset:16384
    ds_write_b128 v2, v[116:119] offset:17408
    ds_write_b128 v2, v[120:123] offset:24576
    ds_write_b128 v2, v[124:127] offset:25600
    s_waitcnt lgkmcnt(0)
    s_barrier
    v_min_u32 v12, 15, v11
    v_lshlrev_b32 v12, 8, v12
    s_lshl_b32 s48, s4, 15
    s_add_u32 s48, s48, 4550664
    ds_write_b128 v2, v[128:131] offset:32768
    ds_write_b128 v2, v[132:135] offset:33792
    ds_write_b128 v2, v[136:139] offset:40960
    ds_write_b128 v2, v[140:143] offset:41984
    ds_write_b128 v2, v[144:147] offset:49152
    ds_write_b128 v2, v[148:151] offset:50176
    ds_write_b128 v2, v[152:155] offset:57344
    ds_write_b128 v2, v[156:159] offset:58368
    s_waitcnt lgkmcnt(0)
    s_barrier
    s_cmp_lg_u32 s3, 0
    s_cbranch_scc1 A_pollo_i
    buffer_load_dword v13, v12, s[24:27], s48 offen sc1
A_pollo_i:
    ds_write_b128 v1, v[160:163] offset:0
    ds_write_b128 v1, v[164:167] offset:1024
    ds_write_b128 v1, v[168:171] offset:8192
    ds_write_b128 v1, v[172:175] offset:9216
    ds_write_b128 v1, v[176:179] offset:16384
    ds_write_b128 v1, v[180:183] offset:17408
    ds_write_b128 v1, v[184:187] offset:24576
    ds_write_b128 v1, v[188:191] offset:25600
    s_cmp_lg_u32 s3, 0
    s_cbranch_scc1 A_pollo_out
    s_mov_b32 s47, 65536
    s_waitcnt vmcnt(0)
A_pollo:
    v_cmp_ne_u32 vcc, 1, v13
    s_sub_u32 s47, s47, 1
    s_cbranch_scc1 A_pollo_out
    s_nop 1
    s_cbranch_vccz A_pollo_out
    s_sleep 2
    buffer_load_dword v13, v12, s[24:27], s48 offen sc1
    s_waitcnt vmcnt(0)
    s_branch A_pollo
A_pollo_out:
    s_waitcnt lgkmcnt(0)
    s_barrier
    ds_write_b128 v1, v[192:195] offset:32768
    ds_write_b128 v1, v[196:199] offset:33792
    ds_write_b128 v1, v[200:203] offset:40960
    ds_write_b128 v1, v[204:207] offset:41984
    ds_write_b128 v1, v[208:211] offset:49152
    ds_write_b128 v1, v[212:215] offset:50176
    ds_write_b128 v1, v[216:219] offset:57344
    ds_write_b128 v1, v[220:223] offset:58368
    s_waitcnt lgkmcnt(0)
    s_barrier
    ds_write_b128 v2, v[224:227] offset:0
    ds_write_b128 v2, v[228:231] offset:1024
    ds_write_b128 v2, v[232:235] offset:8192
    ds_write_b128 v2, v[236:239] offset:9216
    ds_write_b128 v2, v[240:243] offset:16384
    ds_write_b128 v2, v[244:247] offset:17408
    ds_write_b128 v2, v[248:251] offset:24576
    ds_write_b128 v2, v[252:255] offset:25600
    s_waitcnt lgkmcnt(0)
    s_barrier
    s_endpgm
A_gather:
    s_mov_b32 s47, 65536
A_gather_spin:
    buffer_load_dwordx4 v[32:35], v14, s[24:27], s64 offen sc1
    buffer_load_dwordx4 v[36:39], v14, s[24:27], s65 offen sc1
    buffer_load_dwordx4 v[40:43], v14, s[24:27], s66 offen sc1
    buffer_load_dwordx4 v[44:47], v14, s[24:27], s67 offen sc1
    buffer_load_dwordx4 v[48:51], v14, s[24:27], s68 offen sc1
    buffer_load_dwordx4 v[52:55], v14, s[24:27], s69 offen sc1
    buffer_load_dwordx4 v[56:59], v14, s[24:27], s70 offen sc1
    s_waitcnt vmcnt(0)
    v_max_u32 v15, v32, v33
    v_max3_u32 v15, v15, v34, v35
    v_max3_u32 v15, v15, v36, v37
    v_max3_u32 v15, v15, v38, v39
    v_max3_u32 v15, v15, v40, v41
    v_max3_u32 v15, v15, v42, v43
    v_max3_u32 v15, v15, v44, v45
    v_max3_u32 v15, v15, v46, v47
    v_max3_u32 v15, v15, v48, v49
    v_max3_u32 v15, v15, v50, v51
    v_max3_u32 v15, v15, v52, v53
    v_max3_u32 v15, v15, v54, v55
    v_max3_u32 v15, v15, v56, v57
    v_max3_u32 v15, v15, v58, v59
    v_cmp_eq_u32 vcc, -1, v15
    s_sub_u32 s47, s47, 1
    s_cbranch_scc1 A_gather_end
    s_nop 1
    s_cbranch_vccnz A_gather_spin
A_gather_end:
    v_add_f32 v32, v32, v48
    v_add_f32 v33, v33, v49
    v_add_f32 v34, v34, v50
    v_add_f32 v35, v35, v51
    v_add_f32 v36, v36, v52
    v_add_f32 v37, v37, v53
    v_add_f32 v38, v38, v54
    v_add_f32 v39, v39, v55
    v_add_f32 v40, v40, v56
    v_add_f32 v41, v41, v57
    v_add_f32 v42, v42, v58
    v_add_f32 v43, v43, v59
    v_add_f32 v32, v32, v40
    v_add_f32 v33, v33, v41
    v_add_f32 v34, v34, v42
    v_add_f32 v35, v35, v43
    v_add_f32 v36, v36, v44
    v_add_f32 v37, v37, v45
    v_add_f32 v38, v38, v46
    v_add_f32 v39, v39, v47
    v_add_f32 v32, v32, v36
    v_add_f32 v33, v33, v37
    v_add_f32 v34, v34, v38
    v_add_f32 v35, v35, v39
    v_mov_b32 v36, v32
    v_mov_b32 v37, v33
    v_mov_b32 v38, v34
    v_mov_b32 v39, v35
    v_permlane32_swap_b32 v32, v36
    v_permlane32_swap_b32 v33, v37
    v_permlane32_swap_b32 v34, v38
    v_permlane32_swap_b32 v35, v39
    v_add_f32 v32, v32, v36
    v_add_f32 v33, v33, v37
    v_add_f32 v34, v34, v38
    v_add_f32 v35, v35, v39
    v_mov_b32 v36, v32
    v_mov_b32 v37, v33
    v_mov_b32 v38, v34
    v_mov_b32 v39, v35
    v_permlane16_swap_b32 v32, v36
    v_permlane16_swap_b32 v33, v37
    v_permlane16_swap_b32 v34, v38
    v_permlane16_swap_b32 v35, v39
    v_add_f32 v32, v32, v36
    v_add_f32 v33, v33, v37
    v_add_f32 v34, v34, v38
    v_add_f32 v35, v35, v39
    v_mul_f32 v32, 0x3a124925, v32
    v_mul_f32 v33, 0x3a124925, v33
    v_mul_f32 v34, 0x3a124925, v34
    v_mul_f32 v35, 0x3a124925, v35
    v_fma_f32 v33, -v32, v32, v33
    v_fma_f32 v35, -v34, v34, v35
    v_cmp_u_f32 vcc, v33, v35
    v_max_f32 v33, 0, v33
    v_max_f32 v35, 0, v35
    v_add_f32 v33, 0x3727c5ac, v33
    v_add_f32 v35, 0x3727c5ac, v35
    v_rsq_f32 v40, v33
    v_rsq_f32 v41, v35
    s_nop 0
    v_mul_f32 v42, -v32, v40
    v_mul_f32 v43, -v34, v41
    s_branch A_have
PGA_sub_fill:
    s_setpc_b64 s[72:73]
    s_nop 0
A_sub_fill:
    s_mov_b32 m0, s57
    s_nop 0
    buffer_load_dwordx4 v28, s[24:27], s60 offen offset:0 sc1 lds
    buffer_load_dwordx4 v28, s[24:27], s60 offen offset:1024 sc1 lds
    s_add_u32 s59, s51, s53
    s_and_b32 s59, s59, 3
    s_and_b32 s46, s51, 28
    s_or_b32 s59, s59, s46
    s_add_u32 s51, s51, 1
    s_lshl_b32 s58, s59, 7
    s_add_u32 s58, s58, s6
    s_mul_i32 s59, s59, 16384
    s_add_u32 s59, s59, s7
    s_add_u32 m0, s56, 0
    s_nop 0
    buffer_load_dwordx4 v24, s[20:23], s58 offen lds
    s_add_u32 m0, s56, 1024
    s_nop 0
    buffer_load_dwordx4 v25, s[20:23], s58 offen lds
    s_add_u32 m0, s56, 2048
    s_nop 0
    buffer_load_dwordx4 v26, s[20:23], s58 offen lds
    s_add_u32 m0, s56, 3072
    s_nop 0
    buffer_load_dwordx4 v27, s[20:23], s58 offen lds
    s_add_u32 m0, s56, 65536
    s_nop 0
    buffer_load_dwordx4 v28, s[24:27], s59 offen offset:0 sc1 lds
    buffer_load_dwordx4 v28, s[24:27], s59 offen offset:1024 sc1 lds
    buffer_load_dwordx4 v28, s[24:27], s59 offen offset:2048 sc1 lds
    buffer_load_dwordx4 v28, s[24:27], s59 offen offset:3072 sc1 lds
    s_add_u32 s60, s60, 8192
    s_add_u32 s57, s57, 8192
    s_and_b32 s57, s57, 163839
    s_add_u32 s56, s56, 16384
    s_and_b32 s56, s56, 0xffff
    s_setpc_b64 s[66:67]
    .p2align 12
PG11:
    s_setpc_b64 s[72:73]
    s_nop 0
PG11_go:
A_light:
    s_barrier
    v_lshrrev_b32 v108, 5, v251
    v_and_b32 v109, 31, v251
    v_and_b32 v111, 1, v251
    v_lshlrev_b32 v111, 4, v111
    v_and_b32 v113, 2, v251
    v_lshl_add_u32 v111, v113, 2, v111
    v_lshl_add_u32 v113, v108, 3, v110
    v_bfe_u32 v114, v109, 1, 3
    v_xor_b32 v114, v114, v108
    v_lshlrev_b32 v114, 4, v114
    v_lshl_add_u32 v114, v109, 7, v114
    v_add_u32 v240, s46, v114
    v_xor_b32 v241, 32, v240
    v_xor_b32 v242, 64, v240
    v_xor_b32 v243, 96, v240
    v_and_b32 v114, 2, v110
    v_or_b32 v114, v114, v108
    v_xor_b32 v114, v114, v112
    s_lshl_b32 s47, s7, 1
    v_xor_b32 v114, s47, v114
    v_lshl_add_u32 v114, v114, 5, v111
    v_lshl_add_u32 v114, v113, 7, v114
    v_add_u32 v250, 131072, v114
    v_and_b32 v115, 0x13, v109
    v_and_b32 v116, 4, v109
    v_lshl_add_u32 v115, v116, 1, v115
    v_and_b32 v116, 8, v109
    v_lshrrev_b32 v116, 1, v116
    v_add_u32 v115, v115, v116
    s_lshl_b32 s47, s7, 12
    s_add_u32 s46, s46, s47
    v_bfe_u32 v114, v115, 1, 3
    v_xor_b32 v114, v114, v108
    v_lshlrev_b32 v114, 4, v114
    v_lshl_add_u32 v114, v115, 7, v114
    v_add_u32 v232, s46, v114
    v_xor_b32 v233, 32, v232
    v_xor_b32 v234, 64, v232
    v_xor_b32 v235, 96, v232
    v_lshl_add_u32 v114, v112, 5, v111
    s_cmp_eq_u32 s5, 14
    s_cbranch_scc1 A_light_kw
    v_and_b32 v114, 2, v251
    v_add_u32 v114, v114, v112
    v_and_b32 v115, 1, v251
    v_lshl_add_u32 v114, v114, 1, v115
    v_lshlrev_b32 v114, 3, v114
A_light_kw:
    v_lshl_add_u32 v114, v113, 6, v114
    v_add_u32 v236, 65536, v114
    v_lshlrev_b32 v238, 4, v108
    v_add_u32 v238, 156672, v238
    v_mov_b32 v64, 0
    v_mov_b32 v65, 0
    v_mov_b32 v66, 0
    v_mov_b32 v67, 0
    v_mov_b32 v68, 0
    v_mov_b32 v69, 0
    v_mov_b32 v70, 0
    v_mov_b32 v71, 0
    v_mov_b32 v72, 0
    v_mov_b32 v73, 0
    v_mov_b32 v74, 0
    v_mov_b32 v75, 0
    v_mov_b32 v76, 0
    v_mov_b32 v77, 0
    v_mov_b32 v78, 0
    v_mov_b32 v79, 0
    v_mov_b32 v80, 0
    v_mov_b32 v81, 0
    v_mov_b32 v82, 0
    v_mov_b32 v83, 0
    v_mov_b32 v84, 0
    v_mov_b32 v85, 0
    v_mov_b32 v86, 0
    v_mov_b32 v87, 0
    v_mov_b32 v88, 0
    v_mov_b32 v89, 0
    v_mov_b32 v90, 0
    v_mov_b32 v91, 0
    v_mov_b32 v92, 0
    v_mov_b32 v93, 0
    v_mov_b32 v94, 0
    v_mov_b32 v95, 0
    v_mov_b32 v96, 0
    v_mov_b32 v97, 0
    v_mov_b32 v98, 0
    v_mov_b32 v99, 0
    v_mov_b32 v100, 0
    v_mov_b32 v101, 0
    v_mov_b32 v102, 0
    v_mov_b32 v103, 0
    v_mov_b32 v104, 0
    v_mov_b32 v105, 0
    v_mov_b32 v106, 0
    v_mov_b32 v107, 0
    v_mov_b32 v108, 0
    v_mov_b32 v109, 0
    v_mov_b32 v110, 0
    v_mov_b32 v111, 0
    v_mov_b32 v112, 0
    v_mov_b32 v113, 0
    v_mov_b32 v114, 0
    v_mov_b32 v115, 0
    v_mov_b32 v116, 0
    v_mov_b32 v117, 0
    v_mov_b32 v118, 0
    v_mov_b32 v119, 0
    v_mov_b32 v120, 0
    v_mov_b32 v121, 0
    v_mov_b32 v122, 0
    v_mov_b32 v123, 0
    v_mov_b32 v124, 0
    v_mov_b32 v125, 0
    v_mov_b32 v126, 0
    v_mov_b32 v127, 0
WARM_L:
    s_cmp_lg_u32 s3, 0
    s_cbranch_scc1 WARM_L_1
    s_call_b64 s[72:73], PG11
    s_call_b64 s[72:73], PGA_att
    s_call_b64 s[72:73], PG8
    s_branch WARM_L_done
    s_nop 0
    s_nop 0
    s_nop 0
    s_nop 0
    s_nop 0
WARM_L_1:
    s_cmp_lg_u32 s3, 1
    s_cbranch_scc1 WARM_L_2
    s_call_b64 s[72:73], PG12
    s_call_b64 s[72:73], PG5
    s_call_b64 s[72:73], PG9
    s_branch WARM_L_done
WARM_L_2:
    s_cmp_lg_u32 s3, 2
    s_cbranch_scc1 WARM_L_3
    s_call_b64 s[72:73], PG13
    s_call_b64 s[72:73], PG6
    s_call_b64 s[72:73], PG10
    s_branch WARM_L_done
WARM_L_3:
    s_call_b64 s[72:73], PGA_light_v
    s_call_b64 s[72:73], PG7
WARM_L_done:
    s_waitcnt lgkmcnt(0)
    s_barrier
    s_cmp_eq_u32 s5, 15
    s_cbranch_scc1 A_light_v
    ds_read_b64_tr_b16 v[172:173], v250 offset:0
    ds_read_b64_tr_b16 v[174:175], v250 offset:512
    ds_read_b128 v[160:163], v240 offset:0
    ds_read_b128 v[164:167], v240 offset:4096
    ds_read_b128 v[168:171], v232 offset:0
    ds_read_b64_tr_b16 v[176:177], v236 offset:0
    ds_read_b64_tr_b16 v[178:179], v236 offset:256
    ds_read_b128 v[180:183], v238 offset:0
    s_mov_b32 s50, 4
A_lpk:
    s_waitcnt lgkmcnt(5)
    v_mfma_f32_32x32x16_bf16 v[64:79], v[172:175], v[160:163], v[64:79]
    s_waitcnt lgkmcnt(0)
    ds_read_b64_tr_b16 v[196:197], v250 offset:2048
    ds_read_b64_tr_b16 v[198:199], v250 offset:2560
    ds_read_b128 v[184:187], v241 offset:0
    v_mfma_f32_32x32x16_bf16 v[80:95], v[172:175], v[164:167], v[80:95]
    ds_read_b128 v[188:191], v241 offset:4096
    ds_read_b128 v[192:195], v233 offset:0
    ds_read_b64_tr_b16 v[200:201], v236 offset:1024
    v_mfma_f32_32x32x16_bf16 v[96:111], v[176:179], v[168:171], v[96:111]
    ds_read_b64_tr_b16 v[202:203], v236 offset:1280
    ds_read_b128 v[204:207], v238 offset:32
    v_mfma_f32_32x32x16_bf16 v[112:127], v[180:183], v[168:171], v[112:127]
    s_waitcnt lgkmcnt(5)
    v_mfma_f32_32x32x16_bf16 v[64:79], v[196:199], v[184:187], v[64:79]
    s_waitcnt lgkmcnt(0)
    ds_read_b64_tr_b16 v[172:173], v250 offset:4096
    ds_read_b64_tr_b16 v[174:175], v250 offset:4608
    ds_read_b128 v[160:163], v242 offset:0
    v_mfma_f32_32x32x16_bf16 v[80:95], v[196:199], v[188:191], v[80:95]
    ds_read_b128 v[164:167], v242 offset:4096
    ds_read_b128 v[168:171], v234 offset:0
    ds_read_b64_tr_b16 v[176:177], v236 offset:2048
    v_mfma_f32_32x32x16_bf16 v[96:111], v[200:203], v[192:195], v[96:111]
    ds_read_b64_tr_b16 v[178:179], v236 offset:2304
    ds_read_b128 v[180:183], v238 offset:64
    v_mfma_f32_32x32x16_bf16 v[112:127], v[204:207], v[192:195], v[112:127]
    s_waitcnt lgkmcnt(5)
    v_mfma_f32_32x32x16_bf16 v[64:79], v[172:175], v[160:163], v[64:79]
    s_waitcnt lgkmcnt(0)
    ds_read_b64_tr_b16 v[196:197], v250 offset:6144
    ds_read_b64_tr_b16 v[198:199], v250 offset:6656
    ds_read_b128 v[184:187], v243 offset:0
    v_mfma_f32_32x32x16_bf16 v[80:95], v[172:175], v[164:167], v[80:95]
    ds_read_b128 v[188:191], v243 offset:4096
    ds_read_b128 v[192:195], v235 offset:0
    ds_read_b64_tr_b16 v[200:201], v236 offset:3072
    v_mfma_f32_32x32x16_bf16 v[96:111], v[176:179], v[168:171], v[96:111]
    ds_read_b64_tr_b16 v[202:203], v236 offset:3328
    ds_read_b128 v[204:207], v238 offset:96
    s_add_u32 s51, s51, 1
    s_cmp_eq_u32 s51, 3
    s_cselect_b32 s52, s54, s53
    s_cselect_b32 s51, 0, s51
    v_mfma_f32_32x32x16_bf16 v[112:127], v[180:183], v[168:171], v[112:127]
    s_waitcnt lgkmcnt(5)
    v_mfma_f32_32x32x16_bf16 v[64:79], v[196:199], v[184:187], v[64:79]
    s_waitcnt lgkmcnt(0)
    s_barrier
    v_add_u32 v250, s52, v250
    ds_read_b64_tr_b16 v[172:173], v250 offset:0
    ds_read_b64_tr_b16 v[174:175], v250 offset:512
    ds_read_b128 v[160:163], v240 offset:16384
    v_mfma_f32_32x32x16_bf16 v[80:95], v[196:199], v[188:191], v[80:95]
    ds_read_b128 v[164:167], v240 offset:20480
    ds_read_b128 v[168:171], v232 offset:16384
    ds_read_b64_tr_b16 v[176:177], v236 offset:16384
    v_mfma_f32_32x32x16_bf16 v[96:111], v[200:203], v[192:195], v[96:111]
    ds_read_b64_tr_b16 v[178:179], v236 offset:16640
    ds_read_b128 v[180:183], v238 offset:128
    v_mfma_f32_32x32x16_bf16 v[112:127], v[204:207], v[192:195], v[112:127]
    s_waitcnt lgkmcnt(5)
    v_mfma_f32_32x32x16_bf16 v[64:79], v[172:175], v[160:163], v[64:79]
    s_waitcnt lgkmcnt(0)
    ds_read_b64_tr_b16 v[196:197], v250 offset:2048
    ds_read_b64_tr_b16 v[198:199], v250 offset:2560
    ds_read_b128 v[184:187], v241 offset:16384
    v_mfma_f32_32x32x16_bf16 v[80:95], v[172:175], v[164:167], v[80:95]
    ds_read_b128 v[188:191], v241 offset:20480
    ds_read_b128 v[192:195], v233 offset:16384
    ds_read_b64_tr_b16 v[200:201], v236 offset:17408
    v_mfma_f32_32x32x16_bf16 v[96:111], v[176:179], v[168:171], v[96:111]
    ds_read_b64_tr_b16 v[202:203], v236 offset:17664
    ds_read_b128 v[204:207], v238 offset:160
    v_mfma_f32_32x32x16_bf16 v[112:127], v[180:183], v[168:171], v[112:127]
    s_waitcnt lgkmcnt(5)
    v_mfma_f32_32x32x16_bf16 v[64:79], v[196:199], v[184:187], v[64:79]
    s_waitcnt lgkmcnt(0)
    ds_read_b64_tr_b16 v[172:173], v250 offset:4096
    ds_read_b64_tr_b16 v[174:175], v250 offset:4608
    ds_read_b128 v[160:163], v242 offset:16384
    v_mfma_f32_32x32x16_bf16 v[80:95], v[196:199], v[188:191], v[80:95]
    ds_read_b128 v[164:167], v242 offset:20480
    ds_read_b128 v[168:171], v234 offset:16384
    ds_read_b64_tr_b16 v[176:177], v236 offset:18432
    v_mfma_f32_32x32x16_bf16 v[96:111], v[200:203], v[192:195], v[96:111]
    ds_read_b64_tr_b16 v[178:179], v236 offset:18688
    ds_read_b128 v[180:183], v238 offset:192
    v_mfma_f32_32x32x16_bf16 v[112:127], v[204:207], v[192:195], v[112:127]
    s_waitcnt lgkmcnt(5)
    v_mfma_f32_32x32x16_bf16 v[64:79], v[172:175], v[160:163], v[64:79]
    s_waitcnt lgkmcnt(0)
    ds_read_b64_tr_b16 v[196:197], v250 offset:6144
    ds_read_b64_tr_b16 v[198:199], v250 offset:6656
    ds_read_b128 v[184:187], v243 offset:16384
    v_mfma_f32_32x32x16_bf16 v[80:95], v[172:175], v[164:167], v[80:95]
    ds_read_b128 v[188:191], v243 offset:20480
    ds_read_b128 v[192:195], v235 offset:16384
    ds_read_b64_tr_b16 v[200:201], v236 offset:19456
    v_mfma_f32_32x32x16_bf16 v[96:111], v[176:179], v[168:171], v[96:111]
    ds_read_b64_tr_b16 v[202:203], v236 offset:19712
    ds_read_b128 v[204:207], v238 offset:224
    s_add_u32 s51, s51, 1
    s_cmp_eq_u32 s51, 3
    s_cselect_b32 s52, s54, s53
    s_cselect_b32 s51, 0, s51
    v_mfma_f32_32x32x16_bf16 v[112:127], v[180:183], v[168:171], v[112:127]
    s_waitcnt lgkmcnt(5)
    v_mfma_f32_32x32x16_bf16 v[64:79], v[196:199], v[184:187], v[64:79]
    s_waitcnt lgkmcnt(0)
    s_barrier
    v_add_u32 v250, s52, v250
    ds_read_b64_tr_b16 v[172:173], v250 offset:0
    ds_read_b64_tr_b16 v[174:175], v250 offset:512
    ds_read_b128 v[160:163], v240 offset:32768
    v_mfma_f32_32x32x16_bf16 v[80:95], v[196:199], v[188:191], v[80:95]
    ds_read_b128 v[164:167], v240 offset:36864
    ds_read_b128 v[168:171], v232 offset:32768
    ds_read_b64_tr_b16 v[176:177], v236 offset:32768
    v_mfma_f32_32x32x16_bf16 v[96:111], v[200:203], v[192:195], v[96:111]
    ds_read_b64_tr_b16 v[178:179], v236 offset:33024
    ds_read_b128 v[180:183], v238 offset:256
    v_mfma_f32_32x32x16_bf16 v[112:127], v[204:207], v[192:195], v[112:127]
    s_waitcnt lgkmcnt(5)
    v_mfma_f32_32x32x16_bf16 v[64:79], v[172:175], v[160:163], v[64:79]
    s_waitcnt lgkmcnt(0)
    ds_read_b64_tr_b16 v[196:197], v250 offset:2048
    ds_read_b64_tr_b16 v[198:199], v250 offset:2560
    ds_read_b128 v[184:187], v241 offset:32768
    v_mfma_f32_32x32x16_bf16 v[80:95], v[172:175], v[164:167], v[80:95]
    ds_read_b128 v[188:191], v241 offset:36864
    ds_read_b128 v[192:195], v233 offset:32768
    ds_read_b64_tr_b16 v[200:201], v236 offset:33792
    v_mfma_f32_32x32x16_bf16 v[96:111], v[176:179], v[168:171], v[96:111]
    ds_read_b64_tr_b16 v[202:203], v236 offset:34048
    ds_read_b128 v[204:207], v238 offset:288
    v_mfma_f32_32x32x16_bf16 v[112:127], v[180:183], v[168:171], v[112:127]
    s_waitcnt lgkmcnt(5)
    v_mfma_f32_32x32x16_bf16 v[64:79], v[196:199], v[184:187], v[64:79]
    s_waitcnt lgkmcnt(0)
    ds_read_b64_tr_b16 v[172:173], v250 offset:4096
    ds_read_b64_tr_b16 v[174:175], v250 offset:4608
    ds_read_b128 v[160:163], v242 offset:32768
    v_mfma_f32_32x32x16_bf16 v[80:95], v[196:199], v[188:191], v[80:95]
    ds_read_b128 v[164:167], v242 offset:36864
    ds_read_b128 v[168:171], v234 offset:32768
    ds_read_b64_tr_b16 v[176:177], v236 offset:34816
    v_mfma_f32_32x32x16_bf16 v[96:111], v[200:203], v[192:195], v[96:111]
    ds_read_b64_tr_b16 v[178:179], v236 offset:35072
    ds_read_b128 v[180:183], v238 offset:320
    v_mfma_f32_32x32x16_bf16 v[112:127], v[204:207], v[192:195], v[112:127]
    s_waitcnt lgkmcnt(5)
    v_mfma_f32_32x32x16_bf16 v[64:79], v[172:175], v[160:163], v[64:79]
    s_waitcnt lgkmcnt(0)
    ds_read_b64_tr_b16 v[196:197], v250 offset:6144
    ds_read_b64_tr_b16 v[198:199], v250 offset:6656
    ds_read_b128 v[184:187], v243 offset:32768
    v_mfma_f32_32x32x16_bf16 v[80:95], v[172:175], v[164:167], v[80:95]
    ds_read_b128 v[188:191], v243 offset:36864
    ds_read_b128 v[192:195], v235 offset:32768
    ds_read_b64_tr_b16 v[200:201], v236 offset:35840
    v_mfma_f32_32x32x16_bf16 v[96:111], v[176:179], v[168:171], v[96:111]
    ds_read_b64_tr_b16 v[202:203], v236 offset:36096
    ds_read_b128 v[204:207], v238 offset:352
    s_add_u32 s51, s51, 1
    s_cmp_eq_u32 s51, 3
    s_cselect_b32 s52, s54, s53
    s_cselect_b32 s51, 0, s51
    v_mfma_f32_32x32x16_bf16 v[112:127], v[180:183], v[168:171], v[112:127]
    s_waitcnt lgkmcnt(5)
    v_mfma_f32_32x32x16_bf16 v[64:79], v[196:199], v[184:187], v[64:79]
    s_waitcnt lgkmcnt(0)
    s_barrier
    v_add_u32 v250, s52, v250
    ds_read_b64_tr_b16 v[172:173], v250 offset:0
    ds_read_b64_tr_b16 v[174:175], v250 offset:512
    ds_read_b128 v[160:163], v240 offset:49152
    v_mfma_f32_32x32x16_bf16 v[80:95], v[196:199], v[188:191], v[80:95]
    ds_read_b128 v[164:167], v240 offset:53248
    ds_read_b128 v[168:171], v232 offset:49152
    ds_read_b64_tr_b16 v[176:177], v236 offset:49152
    v_mfma_f32_32x32x16_bf16 v[96:111], v[200:203], v[192:195], v[96:111]
    ds_read_b64_tr_b16 v[178:179], v236 offset:49408
    ds_read_b128 v[180:183], v238 offset:384
    v_mfma_f32_32x32x16_bf16 v[112:127], v[204:207], v[192:195], v[112:127]
    s_waitcnt lgkmcnt(5)
    v_mfma_f32_32x32x16_bf16 v[64:79], v[172:175], v[160:163], v[64:79]
    s_waitcnt lgkmcnt(0)
    ds_read_b64_tr_b16 v[196:197], v250 offset:2048
    ds_read_b64_tr_b16 v[198:199], v250 offset:2560
    ds_read_b128 v[184:187], v241 offset:49152
    v_mfma_f32_32x32x16_bf16 v[80:95], v[172:175], v[164:167], v[80:95]
    ds_read_b128 v[188:191], v241 offset:53248
    ds_read_b128 v[192:195], v233 offset:49152
    ds_read_b64_tr_b16 v[200:201], v236 offset:50176
    v_mfma_f32_32x32x16_bf16 v[96:111], v[176:179], v[168:171], v[96:111]
    ds_read_b64_tr_b16 v[202:203], v236 offset:50432
    ds_read_b128 v[204:207], v238 offset:416
    v_mfma_f32_32x32x16_bf16 v[112:127], v[180:183], v[168:171], v[112:127]
    s_waitcnt lgkmcnt(5)
    v_mfma_f32_32x32x16_bf16 v[64:79], v[196:199], v[184:187], v[64:79]
    s_waitcnt lgkmcnt(0)
    ds_read_b64_tr_b16 v[172:173], v250 offset:4096
    ds_read_b64_tr_b16 v[174:175], v250 offset:4608
    ds_read_b128 v[160:163], v242 offset:49152
    v_mfma_f32_32x32x16_bf16 v[80:95], v[196:199], v[188:191], v[80:95]
    ds_read_b128 v[164:167], v242 offset:53248
    ds_read_b128 v[168:171], v234 offset:49152
    ds_read_b64_tr_b16 v[176:177], v236 offset:51200
    v_mfma_f32_32x32x16_bf16 v[96:111], v[200:203], v[192:195], v[96:111]
    ds_read_b64_tr_b16 v[178:179], v236 offset:51456
    ds_read_b128 v[180:183], v238 offset:448
    v_mfma_f32_32x32x16_bf16 v[112:127], v[204:207], v[192:195], v[112:127]
    s_waitcnt lgkmcnt(5)
    v_mfma_f32_32x32x16_bf16 v[64:79], v[172:175], v[160:163], v[64:79]
    s_waitcnt lgkmcnt(0)
    ds_read_b64_tr_b16 v[196:197], v250 offset:6144
    ds_read_b64_tr_b16 v[198:199], v250 offset:6656
    ds_read_b128 v[184:187], v243 offset:49152
    v_mfma_f32_32x32x16_bf16 v[80:95], v[172:175], v[164:167], v[80:95]
    ds_read_b128 v[188:191], v243 offset:53248
    ds_read_b128 v[192:195], v235 offset:49152
    ds_read_b64_tr_b16 v[200:201], v236 offset:52224
    v_mfma_f32_32x32x16_bf16 v[96:111], v[176:179], v[168:171], v[96:111]
    ds_read_b64_tr_b16 v[202:203], v236 offset:52480
    ds_read_b128 v[204:207], v238 offset:480
    s_add_u32 s51, s51, 1
    s_cmp_eq_u32 s51, 3
    s_cselect_b32 s52, s54, s53
    s_cselect_b32 s51, 0, s51
    v_mfma_f32_32x32x16_bf16 v[112:127], v[180:183], v[168:171], v[112:127]
    s_waitcnt lgkmcnt(5)
    v_mfma_f32_32x32x16_bf16 v[64:79], v[196:199], v[184:187], v[64:79]
    s_waitcnt lgkmcnt(0)
    s_barrier
    v_add_u32 v250, s52, v250
    v_add_u32 v238, 512, v238
    ds_read_b64_tr_b16 v[172:173], v250 offset:0
    ds_read_b64_tr_b16 v[174:175], v250 offset:512
    ds_read_b128 v[160:163], v240 offset:0
    v_mfma_f32_32x32x16_bf16 v[80:95], v[196:199], v[188:191], v[80:95]
    ds_read_b128 v[164:167], v240 offset:4096
    ds_read_b128 v[168:171], v232 offset:0
    ds_read_b64_tr_b16 v[176:177], v236 offset:0
    v_mfma_f32_32x32x16_bf16 v[96:111], v[200:203], v[192:195], v[96:111]
    ds_read_b64_tr_b16 v[178:179], v236 offset:256
    ds_read_b128 v[180:183], v238 offset:0
    v_mfma_f32_32x32x16_bf16 v[112:127], v[204:207], v[192:195], v[112:127]
    s_sub_u32 s50, s50, 1
    s_cmp_lg_u32 s50, 0
    s_cbranch_scc1 A_lpk
    s_waitcnt lgkmcnt(0)
    s_nop 15
    s_lshl_b32 s46, s4, 2
    s_lshl_b32 s47, s6, 1
    s_add_u32 s46, s46, s47
    s_add_u32 s46, s46, s7
    s_lshl_b32 s47, s46, 12
    s_add_u32 s47, s47, 4194304
    v_lshlrev_b32 v252, 4, v251
    v_mul_f32 v96, 0x3e8293ee, v96
    v_mul_f32 v97, 0x3e8293ee, v97
    v_mul_f32 v98, 0x3e8293ee, v98
    v_mul_f32 v99, 0x3e8293ee, v99
    v_mul_f32 v100, 0x3e8293ee, v100
    v_mul_f32 v101, 0x3e8293ee, v101
    v_mul_f32 v102, 0x3e8293ee, v102
    v_mul_f32 v103, 0x3e8293ee, v103
    v_mul_f32 v104, 0x3e8293ee, v104
    v_mul_f32 v105, 0x3e8293ee, v105
    v_mul_f32 v106, 0x3e8293ee, v106
    v_mul_f32 v107, 0x3e8293ee, v107
    v_mul_f32 v108, 0x3e8293ee, v108
    v_mul_f32 v109, 0x3e8293ee, v109
    v_mul_f32 v110, 0x3e8293ee, v110
    v_mul_f32 v111, 0x3e8293ee, v111
    v_cvt_pk_bf16_f32 v96, v96, v97
    v_cvt_pk_bf16_f32 v97, v98, v99
    v_cvt_pk_bf16_f32 v98, v100, v101
    v_cvt_pk_bf16_f32 v99, v102, v103
    v_cvt_pk_bf16_f32 v100, v104, v105
    v_cvt_pk_bf16_f32 v101, v106, v107
    v_cvt_pk_bf16_f32 v102, v108, v109
    v_cvt_pk_bf16_f32 v103, v110, v111
    buffer_store_dwordx4 v[96:99], v252, s[24:27], s47 offen offset:0 sc1
    buffer_store_dwordx4 v[100:103], v252, s[24:27], s47 offen offset:1024 sc1
    v_mul_f32 v112, 0xbfb8aa3b, v112
    v_exp_f32 v112, v112
    v_and_b32 v253, 0x13, v251
    v_add_f32 v112, 1.0, v112
    v_rcp_f32 v112, v112
    v_and_b32 v254, 4, v251
    v_lshl_add_u32 v253, v254, 1, v253
    v_and_b32 v254, 8, v251
    v_lshrrev_b32 v254, 1, v254
    v_add_lshl_u32 v253, v253, v254, 2
    s_lshl_b32 s46, s46, 7
    s_add_u32 s46, s46, 4489216
    s_mov_b32 exec_hi, 0
    buffer_store_dword v112, v253, s[24:27], s46 offen sc1
    s_mov_b32 exec_hi, -1
    s_waitcnt vmcnt(0)
    s_barrier
    v_cvt_pk_bf16_f32 v192, v64, v65
    v_cvt_pk_bf16_f32 v193, v66, v67
    v_cvt_pk_bf16_f32 v194, v68, v69
    v_cvt_pk_bf16_f32 v195, v70, v71
    v_cvt_pk_bf16_f32 v196, v72, v73
    v_cvt_pk_bf16_f32 v197, v74, v75
    v_cvt_pk_bf16_f32 v198, v76, v77
    v_cvt_pk_bf16_f32 v199, v78, v79
    v_cvt_pk_bf16_f32 v200, v80, v81
    v_cvt_pk_bf16_f32 v201, v82, v83
    v_cvt_pk_bf16_f32 v202, v84, v85
    v_cvt_pk_bf16_f32 v203, v86, v87
    v_cvt_pk_bf16_f32 v204, v88, v89
    v_cvt_pk_bf16_f32 v205, v90, v91
    v_cvt_pk_bf16_f32 v206, v92, v93
    v_cvt_pk_bf16_f32 v207, v94, v95
    s_barrier
    s_barrier
    s_branch A_att
PGA_light_v:
    s_setpc_b64 s[72:73]
    s_nop 0
A_light_v:
    ds_read_b64_tr_b16 v[172:173], v250 offset:0
    ds_read_b64_tr_b16 v[174:175], v250 offset:512
    ds_read_b128 v[160:163], v240 offset:0
    ds_read_b128 v[164:167], v240 offset:4096
    ds_read_b128 v[168:171], v232 offset:0
    ds_read_b64_tr_b16 v[176:177], v236 offset:0
    ds_read_b64_tr_b16 v[178:179], v236 offset:256
    s_mov_b32 s50, 4
A_lpv:
    s_waitcnt lgkmcnt(4)
    v_mfma_f32_32x32x16_bf16 v[64:79], v[172:175], v[160:163], v[64:79]
    s_waitcnt lgkmcnt(0)
    ds_read_b64_tr_b16 v[196:197], v250 offset:2048
    ds_read_b64_tr_b16 v[198:199], v250 offset:2560
    ds_read_b128 v[184:187], v241 offset:0
    v_mfma_f32_32x32x16_bf16 v[80:95], v[172:175], v[164:167], v[80:95]
    ds_read_b128 v[188:191], v241 offset:4096
    ds_read_b128 v[192:195], v233 offset:0
    ds_read_b64_tr_b16 v[200:201], v236 offset:1024
    v_mfma_f32_32x32x16_bf16 v[96:111], v[168:171], v[176:179], v[96:111]
    ds_read_b64_tr_b16 v[202:203], v236 offset:1280
    s_waitcnt lgkmcnt(4)
    v_mfma_f32_32x32x16_bf16 v[64:79], v[196:199], v[184:187], v[64:79]
    s_waitcnt lgkmcnt(0)
    ds_read_b64_tr_b16 v[172:173], v250 offset:4096
    ds_read_b64_tr_b16 v[174:175], v250 offset:4608
    ds_read_b128 v[160:163], v242 offset:0
    v_mfma_f32_32x32x16_bf16 v[80:95], v[196:199], v[188:191], v[80:95]
    ds_read_b128 v[164:167], v242 offset:4096
    ds_read_b128 v[168:171], v234 offset:0
    ds_read_b64_tr_b16 v[176:177], v236 offset:2048
    v_mfma_f32_32x32x16_bf16 v[96:111], v[192:195], v[200:203], v[96:111]
    ds_read_b64_tr_b16 v[178:179], v236 offset:2304
    s_waitcnt lgkmcnt(4)
    v_mfma_f32_32x32x16_bf16 v[64:79], v[172:175], v[160:163], v[64:79]
    s_waitcnt lgkmcnt(0)
    ds_read_b64_tr_b16 v[196:197], v250 offset:6144
    ds_read_b64_tr_b16 v[198:199], v250 offset:6656
    ds_read_b128 v[184:187], v243 offset:0
    v_mfma_f32_32x32x16_bf16 v[80:95], v[172:175], v[164:167], v[80:95]
    ds_read_b128 v[188:191], v243 offset:4096
    ds_read_b128 v[192:195], v235 offset:0
    ds_read_b64_tr_b16 v[200:201], v236 offset:3072
    v_mfma_f32_32x32x16_bf16 v[96:111], v[168:171], v[176:179], v[96:111]
    ds_read_b64_tr_b16 v[202:203], v236 offset:3328
    s_add_u32 s51, s51, 1
    s_cmp_eq_u32 s51, 3
    s_cselect_b32 s52, s54, s53
    s_cselect_b32 s51, 0, s51
    s_waitcnt lgkmcnt(4)
    v_mfma_f32_32x32x16_bf16 v[64:79], v[196:199], v[184:187], v[64:79]
    s_waitcnt lgkmcnt(0)
    s_barrier
    v_add_u32 v250, s52, v250
    ds_read_b64_tr_b16 v[172:173], v250 offset:0
    ds_read_b64_tr_b16 v[174:175], v250 offset:512
    ds_read_b128 v[160:163], v240 offset:16384
    v_mfma_f32_32x32x16_bf16 v[80:95], v[196:199], v[188:191], v[80:95]
    ds_read_b128 v[164:167], v240 offset:20480
    ds_read_b128 v[168:171], v232 offset:16384
    ds_read_b64_tr_b16 v[176:177], v236 offset:16384
    v_mfma_f32_32x32x16_bf16 v[96:111], v[192:195], v[200:203], v[96:111]
    ds_read_b64_tr_b16 v[178:179], v236 offset:16640
    s_waitcnt lgkmcnt(4)
    v_mfma_f32_32x32x16_bf16 v[64:79], v[172:175], v[160:163], v[64:79]
    s_waitcnt lgkmcnt(0)
    ds_read_b64_tr_b16 v[196:197], v250 offset:2048
    ds_read_b64_tr_b16 v[198:199], v250 offset:2560
    ds_read_b128 v[184:187], v241 offset:16384
    v_mfma_f32_32x32x16_bf16 v[80:95], v[172:175], v[164:167], v[80:95]
    ds_read_b128 v[188:191], v241 offset:20480
    ds_read_b128 v[192:195], v233 offset:16384
    ds_read_b64_tr_b16 v[200:201], v236 offset:17408
    v_mfma_f32_32x32x16_bf16 v[96:111], v[168:171], v[176:179], v[96:111]
    ds_read_b64_tr_b16 v[202:203], v236 offset:17664
    s_waitcnt lgkmcnt(4)
    v_mfma_f32_32x32x16_bf16 v[64:79], v[196:199], v[184:187], v[64:79]
    s_waitcnt lgkmcnt(0)
    ds_read_b64_tr_b16 v[172:173], v250 offset:4096
    ds_read_b64_tr_b16 v[174:175], v250 offset:4608
    ds_read_b128 v[160:163], v242 offset:16384
    v_mfma_f32_32x32x16_bf16 v[80:95], v[196:199], v[188:191], v[80:95]
    ds_read_b128 v[164:167], v242 offset:20480
    ds_read_b128 v[168:171], v234 offset:16384
    ds_read_b64_tr_b16 v[176:177], v236 offset:18432
    v_mfma_f32_32x32x16_bf16 v[96:111], v[192:195], v[200:203], v[96:111]
    ds_read_b64_tr_b16 v[178:179], v236 offset:18688
    s_waitcnt lgkmcnt(4)
    v_mfma_f32_32x32x16_bf16 v[64:79], v[172:175], v[160:163], v[64:79]
    s_waitcnt lgkmcnt(0)
    ds_read_b64_tr_b16 v[196:197], v250 offset:6144
    ds_read_b64_tr_b16 v[198:199], v250 offset:6656
    ds_read_b128 v[184:187], v243 offset:16384
    v_mfma_f32_32x32x16_bf16 v[80:95], v[172:175], v[164:167], v[80:95]
    ds_read_b128 v[188:191], v243 offset:20480
    ds_read_b128 v[192:195], v235 offset:16384
    ds_read_b64_tr_b16 v[200:201], v236 offset:19456
    v_mfma_f32_32x32x16_bf16 v[96:111], v[168:171], v[176:179], v[96:111]
    ds_read_b64_tr_b16 v[202:203], v236 offset:19712
    s_add_u32 s51, s51, 1
    s_cmp_eq_u32 s51, 3
    s_cselect_b32 s52, s54, s53
    s_cselect_b32 s51, 0, s51
    s_waitcnt lgkmcnt(4)
    v_mfma_f32_32x32x16_bf16 v[64:79], v[196:199], v[184:187], v[64:79]
    s_waitcnt lgkmcnt(0)
    s_barrier
    v_add_u32 v250, s52, v250
    ds_read_b64_tr_b16 v[172:173], v250 offset:0
    ds_read_b64_tr_b16 v[174:175], v250 offset:512
    ds_read_b128 v[160:163], v240 offset:32768
    v_mfma_f32_32x32x16_bf16 v[80:95], v[196:199], v[188:191], v[80:95]
    ds_read_b128 v[164:167], v240 offset:36864
    ds_read_b128 v[168:171], v232 offset:32768
    ds_read_b64_tr_b16 v[176:177], v236 offset:32768
    v_mfma_f32_32x32x16_bf16 v[96:111], v[192:195], v[200:203], v[96:111]
    ds_read_b64_tr_b16 v[178:179], v236 offset:33024
    s_waitcnt lgkmcnt(4)
    v_mfma_f32_32x32x16_bf16 v[64:79], v[172:175], v[160:163], v[64:79]
    s_waitcnt lgkmcnt(0)
    ds_read_b64_tr_b16 v[196:197], v250 offset:2048
    ds_read_b64_tr_b16 v[198:199], v250 offset:2560
    ds_read_b128 v[184:187], v241 offset:32768
    v_mfma_f32_32x32x16_bf16 v[80:95], v[172:175], v[164:167], v[80:95]
    ds_read_b128 v[188:191], v241 offset:36864
    ds_read_b128 v[192:195], v233 offset:32768
    ds_read_b64_tr_b16 v[200:201], v236 offset:33792
    v_mfma_f32_32x32x16_bf16 v[96:111], v[168:171], v[176:179], v[96:111]
    ds_read_b64_tr_b16 v[202:203], v236 offset:34048
    s_waitcnt lgkmcnt(4)
    v_mfma_f32_32x32x16_bf16 v[64:79], v[196:199], v[184:187], v[64:79]
    s_waitcnt lgkmcnt(0)
    ds_read_b64_tr_b16 v[172:173], v250 offset:4096
    ds_read_b64_tr_b16 v[174:175], v250 offset:4608
    ds_read_b128 v[160:163], v242 offset:32768
    v_mfma_f32_32x32x16_bf16 v[80:95], v[196:199], v[188:191], v[80:95]
    ds_read_b128 v[164:167], v242 offset:36864
    ds_read_b128 v[168:171], v234 offset:32768
    ds_read_b64_tr_b16 v[176:177], v236 offset:34816
    v_mfma_f32_32x32x16_bf16 v[96:111], v[192:195], v[200:203], v[96:111]
    ds_read_b64_tr_b16 v[178:179], v236 offset:35072
    s_waitcnt lgkmcnt(4)
    v_mfma_f32_32x32x16_bf16 v[64:79], v[172:175], v[160:163], v[64:79]
    s_waitcnt lgkmcnt(0)
    ds_read_b64_tr_b16 v[196:197], v250 offset:6144
    ds_read_b64_tr_b16 v[198:199], v250 offset:6656
    ds_read_b128 v[184:187], v243 offset:32768
    v_mfma_f32_32x32x16_bf16 v[80:95], v[172:175], v[164:167], v[80:95]
    ds_read_b128 v[188:191], v243 offset:36864
    ds_read_b128 v[192:195], v235 offset:32768
    ds_read_b64_tr_b16 v[200:201], v236 offset:35840
    v_mfma_f32_32x32x16_bf16 v[96:111], v[168:171], v[176:179], v[96:111]
    ds_read_b64_tr_b16 v[202:203], v236 offset:36096
    s_add_u32 s51, s51, 1
    s_cmp_eq_u32 s51, 3
    s_cselect_b32 s52, s54, s53
    s_cselect_b32 s51, 0, s51
    s_waitcnt lgkmcnt(4)
    v_mfma_f32_32x32x16_bf16 v[64:79], v[196:199], v[184:187], v[64:79]
    s_branch PG12_go
    .p2align 12
PG12:
    s_setpc_b64 s[72:73]
    s_nop 0
PG12_go:
    s_waitcnt lgkmcnt(0)
    s_barrier
    v_add_u32 v250, s52, v250
    ds_read_b64_tr_b16 v[172:173], v250 offset:0
    ds_read_b64_tr_b16 v[174:175], v250 offset:512
    ds_read_b128 v[160:163], v240 offset:49152
    v_mfma_f32_32x32x16_bf16 v[80:95], v[196:199], v[188:191], v[80:95]
    ds_read_b128 v[164:167], v240 offset:53248
    ds_read_b128 v[168:171], v232 offset:49152
    ds_read_b64_tr_b16 v[176:177], v236 offset:49152
    v_mfma_f32_32x32x16_bf16 v[96:111], v[192:195], v[200:203], v[96:111]
    ds_read_b64_tr_b16 v[178:179], v236 offset:49408
    s_waitcnt lgkmcnt(4)
    v_mfma_f32_32x32x16_bf16 v[64:79], v[172:175], v[160:163], v[64:79]
    s_waitcnt lgkmcnt(0)
    ds_read_b64_tr_b16 v[196:197], v250 offset:2048
    ds_read_b64_tr_b16 v[198:199], v250 offset:2560
    ds_read_b128 v[184:187], v241 offset:49152
    v_mfma_f32_32x32x16_bf16 v[80:95], v[172:175], v[164:167], v[80:95]
    ds_read_b128 v[188:191], v241 offset:53248
    ds_read_b128 v[192:195], v233 offset:49152
    ds_read_b64_tr_b16 v[200:201], v236 offset:50176
    v_mfma_f32_32x32x16_bf16 v[96:111], v[168:171], v[176:179], v[96:111]
    ds_read_b64_tr_b16 v[202:203], v236 offset:50432
    s_waitcnt lgkmcnt(4)
    v_mfma_f32_32x32x16_bf16 v[64:79], v[196:199], v[184:187], v[64:79]
    s_waitcnt lgkmcnt(0)
    ds_read_b64_tr_b16 v[172:173], v250 offset:4096
    ds_read_b64_tr_b16 v[174:175], v250 offset:4608
    ds_read_b128 v[160:163], v242 offset:49152
    v_mfma_f32_32x32x16_bf16 v[80:95], v[196:199], v[188:191], v[80:95]
    ds_read_b128 v[164:167], v242 offset:53248
    ds_read_b128 v[168:171], v234 offset:49152
    ds_read_b64_tr_b16 v[176:177], v236 offset:51200
    v_mfma_f32_32x32x16_bf16 v[96:111], v[192:195], v[200:203], v[96:111]
    ds_read_b64_tr_b16 v[178:179], v236 offset:51456
    s_waitcnt lgkmcnt(4)
    v_mfma_f32_32x32x16_bf16 v[64:79], v[172:175], v[160:163], v[64:79]
    s_waitcnt lgkmcnt(0)
    ds_read_b64_tr_b16 v[196:197], v250 offset:6144
    ds_read_b64_tr_b16 v[198:199], v250 offset:6656
    ds_read_b128 v[184:187], v243 offset:49152
    v_mfma_f32_32x32x16_bf16 v[80:95], v[172:175], v[164:167], v[80:95]
    ds_read_b128 v[188:191], v243 offset:53248
    ds_read_b128 v[192:195], v235 offset:49152
    ds_read_b64_tr_b16 v[200:201], v236 offset:52224
    v_mfma_f32_32x32x16_bf16 v[96:111], v[168:171], v[176:179], v[96:111]
    ds_read_b64_tr_b16 v[202:203], v236 offset:52480
    s_add_u32 s51, s51, 1
    s_cmp_eq_u32 s51, 3
    s_cselect_b32 s52, s54, s53
    s_cselect_b32 s51, 0, s51
    s_waitcnt lgkmcnt(4)
    v_mfma_f32_32x32x16_bf16 v[64:79], v[196:199], v[184:187], v[64:79]
    s_waitcnt lgkmcnt(0)
    s_barrier
    v_add_u32 v250, s52, v250
    ds_read_b64_tr_b16 v[172:173], v250 offset:0
    ds_read_b64_tr_b16 v[174:175], v250 offset:512
    ds_read_b128 v[160:163], v240 offset:0
    v_mfma_f32_32x32x16_bf16 v[80:95], v[196:199], v[188:191], v[80:95]
    ds_read_b128 v[164:167], v240 offset:4096
    ds_read_b128 v[168:171], v232 offset:0
    ds_read_b64_tr_b16 v[176:177], v236 offset:0
    v_mfma_f32_32x32x16_bf16 v[96:111], v[192:195], v[200:203], v[96:111]
    ds_read_b64_tr_b16 v[178:179], v236 offset:256
    s_sub_u32 s50, s50, 1
    s_cmp_lg_u32 s50, 0
    s_cbranch_scc1 A_lpv
    s_waitcnt lgkmcnt(0)
    s_nop 15
    s_lshl_b32 s46, s4, 2
    s_lshl_b32 s47, s6, 1
    s_add_u32 s46, s46, s47
    s_add_u32 s46, s46, s7
    s_lshl_b32 s47, s46, 12
    s_add_u32 s47, s47, 4200448
    v_lshlrev_b32 v252, 4, v251
    v_cvt_pk_bf16_f32 v96, v96, v97
    v_cvt_pk_bf16_f32 v97, v98, v99
    v_cvt_pk_bf16_f32 v98, v100, v101
    v_cvt_pk_bf16_f32 v99, v102, v103
    v_cvt_pk_bf16_f32 v100, v104, v105
    v_cvt_pk_bf16_f32 v101, v106, v107
    v_cvt_pk_bf16_f32 v102, v108, v109
    v_cvt_pk_bf16_f32 v103, v110, v111
    buffer_store_dwordx4 v[96:99], v252, s[24:27], s47 offen offset:0 sc1
    buffer_store_dwordx4 v[100:103], v252, s[24:27], s47 offen offset:1024 sc1
    s_waitcnt vmcnt(0)
    s_barrier
    v_cvt_pk_bf16_f32 v192, v64, v65
    v_cvt_pk_bf16_f32 v193, v66, v67
    v_cvt_pk_bf16_f32 v194, v68, v69
    v_cvt_pk_bf16_f32 v195, v70, v71
    v_cvt_pk_bf16_f32 v196, v72, v73
    v_cvt_pk_bf16_f32 v197, v74, v75
    v_cvt_pk_bf16_f32 v198, v76, v77
    v_cvt_pk_bf16_f32 v199, v78, v79
    v_cvt_pk_bf16_f32 v200, v80, v81
    v_cvt_pk_bf16_f32 v201, v82, v83
    v_cvt_pk_bf16_f32 v202, v84, v85
    v_cvt_pk_bf16_f32 v203, v86, v87
    v_cvt_pk_bf16_f32 v204, v88, v89
    v_cvt_pk_bf16_f32 v205, v90, v91
    v_cvt_pk_bf16_f32 v206, v92, v93
    v_cvt_pk_bf16_f32 v207, v94, v95
    s_barrier
    s_barrier
    s_branch A_att
PGA_att:
    s_setpc_b64 s[72:73]
    s_nop 0
A_att:
    v_add_u32 v250, 131072, v244
    v_and_b32 v248, 31, v251
    v_lshl_add_u32 v248, v248, 2, s22
    v_and_b32 v255, 15, v251
    v_lshl_add_u32 v255, v255, 2, s22
    v_mov_b32 v96, 0
    v_mov_b32 v97, 0
    v_mov_b32 v98, 0
    v_mov_b32 v99, 0
    v_mov_b32 v100, 0
    v_mov_b32 v101, 0
    v_mov_b32 v102, 0
    v_mov_b32 v103, 0
    v_mov_b32 v104, 0
    v_mov_b32 v105, 0
    v_mov_b32 v106, 0
    v_mov_b32 v107, 0
    v_mov_b32 v108, 0
    v_mov_b32 v109, 0
    v_mov_b32 v110, 0
    v_mov_b32 v111, 0
    v_mov_b32 v112, 0
    v_mov_b32 v113, 0
    v_mov_b32 v114, 0
    v_mov_b32 v115, 0
    v_mov_b32 v116, 0
    v_mov_b32 v117, 0
    v_mov_b32 v118, 0
    v_mov_b32 v119, 0
    v_mov_b32 v120, 0
    v_mov_b32 v121, 0
    v_mov_b32 v122, 0
    v_mov_b32 v123, 0
    v_mov_b32 v124, 0
    v_mov_b32 v125, 0
    v_mov_b32 v126, 0
    v_mov_b32 v127, 0
    v_mov_b32 v232, 0
    v_mov_b32 v233, 0
    v_mov_b32 v234, 0
    v_mov_b32 v235, 0
    v_mov_b32 v236, 0
    v_mov_b32 v237, 0
    v_mov_b32 v238, 0
    v_mov_b32 v239, 0
    v_mov_b32 v158, 0
    v_mov_b32 v159, 0
    v_mov_b32 v129, 0x3f803f80
    v_and_b32 v128, 6, v251
    v_cmp_eq_u32 vcc, 0, v128
    v_cmp_eq_u32 s[46:47], 4, v128
    v_and_b32 v128, 1, v251
    v_cndmask_b32 v240, 0, v129, vcc
    v_cndmask_b32 v241, 0, v129, vcc
    v_cndmask_b32 v242, 0, v129, s[46:47]
    v_cndmask_b32 v243, 0, v129, s[46:47]
    v_sub_u32 v128, 0, v128
    v_and_b32 v128, 0xaaaaaaaa, v128
    v_or_b32 v244, 0x44444444, v128
    v_lshlrev_b32 v245, 4, v251
    v_add_u32 v246, 90112, v245
    ds_read_b128 v[216:219], v250 offset:24576
    ds_read_b128 v[220:223], v250 offset:25600
    ds_read_b128 v[224:227], v250 offset:2048
    s_waitcnt lgkmcnt(1)
    v_mfma_f32_32x32x16_bf16 v[128:143], v[216:219], v[192:195], 0
    ds_read_b32 v247, v248 offset:0
    ds_read_b32 v248, v248 offset:128
    v_mfma_f32_32x32x16_bf16 v[128:143], v[220:223], v[196:199], v[128:143]
    v_mov_b32 v208, 0
    v_mov_b32 v209, 0
    v_mov_b32 v210, 0
    v_mov_b32 v211, 0
    v_mov_b32 v212, 0
    v_mov_b32 v213, 0
    v_mov_b32 v214, 0
    v_mov_b32 v215, 0
    v_mov_b32 v228, 0
    v_mov_b32 v229, 0
    v_mov_b32 v230, 0
    v_mov_b32 v231, 0
    s_mov_b32 s50, 7
    s_waitcnt lgkmcnt(0)
    s_branch A_attonly
A_loader_light:
    v_lshlrev_b32 v28, 4, v11
    v_mov_b32 v44, -1
    v_mov_b32 v45, -1
    v_mov_b32 v46, -1
    v_mov_b32 v47, -1
    s_lshl_b32 s48, s4, 1
    s_add_u32 s48, s48, s5
    s_sub_u32 s48, s48, 14
    s_lshl_b32 s48, s48, 2
    s_add_u32 s47, s48, s3
    s_lshl_b32 s47, s47, 12
    s_add_u32 s47, s47, 4521984
    s_waitcnt lgkmcnt(0)
    buffer_store_dwordx4 v[44:47], v28, s[24:27], s47 offen offset:0 sc1
    buffer_store_dwordx4 v[44:47], v28, s[24:27], s47 offen offset:1024 sc1
    buffer_store_dwordx4 v[44:47], v28, s[24:27], s47 offen offset:2048 sc1
    buffer_store_dwordx4 v[44:47], v28, s[24:27], s47 offen offset:3072 sc1
    s_lshl_b32 s58, s4, 1
    s_add_u32 s58, s58, s5
    s_sub_u32 s58, s58, 14
    s_lshl_b32 s58, s58, 2
    s_add_u32 s58, s58, s3
    v_lshrrev_b32 v32, 2, v11
    v_and_b32 v33, 3, v11
    v_lshlrev_b32 v33, 7, v33
    v_lshl_add_u32 v32, v32, 11, v33
    v_and_b32 v33, 31, v11
    v_min_u32 v34, 27, v33
    v_lshrrev_b32 v35, 5, v11
    v_mul_u32_u24 v36, 7168, v35
    v_lshl_add_u32 v34, v34, 7, v36
    v_lshlrev_b32 v33, 7, v33
    v_lshl_add_u32 v33, v35, 19, v33
    s_lshl_b32 s59, s58, 15
    s_mul_i32 s60, s58, 14336
    s_lshl_b32 s58, s58, 12
    s_add_u32 s46, s59, 1024
    buffer_load_dword v40, v32, s[8:11], s46 offen
    s_add_u32 s46, s60, 3673600
    buffer_load_dword v40, v34, s[12:15], s46 offen
    s_load_dwordx2 s[16:17], s[0:1], 8
    s_load_dwordx2 s[20:21], s[0:1], 56
    s_load_dwordx2 s[28:29], s[0:1], 96
    s_load_dwordx2 s[32:33], s[0:1], 80
    s_load_dwordx2 s[40:41], s[0:1], 16
    s_mov_b32 s18, 0x200000
    s_mov_b32 s19, 0x20000
    s_mov_b32 s22, 0x800000
    s_mov_b32 s23, 0x20000
    s_mov_b32 s30, 0x100
    s_mov_b32 s31, 0x20000
    s_mov_b32 s34, 0x800
    s_mov_b32 s35, 0x20000
    s_mov_b32 s42, 0x10000
    s_mov_b32 s43, 0x20000
    s_load_dwordx2 s[44:45], s[0:1], 24
    s_lshl_b32 s57, s3, 11
    s_add_u32 s57, s57, 131072
    s_lshl_b32 s50, s3, 15
    s_lshl_b32 s46, s5, 7
    s_add_u32 s50, s50, s46
    s_mov_b32 s52, 0
    v_lshl_add_u32 v20, v12, 11, v14
    v_lshl_add_u32 v21, v12, 11, v15
    v_add_u32 v21, 16384, v21
    v_lshl_add_u32 v22, v12, 11, v14
    v_add_u32 v22, 32768, v22
    v_lshl_add_u32 v23, v12, 11, v15
    v_add_u32 v23, 49152, v23
    v_and_b32 v16, 2, v12
    v_lshlrev_b32 v16, 1, v16
    v_xor_b32 v16, v16, v13
    v_lshlrev_b32 v16, 4, v16
    v_lshl_add_u32 v9, v12, 11, v16
    v_xor_b32 v10, 32, v9
    v_add_u32 v10, 16384, v10
    v_and_b32 v16, 6, v12
    v_xor_b32 v16, v16, v13
    v_lshlrev_b32 v16, 4, v16
    v_lshl_add_u32 v16, v12, 11, v16
    v_add_u32 v29, s50, v16
    v_add_u32 v30, 16384, v29
    s_lshl_b32 s7, s3, 10
    s_add_u32 s49, s7, 65536
    v_mov_b32 v48, 1
    s_waitcnt lgkmcnt(0)
    s_cmp_eq_u32 s5, 14
    s_cselect_b32 s40, s40, s44
    s_cselect_b32 s41, s41, s45
    s_setprio 0
    s_waitcnt vmcnt(0)
    s_barrier
    s_cmp_lg_u32 s3, 0
    s_cbranch_scc1 A_noclear
    s_mov_b64 exec, 1
    buffer_store_dword v48, off, s[28:31], s48 offset:64 sc1
    s_mov_b64 exec, -1
A_noclear:
    s_add_u32 s46, s59, 1536
    buffer_load_dword v40, v32, s[8:11], s46 offen
    s_add_u32 s46, s60, 5508608
    buffer_load_dword v40, v34, s[12:15], s46 offen
    s_lshl_b32 s46, s4, 2
    s_add_u32 s46, s46, s3
    s_lshl_b32 s46, s46, 10
    v_and_b32 v37, 0x380, v33
    buffer_load_dword v40, v37, s[40:43], s46 offen
    s_add_u32 s46, s60, 0
    buffer_load_dword v40, v34, s[12:15], s46 offen
    s_add_u32 s46, s58, 0
    buffer_load_dword v40, v33, s[16:19], s46 offen
    s_add_u32 s46, s60, 1835008
    buffer_load_dword v40, v34, s[12:15], s46 offen
    s_add_u32 s46, s60, 3670016
    buffer_load_dword v40, v34, s[12:15], s46 offen
    s_add_u32 s46, s58, 1048576
    buffer_load_dword v40, v33, s[16:19], s46 offen
    s_add_u32 s46, s60, 5505024
    buffer_load_dword v40, v34, s[12:15], s46 offen
    v_lshrrev_b32 v19, 2, v11
    v_and_b32 v18, 3, v11
    v_lshlrev_b32 v18, 7, v18
    v_lshl_add_u32 v19, v19, 12, v18
    s_lshl_b32 s68, s4, 1
    s_add_u32 s68, s68, s5
    s_sub_u32 s68, s68, 14
    s_lshl_b32 s68, s68, 2
    s_add_u32 s68, s68, s3
    s_lshl_b32 s69, s68, 16
    buffer_load_dword v18, v19, s[20:23], s69 offen
    s_add_u32 s69, s69, 512
    buffer_load_dword v18, v19, s[20:23], s69 offen
    s_add_u32 s69, s69, 512
    v_and_b32 v12, 31, v11
    v_lshlrev_b32 v12, 2, v12
    s_mov_b32 s48, 64
    s_cmp_lg_u32 s3, 0
    s_cbranch_scc1 A_pollc2_i
    buffer_load_dword v13, v12, s[28:31], s48 offen sc1
A_pollc2_i:
    s_cmp_lg_u32 s3, 0
    s_cbranch_scc1 A_pollc2_out
    s_mov_b32 s47, 65536
    s_waitcnt vmcnt(0)
A_pollc2:
    v_cmp_ne_u32 vcc, 1, v13
    s_sub_u32 s47, s47, 1
    s_cbranch_scc1 A_pollc2_out
    s_nop 1
    s_cbranch_vccz A_pollc2_out
    s_sleep 2
    buffer_load_dword v13, v12, s[28:31], s48 offen sc1
    s_waitcnt vmcnt(0)
    s_branch A_pollc2
A_pollc2_out:
    s_and_b32 s46, s7, 1024
    s_add_u32 m0, s46, 156672
    s_nop 0
    buffer_load_dwordx4 v28, s[32:35], s46 offen lds
    s_mov_b32 s36, 0x76543210
    s_mov_b32 s37, 0xfedcba98
    s_mov_b32 s61, 2
A_seg9:
    s_lshr_b64 s[44:45], s[36:37], s52
    s_and_b32 s60, s44, 15
    s_add_u32 s52, s52, 4
    s_lshl_b32 s60, s60, 17
    s_add_u32 s60, s60, s50
    s_add_u32 m0, s57, 0
    s_nop 0
    buffer_load_dwordx4 v9, s[16:19], s60 offen lds
    s_add_u32 m0, s57, 1024
    s_nop 0
    buffer_load_dwordx4 v10, s[16:19], s60 offen lds
    s_lshr_b64 s[44:45], s[36:37], s51
    s_and_b32 s59, s44, 15
    s_add_u32 s51, s51, 4
    s_lshl_b32 s58, s59, 7
    s_add_u32 s58, s58, s6
    s_mul_i32 s59, s59, 4096
    s_add_u32 s59, s59, s7
    s_add_u32 m0, s56, 0
    s_nop 0
    buffer_load_dwordx4 v20, s[8:11], s58 offen lds
    s_add_u32 m0, s56, 1024
    s_nop 0
    buffer_load_dwordx4 v21, s[8:11], s58 offen lds
    s_add_u32 m0, s56, 2048
    s_nop 0
    buffer_load_dwordx4 v22, s[8:11], s58 offen lds
    s_add_u32 m0, s56, 3072
    s_nop 0
    buffer_load_dwordx4 v23, s[8:11], s58 offen lds
    s_and_b32 s46, s56, 0xc000
    s_add_u32 m0, s46, s49
    s_nop 0
    buffer_load_dwordx4 v28, s[40:43], s59 offen lds
    s_add_u32 s57, s57, 8192
    s_cmp_ge_u32 s57, 155648
    s_cselect_b32 s46, 24576, 0
    s_sub_u32 s57, s57, s46
    s_add_u32 s56, s56, 16384
    s_and_b32 s56, s56, 0xffff
    s_sub_u32 s61, s61, 1
    s_cmp_lg_u32 s61, 0
    s_cbranch_scc1 A_seg9
    s_mov_b32 s61, 14
A_seg10:
    s_waitcnt vmcnt(7)
    s_barrier
    s_lshr_b64 s[44:45], s[36:37], s52
    s_and_b32 s60, s44, 15
    s_add_u32 s52, s52, 4
    s_lshl_b32 s60, s60, 17
    s_add_u32 s60, s60, s50
    s_add_u32 m0, s57, 0
    s_nop 0
    buffer_load_dwordx4 v9, s[16:19], s60 offen lds
    s_add_u32 m0, s57, 1024
    s_nop 0
    buffer_load_dwordx4 v10, s[16:19], s60 offen lds
    s_lshr_b64 s[44:45], s[36:37], s51
    s_and_b32 s59, s44, 15
    s_add_u32 s51, s51, 4
    s_lshl_b32 s58, s59, 7
    s_add_u32 s58, s58, s6
    s_mul_i32 s59, s59, 4096
    s_add_u32 s59, s59, s7
    s_add_u32 m0, s56, 0
    s_nop 0
    buffer_load_dwordx4 v20, s[8:11], s58 offen lds
    s_add_u32 m0, s56, 1024
    s_nop 0
    buffer_load_dwordx4 v21, s[8:11], s58 offen lds
    s_add_u32 m0, s56, 2048
    s_nop 0
    buffer_load_dwordx4 v22, s[8:11], s58 offen lds
    s_add_u32 m0, s56, 3072
    s_nop 0
    buffer_load_dwordx4 v23, s[8:11], s58 offen lds
    s_and_b32 s46, s56, 0xc000
    s_add_u32 m0, s46, s49
    s_nop 0
    buffer_load_dwordx4 v28, s[40:43], s59 offen lds
    s_add_u32 s57, s57, 8192
    s_cmp_ge_u32 s57, 155648
    s_cselect_b32 s46, 24576, 0
    s_sub_u32 s57, s57, s46
    s_add_u32 s56, s56, 16384
    s_and_b32 s56, s56, 0xffff
    s_sub_u32 s61, s61, 1
    s_cmp_lg_u32 s61, 0
    s_cbranch_scc1 A_seg10
    s_waitcnt vmcnt(7)
    s_barrier
    s_waitcnt vmcnt(0)
    s_barrier
    s_barrier
    s_load_dwordx2 s[8:9], s[0:1], 32
    s_load_dwordx2 s[12:13], s[0:1], 72
    s_mul_i32 s62, s55, 7
    s_lshr_b32 s62, s62, 1
    s_mul_i32 s63, s55, 2
    s_waitcnt lgkmcnt(0)
    s_mov_b32 s10, 0x200000
    s_mov_b32 s11, 0x20000
    s_mov_b32 s14, 0x380000
    s_mov_b32 s15, 0x20000
    s_add_u32 s54, s62, 16
    s_cmp_ge_u32 s54, 28
    s_cselect_b32 s46, 28, 0
    s_sub_u32 s54, s54, s46
    s_lshl_b32 s54, s54, 17
    s_barrier
    s_lshl_b32 s46, s4, 7
    s_add_u32 s46, s46, s5
    s_lshl_b32 s46, s46, 8
    s_add_u32 s46, s46, 4550656
    s_cmp_lg_u32 s3, 0
    s_cbranch_scc1 A_setkv
    v_mov_b32 v16, 1
    s_mov_b64 exec, 1
    buffer_store_dword v16, off, s[24:27], s46 sc1
    s_mov_b64 exec, -1
A_setkv:
    buffer_load_dword v18, v19, s[20:23], s69 offen
    s_add_u32 s69, s69, 512
    buffer_load_dword v18, v19, s[20:23], s69 offen
    s_add_u32 s69, s69, 512
    v_bfe_u32 v12, v11, 1, 4
    v_and_b32 v13, 1, v11
    v_lshl_add_u32 v12, v12, 7, v13
    v_lshlrev_b32 v12, 8, v12
    v_lshlrev_b32 v14, 2, v11
    s_mov_b32 s48, 4554240
    s_cmp_lg_u32 s3, 0
    s_cbranch_scc1 A_pollkv2_i
    buffer_load_dword v13, v12, s[24:27], s48 offen sc1
A_pollkv2_i:
    s_cmp_lg_u32 s3, 0
    s_cbranch_scc1 A_pollkv2_out
    s_mov_b32 s47, 65536
    s_waitcnt vmcnt(0)
A_pollkv2:
    v_cmp_ne_u32 vcc, 1, v13
    s_sub_u32 s47, s47, 1
    s_cbranch_scc1 A_pollkv2_out
    s_nop 1
    s_cbranch_vccz A_pollkv2_out
    s_sleep 8
    buffer_load_dword v13, v12, s[24:27], s48 offen sc1
    s_waitcnt vmcnt(0)
    s_branch A_pollkv2
A_pollkv2_out:
    s_barrier
    s_lshl_b32 s60, s3, 11
    s_add_u32 s57, s60, 131072
    s_add_u32 s60, s60, 4198400
    s_cmp_ge_u32 s3, 2
    s_cbranch_scc1 A_ft2_g
    s_lshl_b32 s46, s3, 10
    s_add_u32 m0, s46, 155648
    s_add_u32 s46, s46, 4194304
    buffer_load_dwordx4 v28, s[24:27], s46 offen sc1 lds
    s_branch A_ft2_e
A_ft2_g:
    s_lshl_b32 s46, s3, 8
    s_add_u32 m0, s46, 157184
    s_lshl_b32 s47, s4, 9
    s_add_u32 s46, s46, s47
    s_add_u32 s46, s46, 4488704
    buffer_load_dword v14, s[24:27], s46 offen sc1 lds
A_ft2_e:
    s_mov_b32 s61, 3
A_seg11:
    s_mov_b32 m0, s57
    s_nop 0
    buffer_load_dwordx4 v28, s[24:27], s60 offen offset:0 sc1 lds
    buffer_load_dwordx4 v28, s[24:27], s60 offen offset:1024 sc1 lds
    s_add_u32 s60, s60, 8192
    s_add_u32 s57, s57, 8192
    s_and_b32 s57, s57, 163839
    s_sub_u32 s61, s61, 1
    s_cmp_lg_u32 s61, 0
    s_cbranch_scc1 A_seg11
    s_waitcnt vmcnt(4)
    s_barrier
    s_waitcnt vmcnt(0)
    s_barrier
    s_mov_b32 m0, s57
    s_nop 0
    buffer_load_dwordx4 v28, s[24:27], s60 offen offset:0 sc1 lds
    buffer_load_dwordx4 v28, s[24:27], s60 offen offset:1024 sc1 lds
    s_add_u32 s60, s60, 8192
    s_add_u32 s57, s57, 8192
    s_and_b32 s57, s57, 163839
    s_mov_b32 m0, s57
    s_nop 0
    buffer_load_dwordx4 v28, s[24:27], s60 offen offset:0 sc1 lds
    buffer_load_dwordx4 v28, s[24:27], s60 offen offset:1024 sc1 lds
    s_add_u32 s60, s60, 8192
    s_add_u32 s57, s57, 8192
    s_and_b32 s57, s57, 163839
    buffer_load_dword v18, v19, s[20:23], s69 offen
    s_add_u32 s69, s69, 512
    buffer_load_dword v18, v19, s[20:23], s69 offen
    s_add_u32 s69, s69, 512
    s_waitcnt vmcnt(2)
    s_barrier
    s_mov_b32 m0, s57
    s_nop 0
    buffer_load_dwordx4 v28, s[24:27], s60 offen offset:0 sc1 lds
    buffer_load_dwordx4 v28, s[24:27], s60 offen offset:1024 sc1 lds
    s_add_u32 s60, s60, 8192
    s_add_u32 s57, s57, 8192
    s_and_b32 s57, s57, 163839
    s_mov_b32 m0, s57
    s_nop 0
    buffer_load_dwordx4 v28, s[24:27], s60 offen offset:0 sc1 lds
    buffer_load_dwordx4 v28, s[24:27], s60 offen offset:1024 sc1 lds
    s_add_u32 s60, s60, 8192
    s_add_u32 s57, s57, 8192
    s_and_b32 s57, s57, 163839
    v_mov_b32 v17, v19
    v_lshlrev_b32 v19, 7, v11
    s_lshl_b32 s69, s68, 13
    buffer_load_dword v18, v19, s[12:15], s69 offen
    s_add_u32 s69, s69, 1048576
    buffer_load_dword v18, v19, s[12:15], s69 offen
    s_add_u32 s69, s69, 1048576
    s_waitcnt vmcnt(2)
    s_barrier
    s_mov_b32 m0, s57
    s_nop 0
    buffer_load_dwordx4 v28, s[24:27], s60 offen offset:0 sc1 lds
    buffer_load_dwordx4 v28, s[24:27], s60 offen offset:1024 sc1 lds
    s_add_u32 s60, s60, 8192
    s_add_u32 s57, s57, 8192
    s_and_b32 s57, s57, 163839
    s_mov_b32 m0, s57
    s_nop 0
    buffer_load_dwordx4 v28, s[24:27], s60 offen offset:0 sc1 lds
    buffer_load_dwordx4 v28, s[24:27], s60 offen offset:1024 sc1 lds
    s_add_u32 s60, s60, 8192
    s_add_u32 s57, s57, 8192
    s_and_b32 s57, s57, 163839
    buffer_load_dword v18, v19, s[12:15], s69 offen
    s_add_u32 s69, s69, 1048576
    buffer_load_dword v18, v19, s[12:15], s69 offen
    s_add_u32 s69, s69, 1048576
    s_waitcnt vmcnt(2)
    s_barrier
    s_mov_b32 m0, s57
    s_nop 0
    buffer_load_dwordx4 v28, s[24:27], s60 offen offset:0 sc1 lds
    buffer_load_dwordx4 v28, s[24:27], s60 offen offset:1024 sc1 lds
    s_add_u32 s60, s60, 8192
    s_add_u32 s57, s57, 8192
    s_and_b32 s57, s57, 163839
    s_mov_b32 m0, s57
    s_nop 0
    buffer_load_dwordx4 v28, s[24:27], s60 offen offset:0 sc1 lds
    buffer_load_dwordx4 v28, s[24:27], s60 offen offset:1024 sc1 lds
    s_add_u32 s60, s60, 8192
    s_add_u32 s57, s57, 8192
    s_and_b32 s57, s57, 163839
    v_mov_b32 v19, v17
    s_lshl_b32 s69, s68, 16
    s_add_u32 s69, s69, 3072
    buffer_load_dword v18, v19, s[20:23], s69 offen
    s_add_u32 s69, s69, 512
    buffer_load_dword v18, v19, s[20:23], s69 offen
    s_add_u32 s69, s69, 512
    s_waitcnt vmcnt(2)
    s_barrier
    s_mov_b32 m0, s57
    s_nop 0
    buffer_load_dwordx4 v28, s[24:27], s60 offen offset:0 sc1 lds
    buffer_load_dwordx4 v28, s[24:27], s60 offen offset:1024 sc1 lds
    s_add_u32 s60, s60, 8192
    s_add_u32 s57, s57, 8192
    s_and_b32 s57, s57, 163839
    s_mov_b32 m0, s57
    s_nop 0
    buffer_load_dwordx4 v28, s[24:27], s60 offen offset:0 sc1 lds
    buffer_load_dwordx4 v28, s[24:27], s60 offen offset:1024 sc1 lds
    s_add_u32 s60, s60, 8192
    s_add_u32 s57, s57, 8192
    s_and_b32 s57, s57, 163839
    v_lshlrev_b32 v19, 7, v11
    s_lshl_b32 s69, s68, 13
    buffer_load_dword v18, v19, s[8:11], s69 offen
    s_add_u32 s69, s69, 1048576
    buffer_load_dword v18, v19, s[8:11], s69 offen
    s_add_u32 s69, s69, 1048576
    s_waitcnt vmcnt(2)
    s_barrier
    s_mov_b32 m0, s57
    s_nop 0
    buffer_load_dwordx4 v28, s[24:27], s60 offen offset:0 sc1 lds
    buffer_load_dwordx4 v28, s[24:27], s60 offen offset:1024 sc1 lds
    s_add_u32 s60, s60, 8192
    s_add_u32 s57, s57, 8192
    s_and_b32 s57, s57, 163839
    s_mov_b32 m0, s57
    s_nop 0
    buffer_load_dwordx4 v28, s[24:27], s60 offen offset:0 sc1 lds
    buffer_load_dwordx4 v28, s[24:27], s60 offen offset:1024 sc1 lds
    s_add_u32 s60, s60, 8192
    s_add_u32 s57, s57, 8192
    s_and_b32 s57, s57, 163839
    buffer_load_dwordx4 v[32:35], v29, s[12:15], s54 offen
    buffer_load_dwordx4 v[36:39], v30, s[12:15], s54 offen
    s_add_u32 s54, s54, 131072
    s_cmp_eq_u32 s54, 3670016
    s_cselect_b32 s54, 0, s54
    buffer_load_dwordx4 v[40:43], v29, s[12:15], s54 offen
    buffer_load_dwordx4 v[44:47], v30, s[12:15], s54 offen
    s_add_u32 s54, s54, 131072
    s_cmp_eq_u32 s54, 3670016
    s_cselect_b32 s54, 0, s54
    buffer_load_dwordx4 v[48:51], v29, s[12:15], s54 offen
    buffer_load_dwordx4 v[52:55], v30, s[12:15], s54 offen
    s_add_u32 s54, s54, 131072
    s_cmp_eq_u32 s54, 3670016
    s_cselect_b32 s54, 0, s54
    buffer_load_dwordx4 v[56:59], v29, s[12:15], s54 offen
    buffer_load_dwordx4 v[60:63], v30, s[12:15], s54 offen
    s_add_u32 s54, s54, 131072
    s_cmp_eq_u32 s54, 3670016
    s_cselect_b32 s54, 0, s54
    buffer_load_dwordx4 v[64:67], v29, s[12:15], s54 offen
    buffer_load_dwordx4 v[68:71], v30, s[12:15], s54 offen
    s_add_u32 s54, s54, 131072
    s_cmp_eq_u32 s54, 3670016
    s_cselect_b32 s54, 0, s54
    buffer_load_dwordx4 v[72:75], v29, s[12:15], s54 offen
    buffer_load_dwordx4 v[76:79], v30, s[12:15], s54 offen
    s_add_u32 s54, s54, 131072
    s_cmp_eq_u32 s54, 3670016
    s_cselect_b32 s54, 0, s54
    s_branch PG13_go
    .p2align 12
PG13:
    s_setpc_b64 s[72:73]
    s_nop 0
PG13_go:
    s_waitcnt vmcnt(12)
    s_barrier
    s_mov_b32 m0, s57
    s_nop 0
    buffer_load_dwordx4 v28, s[24:27], s60 offen offset:0 sc1 lds
    buffer_load_dwordx4 v28, s[24:27], s60 offen offset:1024 sc1 lds
    s_add_u32 s60, s60, 8192
    s_add_u32 s57, s57, 8192
    s_and_b32 s57, s57, 163839
    s_mov_b32 m0, s57
    s_nop 0
    buffer_load_dwordx4 v28, s[24:27], s60 offen offset:0 sc1 lds
    buffer_load_dwordx4 v28, s[24:27], s60 offen offset:1024 sc1 lds
    s_add_u32 s60, s60, 8192
    s_add_u32 s57, s57, 8192
    s_and_b32 s57, s57, 163839
    buffer_load_dwordx4 v[80:83], v29, s[12:15], s54 offen
    buffer_load_dwordx4 v[84:87], v30, s[12:15], s54 offen
    s_add_u32 s54, s54, 131072
    s_cmp_eq_u32 s54, 3670016
    s_cselect_b32 s54, 0, s54
    buffer_load_dwordx4 v[88:91], v29, s[12:15], s54 offen
    buffer_load_dwordx4 v[92:95], v30, s[12:15], s54 offen
    s_add_u32 s54, s54, 131072
    s_cmp_eq_u32 s54, 3670016
    s_cselect_b32 s54, 0, s54
    buffer_load_dwordx4 v[96:99], v29, s[12:15], s54 offen
    buffer_load_dwordx4 v[100:103], v30, s[12:15], s54 offen
    s_add_u32 s54, s54, 131072
    s_cmp_eq_u32 s54, 3670016
    s_cselect_b32 s54, 0, s54
    buffer_load_dwordx4 v[104:107], v29, s[12:15], s54 offen
    buffer_load_dwordx4 v[108:111], v30, s[12:15], s54 offen
    s_add_u32 s54, s54, 131072
    s_cmp_eq_u32 s54, 3670016
    s_cselect_b32 s54, 0, s54
    buffer_load_dwordx4 v[112:115], v29, s[12:15], s54 offen
    buffer_load_dwordx4 v[116:119], v30, s[12:15], s54 offen
    s_add_u32 s54, s54, 131072
    s_cmp_eq_u32 s54, 3670016
    s_cselect_b32 s54, 0, s54
    buffer_load_dwordx4 v[120:123], v29, s[12:15], s54 offen
    buffer_load_dwordx4 v[124:127], v30, s[12:15], s54 offen
    s_add_u32 s54, s54, 131072
    s_cmp_eq_u32 s54, 3670016
    s_cselect_b32 s54, 0, s54
    s_waitcnt vmcnt(12)
    s_barrier
    s_mov_b32 m0, s57
    s_nop 0
    buffer_load_dwordx4 v28, s[24:27], s60 offen offset:0 sc1 lds
    buffer_load_dwordx4 v28, s[24:27], s60 offen offset:1024 sc1 lds
    s_add_u32 s60, s60, 8192
    s_add_u32 s57, s57, 8192
    s_and_b32 s57, s57, 163839
    s_mov_b32 m0, s57
    s_nop 0
    buffer_load_dwordx4 v28, s[24:27], s60 offen offset:0 sc1 lds
    buffer_load_dwordx4 v28, s[24:27], s60 offen offset:1024 sc1 lds
    s_add_u32 s60, s60, 8192
    s_add_u32 s57, s57, 8192
    s_and_b32 s57, s57, 163839
    s_lshl_b32 s54, s63, 17
    buffer_load_dwordx4 v[128:131], v29, s[8:11], s54 offen
    buffer_load_dwordx4 v[132:135], v30, s[8:11], s54 offen
    s_add_u32 s54, s54, 131072
    s_cmp_eq_u32 s54, 2097152
    s_cselect_b32 s54, 0, s54
    buffer_load_dwordx4 v[136:139], v29, s[8:11], s54 offen
    buffer_load_dwordx4 v[140:143], v30, s[8:11], s54 offen
    s_add_u32 s54, s54, 131072
    s_cmp_eq_u32 s54, 2097152
    s_cselect_b32 s54, 0, s54
    buffer_load_dwordx4 v[144:147], v29, s[8:11], s54 offen
    buffer_load_dwordx4 v[148:151], v30, s[8:11], s54 offen
    s_add_u32 s54, s54, 131072
    s_cmp_eq_u32 s54, 2097152
    s_cselect_b32 s54, 0, s54
    buffer_load_dwordx4 v[152:155], v29, s[8:11], s54 offen
    buffer_load_dwordx4 v[156:159], v30, s[8:11], s54 offen
    s_add_u32 s54, s54, 131072
    s_cmp_eq_u32 s54, 2097152
    s_cselect_b32 s54, 0, s54
    buffer_load_dwordx4 v[160:163], v29, s[8:11], s54 offen
    buffer_load_dwordx4 v[164:167], v30, s[8:11], s54 offen
    s_add_u32 s54, s54, 131072
    s_cmp_eq_u32 s54, 2097152
    s_cselect_b32 s54, 0, s54
    buffer_load_dwordx4 v[168:171], v29, s[8:11], s54 offen
    buffer_load_dwordx4 v[172:175], v30, s[8:11], s54 offen
    s_add_u32 s54, s54, 131072
    s_cmp_eq_u32 s54, 2097152
    s_cselect_b32 s54, 0, s54
    s_waitcnt vmcnt(12)
    s_barrier
    s_mov_b32 m0, s57
    s_nop 0
    buffer_load_dwordx4 v28, s[24:27], s60 offen offset:0 sc1 lds
    buffer_load_dwordx4 v28, s[24:27], s60 offen offset:1024 sc1 lds
    s_add_u32 s60, s60, 8192
    s_add_u32 s57, s57, 8192
    s_and_b32 s57, s57, 163839
    s_mov_b32 m0, s57
    s_nop 0
    buffer_load_dwordx4 v28, s[24:27], s60 offen offset:0 sc1 lds
    buffer_load_dwordx4 v28, s[24:27], s60 offen offset:1024 sc1 lds
    s_add_u32 s60, s60, 8192
    s_add_u32 s57, s57, 8192
    s_and_b32 s57, s57, 163839
    buffer_load_dwordx4 v[176:179], v29, s[8:11], s54 offen
    buffer_load_dwordx4 v[180:183], v30, s[8:11], s54 offen
    s_add_u32 s54, s54, 131072
    s_cmp_eq_u32 s54, 2097152
    s_cselect_b32 s54, 0, s54
    buffer_load_dwordx4 v[184:187], v29, s[8:11], s54 offen
    buffer_load_dwordx4 v[188:191], v30, s[8:11], s54 offen
    s_add_u32 s54, s54, 131072
    s_cmp_eq_u32 s54, 2097152
    s_cselect_b32 s54, 0, s54
    buffer_load_dwordx4 v[192:195], v29, s[8:11], s54 offen
    buffer_load_dwordx4 v[196:199], v30, s[8:11], s54 offen
    s_add_u32 s54, s54, 131072
    s_cmp_eq_u32 s54, 2097152
    s_cselect_b32 s54, 0, s54
    buffer_load_dwordx4 v[200:203], v29, s[8:11], s54 offen
    buffer_load_dwordx4 v[204:207], v30, s[8:11], s54 offen
    s_add_u32 s54, s54, 131072
    s_cmp_eq_u32 s54, 2097152
    s_cselect_b32 s54, 0, s54
    buffer_load_dwordx4 v[208:211], v29, s[8:11], s54 offen
    buffer_load_dwordx4 v[212:215], v30, s[8:11], s54 offen
    s_add_u32 s54, s54, 131072
    s_cmp_eq_u32 s54, 2097152
    s_cselect_b32 s54, 0, s54
    buffer_load_dwordx4 v[216:219], v29, s[8:11], s54 offen
    buffer_load_dwordx4 v[220:223], v30, s[8:11], s54 offen
    s_add_u32 s54, s54, 131072
    s_cmp_eq_u32 s54, 2097152
    s_cselect_b32 s54, 0, s54
    s_waitcnt vmcnt(0)
    s_branch A_loader_tail
A_fallback:
    s_waitcnt lgkmcnt(0)
    v_mov_b32 v250, 0xff800000
    s_mov_b32 s64, 4194304
    s_mov_b32 s65, 64
A_fb_max0:
    buffer_load_dwordx4 v[216:219], v245, s[24:27], s64 offen offset:0 sc1
    buffer_load_dwordx4 v[220:223], v245, s[24:27], s64 offen offset:1024 sc1
    s_waitcnt vmcnt(0)
    v_mfma_f32_32x32x16_bf16 v[128:143], v[216:219], v[192:195], 0
    v_mfma_f32_32x32x16_bf16 v[128:143], v[220:223], v[196:199], v[128:143]
    s_add_u32 s64, s64, 4096
    s_nop 15
    v_max3_f32 v250, v250, v128, v129
    v_max3_f32 v250, v250, v130, v131
    v_max3_f32 v250, v250, v132, v133
    v_max3_f32 v250, v250, v134, v135
    v_max3_f32 v250, v250, v136, v137
    v_max3_f32 v250, v250, v138, v139
    v_max3_f32 v250, v250, v140, v141
    v_max3_f32 v250, v250, v142, v143
    s_sub_u32 s65, s65, 1
    s_cmp_lg_u32 s65, 0
    s_cbranch_scc1 A_fb_max0
    v_mov_b32 v128, v250
    s_nop 1
    v_permlane32_swap_b32 v250, v128
    s_nop 1
    v_max_f32 v250, v250, v128
    v_sub_f32 v144, 0, v250
    v_mov_b32 v96, 0
    v_sub_f32 v145, 0, v250
    v_mov_b32 v97, 0
    v_sub_f32 v146, 0, v250
    v_mov_b32 v98, 0
    v_sub_f32 v147, 0, v250
    v_mov_b32 v99, 0
    v_sub_f32 v148, 0, v250
    v_mov_b32 v100, 0
    v_sub_f32 v149, 0, v250
    v_mov_b32 v101, 0
    v_sub_f32 v150, 0, v250
    v_mov_b32 v102, 0
    v_sub_f32 v151, 0, v250
    v_mov_b32 v103, 0
    v_sub_f32 v152, 0, v250
    v_mov_b32 v104, 0
    v_sub_f32 v153, 0, v250
    v_mov_b32 v105, 0
    v_sub_f32 v154, 0, v250
    v_mov_b32 v106, 0
    v_sub_f32 v155, 0, v250
    v_mov_b32 v107, 0
    v_sub_f32 v156, 0, v250
    v_mov_b32 v108, 0
    v_sub_f32 v157, 0, v250
    v_mov_b32 v109, 0
    v_sub_f32 v158, 0, v250
    v_mov_b32 v110, 0
    v_sub_f32 v159, 0, v250
    v_mov_b32 v111, 0
    v_mov_b32 v232, 0
    v_mov_b32 v233, 0
    v_mov_b32 v234, 0
    v_mov_b32 v235, 0
    s_mov_b32 s64, 4194304
    s_mov_b32 s65, 64
A_fb_sum0:
    buffer_load_dwordx4 v[216:219], v245, s[24:27], s64 offen offset:0 sc1
    buffer_load_dwordx4 v[220:223], v245, s[24:27], s64 offen offset:1024 sc1
    s_add_u32 s64, s64, 4096
    buffer_load_dwordx4 v[224:227], v245, s[24:27], s64 offen offset:2048 sc1
    buffer_load_dwordx4 v[228:231], v245, s[24:27], s64 offen offset:3072 sc1
    s_waitcnt vmcnt(0)
    v_mfma_f32_32x32x16_bf16 v[128:143], v[216:219], v[192:195], v[144:159]
    v_mfma_f32_32x32x16_bf16 v[128:143], v[220:223], v[196:199], v[128:143]
    s_nop 15
    v_exp_f32 v128, v128
    v_exp_f32 v129, v129
    v_exp_f32 v130, v130
    v_exp_f32 v131, v131
    v_exp_f32 v132, v132
    v_exp_f32 v133, v133
    v_exp_f32 v134, v134
    v_exp_f32 v135, v135
    v_exp_f32 v136, v136
    v_exp_f32 v137, v137
    v_exp_f32 v138, v138
    v_exp_f32 v139, v139
    v_exp_f32 v140, v140
    v_exp_f32 v141, v141
    v_exp_f32 v142, v142
    v_exp_f32 v143, v143
    s_nop 0
    v_cvt_pk_bf16_f32 v208, v128, v129
    v_cvt_pk_bf16_f32 v209, v130, v131
    v_cvt_pk_bf16_f32 v210, v132, v133
    v_cvt_pk_bf16_f32 v211, v134, v135
    v_cvt_pk_bf16_f32 v212, v136, v137
    v_cvt_pk_bf16_f32 v213, v138, v139
    v_cvt_pk_bf16_f32 v214, v140, v141
    v_cvt_pk_bf16_f32 v215, v142, v143
    s_nop 1
    v_mfma_f32_32x32x16_bf16 v[96:111], v[224:227], v[208:211], v[96:111]
    v_mfma_f32_32x32x16_bf16 v[96:111], v[228:231], v[212:215], v[96:111]
    v_smfmac_f32_16x16x64_bf16 v[232:235], v[240:243], v[208:215], v244
    s_sub_u32 s65, s65, 1
    s_cmp_lg_u32 s65, 0
    s_cbranch_scc1 A_fb_sum0
    s_nop 15
    v_add_f32 v232, v232, v233
    v_mov_b32 v250, 0xff800000
    s_mov_b32 s64, 4194304
    s_mov_b32 s65, 64
A_fb_max1:
    buffer_load_dwordx4 v[216:219], v245, s[24:27], s64 offen offset:0 sc1
    buffer_load_dwordx4 v[220:223], v245, s[24:27], s64 offen offset:1024 sc1
    s_waitcnt vmcnt(0)
    v_mfma_f32_32x32x16_bf16 v[128:143], v[216:219], v[200:203], 0
    v_mfma_f32_32x32x16_bf16 v[128:143], v[220:223], v[204:207], v[128:143]
    s_add_u32 s64, s64, 4096
    s_nop 15
    v_max3_f32 v250, v250, v128, v129
    v_max3_f32 v250, v250, v130, v131
    v_max3_f32 v250, v250, v132, v133
    v_max3_f32 v250, v250, v134, v135
    v_max3_f32 v250, v250, v136, v137
    v_max3_f32 v250, v250, v138, v139
    v_max3_f32 v250, v250, v140, v141
    v_max3_f32 v250, v250, v142, v143
    s_sub_u32 s65, s65, 1
    s_cmp_lg_u32 s65, 0
    s_cbranch_scc1 A_fb_max1
    v_mov_b32 v128, v250
    s_nop 1
    v_permlane32_swap_b32 v250, v128
    s_nop 1
    v_max_f32 v250, v250, v128
    v_sub_f32 v144, 0, v250
    v_mov_b32 v112, 0
    v_sub_f32 v145, 0, v250
    v_mov_b32 v113, 0
    v_sub_f32 v146, 0, v250
    v_mov_b32 v114, 0
    v_sub_f32 v147, 0, v250
    v_mov_b32 v115, 0
    v_sub_f32 v148, 0, v250
    v_mov_b32 v116, 0
    v_sub_f32 v149, 0, v250
    v_mov_b32 v117, 0
    v_sub_f32 v150, 0, v250
    v_mov_b32 v118, 0
    v_sub_f32 v151, 0, v250
    v_mov_b32 v119, 0
    v_sub_f32 v152, 0, v250
    v_mov_b32 v120, 0
    v_sub_f32 v153, 0, v250
    v_mov_b32 v121, 0
    v_sub_f32 v154, 0, v250
    v_mov_b32 v122, 0
    v_sub_f32 v155, 0, v250
    v_mov_b32 v123, 0
    v_sub_f32 v156, 0, v250
    v_mov_b32 v124, 0
    v_sub_f32 v157, 0, v250
    v_mov_b32 v125, 0
    v_sub_f32 v158, 0, v250
    v_mov_b32 v126, 0
    v_sub_f32 v159, 0, v250
    v_mov_b32 v127, 0
    v_mov_b32 v236, 0
    v_mov_b32 v237, 0
    v_mov_b32 v238, 0
    v_mov_b32 v239, 0
    s_mov_b32 s64, 4194304
    s_mov_b32 s65, 64
A_fb_sum1:
    buffer_load_dwordx4 v[216:219], v245, s[24:27], s64 offen offset:0 sc1
    buffer_load_dwordx4 v[220:223], v245, s[24:27], s64 offen offset:1024 sc1
    s_add_u32 s64, s64, 4096
    buffer_load_dwordx4 v[224:227], v245, s[24:27], s64 offen offset:2048 sc1
    buffer_load_dwordx4 v[228:231], v245, s[24:27], s64 offen offset:3072 sc1
    s_waitcnt vmcnt(0)
    v_mfma_f32_32x32x16_bf16 v[128:143], v[216:219], v[200:203], v[144:159]
    v_mfma_f32_32x32x16_bf16 v[128:143], v[220:223], v[204:207], v[128:143]
    s_nop 15
    v_exp_f32 v128, v128
    v_exp_f32 v129, v129
    v_exp_f32 v130, v130
    v_exp_f32 v131, v131
    v_exp_f32 v132, v132
    v_exp_f32 v133, v133
    v_exp_f32 v134, v134
    v_exp_f32 v135, v135
    v_exp_f32 v136, v136
    v_exp_f32 v137, v137
    v_exp_f32 v138, v138
    v_exp_f32 v139, v139
    v_exp_f32 v140, v140
    v_exp_f32 v141, v141
    v_exp_f32 v142, v142
    v_exp_f32 v143, v143
    s_nop 0
    v_cvt_pk_bf16_f32 v208, v128, v129
    v_cvt_pk_bf16_f32 v209, v130, v131
    v_cvt_pk_bf16_f32 v210, v132, v133
    v_cvt_pk_bf16_f32 v211, v134, v135
    v_cvt_pk_bf16_f32 v212, v136, v137
    v_cvt_pk_bf16_f32 v213, v138, v139
    v_cvt_pk_bf16_f32 v214, v140, v141
    v_cvt_pk_bf16_f32 v215, v142, v143
    s_nop 1
    v_mfma_f32_32x32x16_bf16 v[112:127], v[224:227], v[208:211], v[112:127]
    v_mfma_f32_32x32x16_bf16 v[112:127], v[228:231], v[212:215], v[112:127]
    v_smfmac_f32_16x16x64_bf16 v[236:239], v[240:243], v[208:215], v244
    s_sub_u32 s65, s65, 1
    s_cmp_lg_u32 s65, 0
    s_cbranch_scc1 A_fb_sum1
    s_nop 15
    v_add_f32 v236, v236, v237
    ds_read_b64_tr_b16 v[128:129], v252 offset:0
    ds_read_b64_tr_b16 v[130:131], v252 offset:2048
    ds_read_b64_tr_b16 v[132:133], v252 offset:4096
    ds_read_b64_tr_b16 v[134:135], v252 offset:6144
    ds_read_b64_tr_b16 v[136:137], v253 offset:0
    ds_read_b64_tr_b16 v[138:139], v253 offset:2048
    ds_read_b64_tr_b16 v[140:141], v253 offset:4096
    ds_read_b64_tr_b16 v[142:143], v253 offset:6144
    ds_read_b64_tr_b16 v[144:145], v254 offset:0
    ds_read_b64_tr_b16 v[146:147], v254 offset:2048
    ds_read_b64_tr_b16 v[148:149], v254 offset:4096
    ds_read_b64_tr_b16 v[150:151], v254 offset:6144
    s_branch A_fallback_back
.section .rodata,"a"
.p2align 6
.amdhsa_kernel gated_mix__grouped_kv_mqa__mixer_gmlp__prompt_kernel
  .amdhsa_next_free_vgpr 256
  .amdhsa_next_free_sgpr 102
  .amdhsa_accum_offset 256
  .amdhsa_group_segment_fixed_size 0
  .amdhsa_kernarg_size 112
  .amdhsa_user_sgpr_count 2
  .amdhsa_user_sgpr_kernarg_segment_ptr 1
  .amdhsa_system_sgpr_workgroup_id_x 1
.end_amdhsa_kernel
```
